```python
import torch

def _softmax(x, axis=-1):
    return torch.softmax(x, dim=axis)
def _gelu(x):
    return torch.nn.functional.gelu(x, approximate="tanh")
def _silu(x):
    return torch.nn.functional.silu(x)
def _sigmoid(x):
    return torch.sigmoid(x)
def _layernorm(x, axis=-1, eps=1e-5):
    m = x.mean(dim=axis, keepdim=True)
    v = x.var(dim=axis, keepdim=True, unbiased=False)
    return (x - m) / torch.sqrt(v + eps)
def _scatter_add(tgt, idx, src, axis=0):
    return tgt.clone().index_add_(axis, idx, src)
def _segment_sum(src, seg, n):
    out = torch.zeros((n,) + src.shape[1:], dtype=src.dtype)
    return out.index_add_(0, seg, src)
def _pad(x, pw):
    flat = tuple(v for pair in reversed(pw) for v in pair)
    return torch.nn.functional.pad(x, flat)

kernel_name = 'standalone__mha_block_cached__near_ridge'

def setup_inputs():

    _w = (lambda a: (lambda t: t.to(torch.bfloat16) if t.is_floating_point() else t)(torch.as_tensor(a)))
    B, Sq, D = 8, 288, 512
    H, Sk, Dh = 32, 1024, 128
    return {
        "x": _w((lambda *s: torch.randn(*s, dtype=torch.bfloat16) * 0.8)(B, Sq, D)),
        "k_cache": _w((lambda *s: torch.randn(*s, dtype=torch.bfloat16) * 0.8)(B, H, Sk, Dh)),
        "v_cache": _w((lambda *s: torch.randn(*s, dtype=torch.bfloat16) * 0.05)(B, H, Sk, Dh)),
        "wq": _w((lambda *s: torch.randn(*s, dtype=torch.bfloat16) * 0.8)(D, H * Dh) * (D ** -0.5)),
        "wo": _w((lambda *s: torch.randn(*s, dtype=torch.bfloat16) * 0.05)(H * Dh, D) * ((H * Dh) ** -0.5)),
    }

def reference(x, k_cache, v_cache, wq, wo):
    B, Sq, D = x.shape
    H, Dh = 32, 128
    q = (lambda x, *d: x.permute(*d))((x @ wq).reshape(B, Sq, H, Dh), 0, 2, 1, 3)
    scores = torch.einsum("bhqd,bhkd->bhqk", q, k_cache) * (Dh ** -0.5)
    p = _softmax(scores, axis=-1)
    o = torch.einsum("bhqk,bhkd->bhqd", p, v_cache)
    return (lambda x, *d: x.permute(*d))(o, 0, 2, 1, 3).reshape(B, Sq, H * Dh) @ wo
```

```asm
; @launch grid=(256,1,1) block=(256,1,1) lds=163840
.amdgcn_target "amdgcn-amd-amdhsa--gfx950"
.text
.globl standalone__mha_block_cached__near_ridge_kernel
.p2align 8
.type standalone__mha_block_cached__near_ridge_kernel,@function
standalone__mha_block_cached__near_ridge_kernel:
  s_cmp_ge_u32 s2, 0x100
  s_cbranch_scc1 L_exit
  s_load_dwordx16 s[48:63], s[0:1], 0
  s_getpc_b64 s[36:37]
  s_lshr_b32 s42, s2, 3
  s_mul_i32 s42, s42, 10
  v_min_u32 v253, 9, v0
  v_add_lshl_u32 v253, v253, s42, 7
  global_load_dword a239, v253, s[36:37]
  v_lshrrev_b32 v249, 6, v0
  v_and_b32 v14, 63, v0
  v_readfirstlane_b32 s3, v249
  s_bfe_u32 s42, s2, 0x20001
  s_lshr_b32 s43, s2, 5
  s_lshl3_add_u32 s41, s42, s43
  s_bfe_u32 s42, s2, 0x10000
  s_bfe_u32 s43, s2, 0x20003
  s_lshl2_add_u32 s40, s42, s43
  s_mov_b32 s39, 0
L_restart:
  v_and_b32 v250, 3, v14
  v_lshrrev_b32 v251, 4, v14
  v_lshlrev_b32 v251, 6, v251
  v_lshl_add_u32 v251, v250, 4, v251
  v_bfe_u32 v252, v14, 2, 2
  v_lshl_add_u32 v224, v252, 13, v251
  s_lshl_b32 s42, s3, 17
  v_add_u32 v224, s42, v224
  v_xor_b32 v248, 32, v224
  v_add_u32 v225, 0x7c00, v224
  v_add_u32 v226, 0xf800, v248
  v_add_u32 v227, 0x17400, v248
  s_lshl_b32 s75, s3, 12
  s_mov_b32 s67, 0
  s_lshl_b32 s42, s41, 8
  s_sub_u32 s10, 0x400000, s42
  s_mov_b32 s11, 0x20000
  s_add_u32 m0, s75, 0x16000
  s_waitcnt lgkmcnt(0)
  s_add_u32 s8, s54, s42
  s_addc_u32 s9, s55, 0
  buffer_load_dwordx4 v224, s[8:11], s67 offen lds
  buffer_load_dwordx4 v225, s[8:11], s67 offen offset:1024 lds
  buffer_load_dwordx4 v226, s[8:11], s67 offen offset:2048 lds
  buffer_load_dwordx4 v227, s[8:11], s67 offen offset:3072 lds
  s_mul_i32 s42, s40, 0x48000
  s_add_u32 s4, s48, s42
  s_addc_u32 s5, s49, 0
  s_mov_b32 s6, 0x48000
  s_mov_b32 s7, 0x20000
  v_bfe_u32 v249, v14, 2, 3
  v_lshlrev_b32 v249, 10, v249
  v_lshl_add_u32 v249, v250, 4, v249
  v_lshrrev_b32 v250, 5, v14
  v_lshl_add_u32 v249, v250, 6, v249
  s_lshl_b32 s42, s3, 16
  v_add_u32 v216, s42, v249
  v_add_u32 v245, 0x2000, v216
  v_xor_b32 v245, 32, v245
  s_lshl_b32 s68, s3, 13
  s_mov_b32 s66, 0
  v_add_u32 v217, 0xfffffc00, v245
  v_add_u32 v218, 0x3800, v216
  s_add_u32 m0, s68, 0xd000
  s_nop 0
  buffer_load_dwordx4 v216, s[4:7], s66 offen lds
  buffer_load_dwordx4 v217, s[4:7], s66 offen offset:1024 lds
  buffer_load_dwordx4 v218, s[4:7], s66 offen offset:2048 lds
  v_add_u32 v219, 0x3400, v245
  v_add_u32 v220, 0x8000, v216
  v_add_u32 v221, 0x7c00, v245
  v_add_u32 v222, 0xb800, v216
  v_add_u32 v223, 0xb400, v245
  s_add_u32 s42, s68, 0x40000
  v_add_u32 v246, s42, v249
  s_and_b32 s43, s3, 1
  s_lshl_b32 s43, s43, 5
  v_xor_b32 v246, s43, v246
  v_lshl_add_u32 v7, v252, 8, v251
  s_lshl_b32 s69, s3, 10
  v_add_u32 v7, s75, v7
  v_xor_b32 v8, 32, v7
  s_lshl1_add_u32 s42, s40, s41
  s_and_b32 s42, s42, 7
  s_max_u32 s42, s42, 1
  s_lshl_b32 s70, s42, 7
  s_lshl_b32 s42, s39, 8
  s_add_u32 s42, s42, s2
  s_cmp_ge_u32 s42, 8
  s_cbranch_scc1 L_nozero
  s_add_u32 s32, s62, 0x1900000
  s_addc_u32 s33, s63, 0
  s_mov_b32 s34, 0x10000
  s_mov_b32 s35, 0x20000
  v_min_u32 v254, 15, v14
  v_lshlrev_b32 v254, 7, v254
  v_mov_b32 v255, 0
  s_lshl_b32 s43, s2, 2
  s_add_u32 s43, s43, s3
  s_lshl_b32 s43, s43, 11
  buffer_store_dword v255, v254, s[32:35], s43 offen sc1
L_nozero:
  s_lshl_b32 s42, s40, 5
  s_add_u32 s42, s42, s41
  s_lshl_b32 s42, s42, 18
  s_mul_i32 s98, s2, 0
  s_lshr_b32 s43, s2, 4
  s_mul_i32 s43, s43, 0
  s_add_u32 s98, s98, s43
  s_and_b32 s98, s98, 15
  s_lshl_b32 s98, s98, 14
  s_add_u32 s12, s50, s42
  s_addc_u32 s13, s51, 0
  s_mov_b32 s14, 0x40000
  s_mov_b32 s15, 0x20000
  s_add_u32 s16, s52, s42
  s_addc_u32 s17, s53, 0
  s_mov_b32 s18, 0x40000
  s_mov_b32 s19, 0x20000
  s_mul_i32 s42, s40, 0x240000
  s_lshl_b32 s43, s41, 12
  s_add_u32 s42, s42, s43
  s_sub_u32 s43, 0x1200000, s42
  s_add_u32 s42, s42, 0
  s_add_u32 s20, s62, s42
  s_addc_u32 s21, s63, 0
  s_mov_b32 s22, s43
  s_mov_b32 s23, 0x20000
  s_mov_b32 s64, 0x3e0293ee
  s_mov_b32 s65, 0x3e0293ee
  s_mov_b32 s76, 0
  s_mov_b32 s77, -1
  v_lshrrev_b32 v249, 4, v14
  v_bfe_u32 v250, v14, 3, 1
  v_lshlrev_b32 v251, 1, v250
  v_xor_b32 v251, v251, v249
  v_lshlrev_b32 v251, 4, v251
  v_lshl_add_u32 v252, v250, 10, v251
  v_and_b32 v253, 7, v14
  v_lshl_add_u32 v252, v253, 6, v252
  s_lshl_b32 s42, s3, 13
  s_add_u32 s42, s42, 0xd000
  v_add_u32 v240, s42, v252
  s_and_b32 s42, s3, 1
  s_lshl_b32 s42, s42, 11
  s_add_u32 s42, s42, 0x15000
  v_add_u32 v241, s42, v252
  v_bfe_u32 v252, v14, 2, 2
  v_lshl_add_u32 v252, v252, 10, v251
  v_and_b32 v253, 3, v14
  v_lshl_add_u32 v252, v253, 6, v252
  s_lshr_b32 s42, s3, 1
  s_lshl_b32 s44, s42, 9
  s_lshl_b32 s42, s42, 13
  v_add3_u32 v1, s42, v252, 0
  v_add_u32 v1, s44, v1
  v_xor_b32 v2, 0x2000, v1
  v_bfe_u32 v252, v14, 2, 2
  v_lshlrev_b32 v252, 6, v252
  v_lshl_add_u32 v252, v253, 3, v252
  v_lshl_add_u32 v251, v249, 10, v252
  v_and_b32 v250, 1, v249
  v_lshl_add_u32 v251, v250, 5, v251
  s_add_u32 s42, s42, 0x10000
  v_add_u32 v3, s42, v251
  v_xor_b32 v4, 32, v3
  v_xor_b32 v5, 0x2000, v3
  v_xor_b32 v6, 32, v5
  v_bfe_u32 v252, v14, 2, 2
  v_lshlrev_b32 v252, 6, v252
  v_lshl_add_u32 v252, v249, 11, v252
  v_lshlrev_b32 v250, 1, v250
  v_xor_b32 v250, v250, v253
  v_lshl_add_u32 v252, v250, 4, v252
  v_lshrrev_b32 v253, 2, v253
  v_lshl_add_u32 v252, v253, 3, v252
  v_add_u32 v252, 0x16000, v252
  v_add_u32 v242, s44, v252
  v_xor_b32 v243, 8, v242
  v_subrev_u32 v9, s44, v252
  v_xor_b32 v10, 8, v9
  v_lshlrev_b32 v0, 7, v14
  v_mov_b32 v255, 0
  v_mov_b32 v254, 0
  v_mov_b32 v249, 0x3f803f80
  v_accvgpr_write_b32 a240, v249
  v_accvgpr_write_b32 a241, v249
  v_accvgpr_write_b32 a242, v249
  v_accvgpr_write_b32 a243, v249
  v_accvgpr_write_b32 a244, 0
  v_accvgpr_write_b32 a245, 0
  v_accvgpr_write_b32 a246, 0
  v_accvgpr_write_b32 a247, 0
  v_accvgpr_write_b32 a248, 0
  v_accvgpr_write_b32 a249, 0
  v_accvgpr_write_b32 a250, 0
  v_accvgpr_write_b32 a251, 0
  v_accvgpr_write_b32 a0, 0
  v_accvgpr_write_b32 a1, 0
  v_accvgpr_write_b32 a2, 0
  v_accvgpr_write_b32 a3, 0
  v_accvgpr_write_b32 a4, 0
  v_accvgpr_write_b32 a5, 0
  v_accvgpr_write_b32 a6, 0
  v_accvgpr_write_b32 a7, 0
  v_accvgpr_write_b32 a8, 0
  v_accvgpr_write_b32 a9, 0
  v_accvgpr_write_b32 a10, 0
  v_accvgpr_write_b32 a11, 0
  v_accvgpr_write_b32 a12, 0
  v_accvgpr_write_b32 a13, 0
  v_accvgpr_write_b32 a14, 0
  v_accvgpr_write_b32 a15, 0
  v_accvgpr_write_b32 a16, 0
  v_accvgpr_write_b32 a17, 0
  v_accvgpr_write_b32 a18, 0
  v_accvgpr_write_b32 a19, 0
  v_accvgpr_write_b32 a20, 0
  v_accvgpr_write_b32 a21, 0
  v_accvgpr_write_b32 a22, 0
  v_accvgpr_write_b32 a23, 0
  v_accvgpr_write_b32 a24, 0
  v_accvgpr_write_b32 a25, 0
  v_accvgpr_write_b32 a26, 0
  v_accvgpr_write_b32 a27, 0
  v_accvgpr_write_b32 a28, 0
  v_accvgpr_write_b32 a29, 0
  v_accvgpr_write_b32 a30, 0
  v_accvgpr_write_b32 a31, 0
  v_accvgpr_write_b32 a32, 0
  v_accvgpr_write_b32 a33, 0
  v_accvgpr_write_b32 a34, 0
  v_accvgpr_write_b32 a35, 0
  v_accvgpr_write_b32 a36, 0
  v_accvgpr_write_b32 a37, 0
  v_accvgpr_write_b32 a38, 0
  v_accvgpr_write_b32 a39, 0
  v_accvgpr_write_b32 a40, 0
  v_accvgpr_write_b32 a41, 0
  v_accvgpr_write_b32 a42, 0
  v_accvgpr_write_b32 a43, 0
  v_accvgpr_write_b32 a44, 0
  v_accvgpr_write_b32 a45, 0
  v_accvgpr_write_b32 a46, 0
  v_accvgpr_write_b32 a47, 0
  v_accvgpr_write_b32 a48, 0
  v_accvgpr_write_b32 a49, 0
  v_accvgpr_write_b32 a50, 0
  v_accvgpr_write_b32 a51, 0
  v_accvgpr_write_b32 a52, 0
  v_accvgpr_write_b32 a53, 0
  v_accvgpr_write_b32 a54, 0
  v_accvgpr_write_b32 a55, 0
  v_accvgpr_write_b32 a56, 0
  v_accvgpr_write_b32 a57, 0
  v_accvgpr_write_b32 a58, 0
  v_accvgpr_write_b32 a59, 0
  buffer_load_dwordx4 v219, s[4:7], s66 offen offset:3072 lds
  s_add_u32 m0, s68, 0xe000
  s_nop 0
  buffer_load_dwordx4 v220, s[4:7], s66 offen lds
  buffer_load_dwordx4 v221, s[4:7], s66 offen offset:1024 lds
  buffer_load_dwordx4 v222, s[4:7], s66 offen offset:2048 lds
  buffer_load_dwordx4 v223, s[4:7], s66 offen offset:3072 lds
  s_add_u32 m0, s69, 0x15000
  s_nop 0
  buffer_load_dwordx4 v246, s[4:7], s66 offen lds
  v_accvgpr_write_b32 a60, 0
  v_accvgpr_write_b32 a61, 0
  v_accvgpr_write_b32 a62, 0
  v_accvgpr_write_b32 a63, 0
  v_accvgpr_write_b32 a64, 0
  v_accvgpr_write_b32 a65, 0
  v_accvgpr_write_b32 a66, 0
  v_accvgpr_write_b32 a67, 0
  v_accvgpr_write_b32 a68, 0
  v_accvgpr_write_b32 a69, 0
  v_accvgpr_write_b32 a70, 0
  v_accvgpr_write_b32 a71, 0
  v_accvgpr_write_b32 a72, 0
  v_accvgpr_write_b32 a73, 0
  v_accvgpr_write_b32 a74, 0
  v_accvgpr_write_b32 a75, 0
  v_accvgpr_write_b32 a76, 0
  v_accvgpr_write_b32 a77, 0
  v_accvgpr_write_b32 a78, 0
  v_accvgpr_write_b32 a79, 0
  v_accvgpr_write_b32 a80, 0
  v_accvgpr_write_b32 a81, 0
  v_accvgpr_write_b32 a82, 0
  v_accvgpr_write_b32 a83, 0
  v_accvgpr_write_b32 a84, 0
  v_accvgpr_write_b32 a85, 0
  v_accvgpr_write_b32 a86, 0
  v_accvgpr_write_b32 a87, 0
  v_accvgpr_write_b32 a88, 0
  v_accvgpr_write_b32 a89, 0
  v_accvgpr_write_b32 a90, 0
  v_accvgpr_write_b32 a91, 0
  v_accvgpr_write_b32 a92, 0
  v_accvgpr_write_b32 a93, 0
  v_accvgpr_write_b32 a94, 0
  v_accvgpr_write_b32 a95, 0
  v_accvgpr_write_b32 a96, 0
  v_accvgpr_write_b32 a97, 0
  v_accvgpr_write_b32 a98, 0
  v_accvgpr_write_b32 a99, 0
  v_accvgpr_write_b32 a100, 0
  v_accvgpr_write_b32 a101, 0
  v_accvgpr_write_b32 a102, 0
  v_accvgpr_write_b32 a103, 0
  v_accvgpr_write_b32 a104, 0
  v_accvgpr_write_b32 a105, 0
  v_accvgpr_write_b32 a106, 0
  v_accvgpr_write_b32 a107, 0
  v_accvgpr_write_b32 a108, 0
  v_accvgpr_write_b32 a109, 0
  v_accvgpr_write_b32 a110, 0
  v_accvgpr_write_b32 a111, 0
  v_accvgpr_write_b32 a112, 0
  v_accvgpr_write_b32 a113, 0
  v_accvgpr_write_b32 a114, 0
  v_accvgpr_write_b32 a115, 0
  v_accvgpr_write_b32 a116, 0
  v_accvgpr_write_b32 a117, 0
  v_accvgpr_write_b32 a118, 0
  v_accvgpr_write_b32 a119, 0
  v_accvgpr_write_b32 a120, 0
  v_accvgpr_write_b32 a121, 0
  v_accvgpr_write_b32 a122, 0
  v_accvgpr_write_b32 a123, 0
  v_accvgpr_write_b32 a124, 0
  v_accvgpr_write_b32 a125, 0
  v_accvgpr_write_b32 a126, 0
  v_accvgpr_write_b32 a127, 0
  v_accvgpr_write_b32 a128, 0
  v_accvgpr_write_b32 a129, 0
  v_accvgpr_write_b32 a130, 0
  v_accvgpr_write_b32 a131, 0
  v_accvgpr_write_b32 a132, 0
  v_accvgpr_write_b32 a133, 0
  v_accvgpr_write_b32 a134, 0
  v_accvgpr_write_b32 a135, 0
  v_accvgpr_write_b32 a136, 0
  v_accvgpr_write_b32 a137, 0
  v_accvgpr_write_b32 a138, 0
  v_accvgpr_write_b32 a139, 0
  v_accvgpr_write_b32 a140, 0
  v_accvgpr_write_b32 a141, 0
  v_accvgpr_write_b32 a142, 0
  v_accvgpr_write_b32 a143, 0
  v_accvgpr_write_b32 a144, 0
  v_accvgpr_write_b32 a145, 0
  v_accvgpr_write_b32 a146, 0
  v_accvgpr_write_b32 a147, 0
  v_accvgpr_write_b32 a148, 0
  v_accvgpr_write_b32 a149, 0
  v_accvgpr_write_b32 a150, 0
  v_accvgpr_write_b32 a151, 0
  v_accvgpr_write_b32 a152, 0
  v_accvgpr_write_b32 a153, 0
  v_accvgpr_write_b32 a154, 0
  v_accvgpr_write_b32 a155, 0
  v_accvgpr_write_b32 a156, 0
  v_accvgpr_write_b32 a157, 0
  v_accvgpr_write_b32 a158, 0
  v_accvgpr_write_b32 a159, 0
  s_mov_b32 s66, s70
  s_lshl_b32 s67, s66, 12
  s_add_u32 m0, s75, 0x23000
  s_nop 0
  buffer_load_dwordx4 v224, s[8:11], s67 offen lds
  buffer_load_dwordx4 v225, s[8:11], s67 offen offset:1024 lds
  buffer_load_dwordx4 v226, s[8:11], s67 offen offset:2048 lds
  buffer_load_dwordx4 v227, s[8:11], s67 offen offset:3072 lds
  s_add_u32 m0, s68, 0x1a000
  s_nop 0
  buffer_load_dwordx4 v216, s[4:7], s66 offen lds
  buffer_load_dwordx4 v217, s[4:7], s66 offen offset:1024 lds
  s_waitcnt vmcnt(6)
  s_barrier
  s_add_u32 s42, s39, s3
  s_lshl_b32 s42, s42, 8
  s_add_u32 s42, s42, s2
  s_cmp_ge_u32 s42, 8
  s_cbranch_scc1 L_nozero2
  s_lshl_b32 s43, s2, 2
  s_add_u32 s32, s60, s43
  s_addc_u32 s33, s61, 0
  s_mov_b32 s34, 4
  s_mov_b32 s35, 0x20000
  v_lshlrev_b32 v254, 2, v14
  v_mov_b32 v255, 1
  buffer_store_dword v255, v254, s[32:35], 0 offen sc1
L_nozero2:
  ds_read_b64_tr_b16 a[192:193], v242
  ds_read_b64_tr_b16 a[194:195], v242 offset:1024
  ds_read_b64_tr_b16 a[196:197], v242 offset:8192
  ds_read_b64_tr_b16 a[198:199], v242 offset:9216
  ds_read_b128 a[160:163], v240
  ds_read_b128 a[164:167], v240 offset:512
  ds_read_b128 a[168:171], v240 offset:2048
  ds_read_b128 a[172:175], v240 offset:2560
  ds_read_b128 a[176:179], v240 offset:4096
  ds_read_b128 a[180:183], v240 offset:4608
  ds_read_b128 a[184:187], v240 offset:6144
  ds_read_b128 a[188:191], v240 offset:6656
  ds_read_b128 v[232:235], v241
  ds_read_b128 v[236:239], v241 offset:512
  s_waitcnt lgkmcnt(8)
  v_mfma_f32_16x16x32_bf16 v[16:19], a[192:195], a[160:163], 0
  buffer_load_dwordx4 v218, s[4:7], s66 offen offset:2048 lds
  v_mfma_f32_16x16x32_bf16 v[16:19], a[196:199], a[164:167], v[16:19]
  buffer_load_dwordx4 v219, s[4:7], s66 offen offset:3072 lds
  s_waitcnt lgkmcnt(6)
  s_add_u32 m0, s68, 0x1b000
  v_mfma_f32_16x16x32_bf16 v[48:51], a[192:195], a[168:171], 0
  buffer_load_dwordx4 v220, s[4:7], s66 offen lds
  v_mfma_f32_16x16x32_bf16 v[48:51], a[196:199], a[172:175], v[48:51]
  buffer_load_dwordx4 v221, s[4:7], s66 offen offset:1024 lds
  s_waitcnt lgkmcnt(4)
  v_mfma_f32_16x16x32_bf16 v[80:83], a[192:195], a[176:179], 0
  ds_read_b64_tr_b16 a[200:201], v243
  ds_read_b64_tr_b16 a[202:203], v243 offset:1024
  ds_read_b64_tr_b16 a[204:205], v243 offset:8192
  ds_read_b64_tr_b16 a[206:207], v243 offset:9216
  buffer_load_dwordx4 v222, s[4:7], s66 offen offset:2048 lds
  v_mfma_f32_16x16x32_bf16 v[80:83], a[196:199], a[180:183], v[80:83]
  buffer_load_dwordx4 v223, s[4:7], s66 offen offset:3072 lds
  s_waitcnt lgkmcnt(6)
  s_add_u32 m0, s69, 0x22000
  v_mfma_f32_16x16x32_bf16 v[112:115], a[192:195], a[184:187], 0
  buffer_load_dwordx4 v246, s[4:7], s66 offen lds
  v_mfma_f32_16x16x32_bf16 v[112:115], a[196:199], a[188:191], v[112:115]
  s_waitcnt lgkmcnt(4)
  s_add_u32 s66, s66, 0x80
  s_cmp_eq_u32 s66, 0x400
  s_cselect_b32 s66, 0x80, s66
  s_lshl_b32 s67, s66, 12
  s_add_u32 m0, s75, 0x9000
  v_mfma_f32_16x16x32_bf16 v[144:147], a[192:195], v[232:235], 0
  buffer_load_dwordx4 v224, s[8:11], s67 offen lds
  v_mfma_f32_16x16x32_bf16 v[144:147], a[196:199], v[236:239], v[144:147]
  ds_read_b64_tr_b16 a[208:209], v242 offset:256
  s_waitcnt lgkmcnt(1)
  v_mfma_f32_16x16x32_bf16 v[20:23], a[200:203], a[160:163], 0
  ds_read_b64_tr_b16 a[210:211], v242 offset:1280
  v_add_u32 v240, 0xd000, v240
  v_mfma_f32_16x16x32_bf16 v[20:23], a[204:207], a[164:167], v[20:23]
  buffer_load_dwordx4 v225, s[8:11], s67 offen offset:1024 lds
  v_mfma_f32_16x16x32_bf16 v[52:55], a[200:203], a[168:171], 0
  ds_read_b64_tr_b16 a[212:213], v242 offset:8448
  v_add_u32 v241, 0xd000, v241
  v_mfma_f32_16x16x32_bf16 v[52:55], a[204:207], a[172:175], v[52:55]
  ds_read_b64_tr_b16 a[214:215], v242 offset:9472
  v_mfma_f32_16x16x32_bf16 v[84:87], a[200:203], a[176:179], 0
  buffer_load_dwordx4 v226, s[8:11], s67 offen offset:2048 lds
  v_mfma_f32_16x16x32_bf16 v[84:87], a[204:207], a[180:183], v[84:87]
  ds_read_b64_tr_b16 a[216:217], v243 offset:256
  v_mfma_f32_16x16x32_bf16 v[116:119], a[200:203], a[184:187], 0
  ds_read_b64_tr_b16 a[218:219], v243 offset:1280
  ds_read_b64_tr_b16 a[220:221], v243 offset:8448
  v_mfma_f32_16x16x32_bf16 v[116:119], a[204:207], a[188:191], v[116:119]
  buffer_load_dwordx4 v227, s[8:11], s67 offen offset:3072 lds
  v_mfma_f32_16x16x32_bf16 v[148:151], a[200:203], v[232:235], 0
  ds_read_b64_tr_b16 a[222:223], v243 offset:9472
  s_add_u32 m0, s68, 0
  v_mfma_f32_16x16x32_bf16 v[148:151], a[204:207], v[236:239], v[148:151]
  ds_read_b64_tr_b16 a[192:193], v9 offset:512
  s_waitcnt lgkmcnt(5)
  v_mfma_f32_16x16x32_bf16 v[24:27], a[208:211], a[160:163], 0
  buffer_load_dwordx4 v216, s[4:7], s66 offen lds
  v_mfma_f32_16x16x32_bf16 v[24:27], a[212:215], a[164:167], v[24:27]
  ds_read_b64_tr_b16 a[194:195], v9 offset:1536
  v_mfma_f32_16x16x32_bf16 v[56:59], a[208:211], a[168:171], 0
  ds_read_b64_tr_b16 a[196:197], v9 offset:8704
  ds_read_b64_tr_b16 a[198:199], v9 offset:9728
  v_mfma_f32_16x16x32_bf16 v[56:59], a[212:215], a[172:175], v[56:59]
  buffer_load_dwordx4 v217, s[4:7], s66 offen offset:1024 lds
  v_mfma_f32_16x16x32_bf16 v[88:91], a[208:211], a[176:179], 0
  ds_read_b64_tr_b16 a[200:201], v10 offset:512
  v_mfma_f32_16x16x32_bf16 v[88:91], a[212:215], a[180:183], v[88:91]
  ds_read_b64_tr_b16 a[202:203], v10 offset:1536
  ds_read_b64_tr_b16 a[204:205], v10 offset:8704
  v_mfma_f32_16x16x32_bf16 v[120:123], a[208:211], a[184:187], 0
  buffer_load_dwordx4 v218, s[4:7], s66 offen offset:2048 lds
  v_mfma_f32_16x16x32_bf16 v[120:123], a[212:215], a[188:191], v[120:123]
  ds_read_b64_tr_b16 a[206:207], v10 offset:9728
  v_mfma_f32_16x16x32_bf16 v[152:155], a[208:211], v[232:235], 0
  s_waitcnt lgkmcnt(8)
  v_mfma_f32_16x16x32_bf16 v[152:155], a[212:215], v[236:239], v[152:155]
  buffer_load_dwordx4 v219, s[4:7], s66 offen offset:3072 lds
  v_mfma_f32_16x16x32_bf16 v[28:31], a[216:219], a[160:163], 0
  ds_read_b64_tr_b16 a[208:209], v9 offset:768
  s_add_u32 m0, s68, 0x1000
  v_mfma_f32_16x16x32_bf16 v[28:31], a[220:223], a[164:167], v[28:31]
  ds_read_b64_tr_b16 a[210:211], v9 offset:1792
  v_mfma_f32_16x16x32_bf16 v[60:63], a[216:219], a[168:171], 0
  buffer_load_dwordx4 v220, s[4:7], s66 offen lds
  v_mfma_f32_16x16x32_bf16 v[60:63], a[220:223], a[172:175], v[60:63]
  ds_read_b64_tr_b16 a[212:213], v9 offset:8960
  v_mfma_f32_16x16x32_bf16 v[92:95], a[216:219], a[176:179], 0
  ds_read_b64_tr_b16 a[214:215], v9 offset:9984
  v_mfma_f32_16x16x32_bf16 v[92:95], a[220:223], a[180:183], v[92:95]
  buffer_load_dwordx4 v221, s[4:7], s66 offen offset:1024 lds
  v_mfma_f32_16x16x32_bf16 v[124:127], a[216:219], a[184:187], 0
  v_mfma_f32_16x16x32_bf16 v[124:127], a[220:223], a[188:191], v[124:127]
  v_mfma_f32_16x16x32_bf16 v[156:159], a[216:219], v[232:235], 0
  buffer_load_dwordx4 v222, s[4:7], s66 offen offset:2048 lds
  v_mfma_f32_16x16x32_bf16 v[156:159], a[220:223], v[236:239], v[156:159]
  ds_read_b64_tr_b16 a[216:217], v10 offset:768
  s_waitcnt lgkmcnt(9)
  v_mfma_f32_16x16x32_bf16 v[32:35], a[192:195], a[160:163], 0
  ds_read_b64_tr_b16 a[218:219], v10 offset:1792
  v_mfma_f32_16x16x32_bf16 v[32:35], a[196:199], a[164:167], v[32:35]
  buffer_load_dwordx4 v223, s[4:7], s66 offen offset:3072 lds
  v_mfma_f32_16x16x32_bf16 v[64:67], a[192:195], a[168:171], 0
  ds_read_b64_tr_b16 a[220:221], v10 offset:8960
  s_add_u32 m0, s69, 0x8000
  v_mfma_f32_16x16x32_bf16 v[64:67], a[196:199], a[172:175], v[64:67]
  ds_read_b64_tr_b16 a[222:223], v10 offset:9984
  v_mfma_f32_16x16x32_bf16 v[96:99], a[192:195], a[176:179], 0
  buffer_load_dwordx4 v246, s[4:7], s66 offen lds
  v_mfma_f32_16x16x32_bf16 v[96:99], a[196:199], a[180:183], v[96:99]
  v_add_u32 v242, 0xd000, v242
  v_add_u32 v243, 0xd000, v243
  v_mfma_f32_16x16x32_bf16 v[128:131], a[192:195], a[184:187], 0
  s_waitcnt lgkmcnt(8)
  v_add_u32 v9, 0xd000, v9
  v_add_u32 v10, 0xd000, v10
  v_mfma_f32_16x16x32_bf16 v[128:131], a[196:199], a[188:191], v[128:131]
  v_mfma_f32_16x16x32_bf16 v[36:39], a[200:203], a[160:163], 0
  v_mfma_f32_16x16x32_bf16 v[36:39], a[204:207], a[164:167], v[36:39]
  s_waitcnt vmcnt(13) lgkmcnt(0)
  v_mfma_f32_16x16x32_bf16 v[68:71], a[200:203], a[168:171], 0
  s_barrier
  v_mfma_f32_16x16x32_bf16 v[68:71], a[204:207], a[172:175], v[68:71]
  ds_read_b64_tr_b16 a[192:193], v242
  ds_read_b64_tr_b16 a[194:195], v242 offset:1024
  v_mfma_f32_16x16x32_bf16 v[100:103], a[200:203], a[176:179], 0
  ds_read_b64_tr_b16 a[196:197], v242 offset:8192
  v_mfma_f32_16x16x32_bf16 v[100:103], a[204:207], a[180:183], v[100:103]
  ds_read_b64_tr_b16 a[198:199], v242 offset:9216
  ds_read_b128 v[176:179], v240
  v_mfma_f32_16x16x32_bf16 v[132:135], a[200:203], a[184:187], 0
  ds_read_b128 v[180:183], v240 offset:512
  s_waitcnt lgkmcnt(15)
  v_mfma_f32_16x16x32_bf16 v[132:135], a[204:207], a[188:191], v[132:135]
  ds_read_b128 v[184:187], v240 offset:2048
  v_mfma_f32_16x16x32_bf16 v[40:43], a[208:211], a[160:163], 0
  ds_read_b128 v[188:191], v240 offset:2560
  ds_read_b128 v[192:195], v240 offset:4096
  v_mfma_f32_16x16x32_bf16 v[40:43], a[212:215], a[164:167], v[40:43]
  ds_read_b128 v[196:199], v240 offset:4608
  s_add_u32 s66, s66, 0x80
  v_mfma_f32_16x16x32_bf16 v[72:75], a[208:211], a[168:171], 0
  ds_read_b128 v[200:203], v240 offset:6144
  s_cmp_eq_u32 s66, 0x400
  s_cselect_b32 s66, 0x80, s66
  v_mfma_f32_16x16x32_bf16 v[72:75], a[212:215], a[172:175], v[72:75]
  ds_read_b128 v[204:207], v240 offset:6656
  s_lshl_b32 s67, s66, 12
  v_mfma_f32_16x16x32_bf16 v[104:107], a[208:211], a[176:179], 0
  ds_read_b128 v[208:211], v241
  s_add_u32 m0, s75, 0x16000
  v_mfma_f32_16x16x32_bf16 v[104:107], a[212:215], a[180:183], v[104:107]
  ds_read_b128 v[212:215], v241 offset:512
  v_mfma_f32_16x16x32_bf16 v[136:139], a[208:211], a[184:187], 0
  buffer_load_dwordx4 v224, s[8:11], s67 offen lds
  v_mfma_f32_16x16x32_bf16 v[136:139], a[212:215], a[188:191], v[136:139]
  s_waitcnt lgkmcnt(15)
  v_mfma_f32_16x16x32_bf16 v[44:47], a[216:219], a[160:163], 0
  buffer_load_dwordx4 v225, s[8:11], s67 offen offset:1024 lds
  v_mfma_f32_16x16x32_bf16 v[44:47], a[220:223], a[164:167], v[44:47]
  v_mfma_f32_16x16x32_bf16 v[76:79], a[216:219], a[168:171], 0
  buffer_load_dwordx4 v226, s[8:11], s67 offen offset:2048 lds
  v_mfma_f32_16x16x32_bf16 v[76:79], a[220:223], a[172:175], v[76:79]
  v_mfma_f32_16x16x32_bf16 v[108:111], a[216:219], a[176:179], 0
  buffer_load_dwordx4 v227, s[8:11], s67 offen offset:3072 lds
  v_mfma_f32_16x16x32_bf16 v[108:111], a[220:223], a[180:183], v[108:111]
  v_mfma_f32_16x16x32_bf16 v[140:143], a[216:219], a[184:187], 0
  v_mfma_f32_16x16x32_bf16 v[140:143], a[220:223], a[188:191], v[140:143]
  s_waitcnt lgkmcnt(0)
  v_mfma_f32_16x16x32_bf16 v[16:19], a[192:195], v[176:179], v[16:19]
  ds_read_b64_tr_b16 a[200:201], v243
  s_add_u32 m0, s68, 0xd000
  v_mfma_f32_16x16x32_bf16 v[16:19], a[196:199], v[180:183], v[16:19]
  ds_read_b64_tr_b16 a[202:203], v243 offset:1024
  v_add_u32 v240, 0xfffe6000, v240
  v_mfma_f32_16x16x32_bf16 v[48:51], a[192:195], v[184:187], v[48:51]
  ds_read_b64_tr_b16 a[204:205], v243 offset:8192
  v_add_u32 v241, 0xfffe6000, v241
  v_mfma_f32_16x16x32_bf16 v[48:51], a[196:199], v[188:191], v[48:51]
  ds_read_b64_tr_b16 a[206:207], v243 offset:9216
  v_mfma_f32_16x16x32_bf16 v[80:83], a[192:195], v[192:195], v[80:83]
  ds_read_b64_tr_b16 a[208:209], v242 offset:256
  ds_read_b64_tr_b16 a[210:211], v242 offset:1280
  v_mfma_f32_16x16x32_bf16 v[80:83], a[196:199], v[196:199], v[80:83]
  ds_read_b64_tr_b16 a[212:213], v242 offset:8448
  v_mfma_f32_16x16x32_bf16 v[112:115], a[192:195], v[200:203], v[112:115]
  ds_read_b64_tr_b16 a[214:215], v242 offset:9472
  ds_read_b64_tr_b16 a[216:217], v243 offset:256
  v_mfma_f32_16x16x32_bf16 v[112:115], a[196:199], v[204:207], v[112:115]
  ds_read_b64_tr_b16 a[218:219], v243 offset:1280
  v_mfma_f32_16x16x32_bf16 v[144:147], a[192:195], v[208:211], v[144:147]
  ds_read_b64_tr_b16 a[220:221], v243 offset:8448
  s_waitcnt lgkmcnt(7)
  v_mfma_f32_16x16x32_bf16 v[144:147], a[196:199], v[212:215], v[144:147]
  ds_read_b64_tr_b16 a[222:223], v243 offset:9472
  ds_read_b64_tr_b16 a[192:193], v9 offset:512
  v_mfma_f32_16x16x32_bf16 v[20:23], a[200:203], v[176:179], v[20:23]
  ds_read_b64_tr_b16 a[194:195], v9 offset:1536
  v_mfma_f32_16x16x32_bf16 v[20:23], a[204:207], v[180:183], v[20:23]
  ds_read_b64_tr_b16 a[196:197], v9 offset:8704
  ds_read_b64_tr_b16 a[198:199], v9 offset:9728
  v_mfma_f32_16x16x32_bf16 v[52:55], a[200:203], v[184:187], v[52:55]
  v_mfma_f32_16x16x32_bf16 v[52:55], a[204:207], v[188:191], v[52:55]
  buffer_load_dwordx4 v216, s[4:7], s66 offen lds
  v_mfma_f32_16x16x32_bf16 v[84:87], a[200:203], v[192:195], v[84:87]
  v_mfma_f32_16x16x32_bf16 v[84:87], a[204:207], v[196:199], v[84:87]
  buffer_load_dwordx4 v217, s[4:7], s66 offen offset:1024 lds
  v_mfma_f32_16x16x32_bf16 v[116:119], a[200:203], v[200:203], v[116:119]
  v_mfma_f32_16x16x32_bf16 v[116:119], a[204:207], v[204:207], v[116:119]
  buffer_load_dwordx4 v218, s[4:7], s66 offen offset:2048 lds
  v_mfma_f32_16x16x32_bf16 v[148:151], a[200:203], v[208:211], v[148:151]
  s_waitcnt lgkmcnt(8)
  v_mfma_f32_16x16x32_bf16 v[148:151], a[204:207], v[212:215], v[148:151]
  ds_read_b64_tr_b16 a[200:201], v10 offset:512
  ds_read_b64_tr_b16 a[202:203], v10 offset:1536
  v_mfma_f32_16x16x32_bf16 v[24:27], a[208:211], v[176:179], v[24:27]
  ds_read_b64_tr_b16 a[204:205], v10 offset:8704
  v_mfma_f32_16x16x32_bf16 v[24:27], a[212:215], v[180:183], v[24:27]
  ds_read_b64_tr_b16 a[206:207], v10 offset:9728
  v_mfma_f32_16x16x32_bf16 v[56:59], a[208:211], v[184:187], v[56:59]
  buffer_load_dwordx4 v219, s[4:7], s66 offen offset:3072 lds
  v_mfma_f32_16x16x32_bf16 v[56:59], a[212:215], v[188:191], v[56:59]
  s_add_u32 m0, s68, 0xe000
  v_mfma_f32_16x16x32_bf16 v[88:91], a[208:211], v[192:195], v[88:91]
  buffer_load_dwordx4 v220, s[4:7], s66 offen lds
  v_mfma_f32_16x16x32_bf16 v[88:91], a[212:215], v[196:199], v[88:91]
  v_mfma_f32_16x16x32_bf16 v[120:123], a[208:211], v[200:203], v[120:123]
  v_mfma_f32_16x16x32_bf16 v[120:123], a[212:215], v[204:207], v[120:123]
  buffer_load_dwordx4 v221, s[4:7], s66 offen offset:1024 lds
  v_mfma_f32_16x16x32_bf16 v[152:155], a[208:211], v[208:211], v[152:155]
  s_waitcnt lgkmcnt(8)
  v_mfma_f32_16x16x32_bf16 v[152:155], a[212:215], v[212:215], v[152:155]
  ds_read_b64_tr_b16 a[208:209], v9 offset:768
  ds_read_b64_tr_b16 a[210:211], v9 offset:1792
  v_mfma_f32_16x16x32_bf16 v[28:31], a[216:219], v[176:179], v[28:31]
  ds_read_b64_tr_b16 a[212:213], v9 offset:8960
  v_mfma_f32_16x16x32_bf16 v[28:31], a[220:223], v[180:183], v[28:31]
  ds_read_b64_tr_b16 a[214:215], v9 offset:9984
  v_mfma_f32_16x16x32_bf16 v[60:63], a[216:219], v[184:187], v[60:63]
  buffer_load_dwordx4 v222, s[4:7], s66 offen offset:2048 lds
  v_mfma_f32_16x16x32_bf16 v[60:63], a[220:223], v[188:191], v[60:63]
  v_mfma_f32_16x16x32_bf16 v[92:95], a[216:219], v[192:195], v[92:95]
  v_mfma_f32_16x16x32_bf16 v[92:95], a[220:223], v[196:199], v[92:95]
  v_mfma_f32_16x16x32_bf16 v[124:127], a[216:219], v[200:203], v[124:127]
  v_mfma_f32_16x16x32_bf16 v[124:127], a[220:223], v[204:207], v[124:127]
  buffer_load_dwordx4 v223, s[4:7], s66 offen offset:3072 lds
  v_mfma_f32_16x16x32_bf16 v[156:159], a[216:219], v[208:211], v[156:159]
  s_waitcnt lgkmcnt(8)
  v_mfma_f32_16x16x32_bf16 v[156:159], a[220:223], v[212:215], v[156:159]
  ds_read_b64_tr_b16 a[216:217], v10 offset:768
  ds_read_b64_tr_b16 a[218:219], v10 offset:1792
  v_mfma_f32_16x16x32_bf16 v[32:35], a[192:195], v[176:179], v[32:35]
  ds_read_b64_tr_b16 a[220:221], v10 offset:8960
  s_add_u32 m0, s69, 0x15000
  v_mfma_f32_16x16x32_bf16 v[32:35], a[196:199], v[180:183], v[32:35]
  ds_read_b64_tr_b16 a[222:223], v10 offset:9984
  v_mfma_f32_16x16x32_bf16 v[64:67], a[192:195], v[184:187], v[64:67]
  buffer_load_dwordx4 v246, s[4:7], s66 offen lds
  v_mfma_f32_16x16x32_bf16 v[64:67], a[196:199], v[188:191], v[64:67]
  v_mfma_f32_16x16x32_bf16 v[96:99], a[192:195], v[192:195], v[96:99]
  v_mfma_f32_16x16x32_bf16 v[96:99], a[196:199], v[196:199], v[96:99]
  v_add_u32 v242, 0xfffe6000, v242
  v_add_u32 v243, 0xfffe6000, v243
  v_add_u32 v9, 0xfffe6000, v9
  v_mfma_f32_16x16x32_bf16 v[128:131], a[192:195], v[200:203], v[128:131]
  s_waitcnt lgkmcnt(8)
  v_add_u32 v10, 0xfffe6000, v10
  v_mfma_f32_16x16x32_bf16 v[128:131], a[196:199], v[204:207], v[128:131]
  v_mfma_f32_16x16x32_bf16 v[36:39], a[200:203], v[176:179], v[36:39]
  v_mfma_f32_16x16x32_bf16 v[36:39], a[204:207], v[180:183], v[36:39]
  s_waitcnt vmcnt(13) lgkmcnt(0)
  v_mfma_f32_16x16x32_bf16 v[68:71], a[200:203], v[184:187], v[68:71]
  s_barrier
  v_mfma_f32_16x16x32_bf16 v[68:71], a[204:207], v[188:191], v[68:71]
  ds_read_b64_tr_b16 a[192:193], v242
  ds_read_b64_tr_b16 a[194:195], v242 offset:1024
  v_mfma_f32_16x16x32_bf16 v[100:103], a[200:203], v[192:195], v[100:103]
  ds_read_b64_tr_b16 a[196:197], v242 offset:8192
  v_mfma_f32_16x16x32_bf16 v[100:103], a[204:207], v[196:199], v[100:103]
  ds_read_b64_tr_b16 a[198:199], v242 offset:9216
  ds_read_b128 a[160:163], v240
  v_mfma_f32_16x16x32_bf16 v[132:135], a[200:203], v[200:203], v[132:135]
  ds_read_b128 a[164:167], v240 offset:512
  s_waitcnt lgkmcnt(15)
  v_mfma_f32_16x16x32_bf16 v[132:135], a[204:207], v[204:207], v[132:135]
  ds_read_b128 a[168:171], v240 offset:2048
  v_mfma_f32_16x16x32_bf16 v[40:43], a[208:211], v[176:179], v[40:43]
  ds_read_b128 a[172:175], v240 offset:2560
  ds_read_b128 a[176:179], v240 offset:4096
  v_mfma_f32_16x16x32_bf16 v[40:43], a[212:215], v[180:183], v[40:43]
  ds_read_b128 a[180:183], v240 offset:4608
  s_add_u32 s66, s66, 0x80
  v_mfma_f32_16x16x32_bf16 v[72:75], a[208:211], v[184:187], v[72:75]
  ds_read_b128 a[184:187], v240 offset:6144
  s_cmp_eq_u32 s66, 0x400
  s_cselect_b32 s66, 0x80, s66
  v_mfma_f32_16x16x32_bf16 v[72:75], a[212:215], v[188:191], v[72:75]
  ds_read_b128 a[188:191], v240 offset:6656
  s_lshl_b32 s67, s66, 12
  v_mfma_f32_16x16x32_bf16 v[104:107], a[208:211], v[192:195], v[104:107]
  ds_read_b128 v[232:235], v241
  s_add_u32 m0, s75, 0x23000
  v_mfma_f32_16x16x32_bf16 v[104:107], a[212:215], v[196:199], v[104:107]
  ds_read_b128 v[236:239], v241 offset:512
  v_mfma_f32_16x16x32_bf16 v[136:139], a[208:211], v[200:203], v[136:139]
  buffer_load_dwordx4 v224, s[8:11], s67 offen lds
  v_mfma_f32_16x16x32_bf16 v[136:139], a[212:215], v[204:207], v[136:139]
  s_waitcnt lgkmcnt(15)
  v_mfma_f32_16x16x32_bf16 v[44:47], a[216:219], v[176:179], v[44:47]
  buffer_load_dwordx4 v225, s[8:11], s67 offen offset:1024 lds
  v_mfma_f32_16x16x32_bf16 v[44:47], a[220:223], v[180:183], v[44:47]
  v_mfma_f32_16x16x32_bf16 v[76:79], a[216:219], v[184:187], v[76:79]
  buffer_load_dwordx4 v226, s[8:11], s67 offen offset:2048 lds
  v_mfma_f32_16x16x32_bf16 v[76:79], a[220:223], v[188:191], v[76:79]
  v_mfma_f32_16x16x32_bf16 v[108:111], a[216:219], v[192:195], v[108:111]
  buffer_load_dwordx4 v227, s[8:11], s67 offen offset:3072 lds
  v_mfma_f32_16x16x32_bf16 v[108:111], a[220:223], v[196:199], v[108:111]
  v_mfma_f32_16x16x32_bf16 v[140:143], a[216:219], v[200:203], v[140:143]
  v_mfma_f32_16x16x32_bf16 v[140:143], a[220:223], v[204:207], v[140:143]
  s_waitcnt lgkmcnt(0)
  v_mfma_f32_16x16x32_bf16 v[16:19], a[192:195], a[160:163], v[16:19]
  ds_read_b64_tr_b16 a[200:201], v243
  s_add_u32 m0, s68, 0x1a000
  v_mfma_f32_16x16x32_bf16 v[16:19], a[196:199], a[164:167], v[16:19]
  ds_read_b64_tr_b16 a[202:203], v243 offset:1024
  v_add_u32 v240, 0xd000, v240
  v_mfma_f32_16x16x32_bf16 v[48:51], a[192:195], a[168:171], v[48:51]
  ds_read_b64_tr_b16 a[204:205], v243 offset:8192
  v_add_u32 v241, 0xd000, v241
  v_mfma_f32_16x16x32_bf16 v[48:51], a[196:199], a[172:175], v[48:51]
  ds_read_b64_tr_b16 a[206:207], v243 offset:9216
  v_mfma_f32_16x16x32_bf16 v[80:83], a[192:195], a[176:179], v[80:83]
  ds_read_b64_tr_b16 a[208:209], v242 offset:256
  ds_read_b64_tr_b16 a[210:211], v242 offset:1280
  v_mfma_f32_16x16x32_bf16 v[80:83], a[196:199], a[180:183], v[80:83]
  ds_read_b64_tr_b16 a[212:213], v242 offset:8448
  v_mfma_f32_16x16x32_bf16 v[112:115], a[192:195], a[184:187], v[112:115]
  ds_read_b64_tr_b16 a[214:215], v242 offset:9472
  ds_read_b64_tr_b16 a[216:217], v243 offset:256
  v_mfma_f32_16x16x32_bf16 v[112:115], a[196:199], a[188:191], v[112:115]
  ds_read_b64_tr_b16 a[218:219], v243 offset:1280
  v_mfma_f32_16x16x32_bf16 v[144:147], a[192:195], v[232:235], v[144:147]
  ds_read_b64_tr_b16 a[220:221], v243 offset:8448
  s_waitcnt lgkmcnt(7)
  v_mfma_f32_16x16x32_bf16 v[144:147], a[196:199], v[236:239], v[144:147]
  ds_read_b64_tr_b16 a[222:223], v243 offset:9472
  ds_read_b64_tr_b16 a[192:193], v9 offset:512
  v_mfma_f32_16x16x32_bf16 v[20:23], a[200:203], a[160:163], v[20:23]
  ds_read_b64_tr_b16 a[194:195], v9 offset:1536
  v_mfma_f32_16x16x32_bf16 v[20:23], a[204:207], a[164:167], v[20:23]
  ds_read_b64_tr_b16 a[196:197], v9 offset:8704
  ds_read_b64_tr_b16 a[198:199], v9 offset:9728
  v_mfma_f32_16x16x32_bf16 v[52:55], a[200:203], a[168:171], v[52:55]
  v_mfma_f32_16x16x32_bf16 v[52:55], a[204:207], a[172:175], v[52:55]
  buffer_load_dwordx4 v216, s[4:7], s66 offen lds
  v_mfma_f32_16x16x32_bf16 v[84:87], a[200:203], a[176:179], v[84:87]
  v_mfma_f32_16x16x32_bf16 v[84:87], a[204:207], a[180:183], v[84:87]
  buffer_load_dwordx4 v217, s[4:7], s66 offen offset:1024 lds
  v_mfma_f32_16x16x32_bf16 v[116:119], a[200:203], a[184:187], v[116:119]
  v_mfma_f32_16x16x32_bf16 v[116:119], a[204:207], a[188:191], v[116:119]
  buffer_load_dwordx4 v218, s[4:7], s66 offen offset:2048 lds
  v_mfma_f32_16x16x32_bf16 v[148:151], a[200:203], v[232:235], v[148:151]
  s_waitcnt lgkmcnt(8)
  v_mfma_f32_16x16x32_bf16 v[148:151], a[204:207], v[236:239], v[148:151]
  ds_read_b64_tr_b16 a[200:201], v10 offset:512
  ds_read_b64_tr_b16 a[202:203], v10 offset:1536
  v_mfma_f32_16x16x32_bf16 v[24:27], a[208:211], a[160:163], v[24:27]
  ds_read_b64_tr_b16 a[204:205], v10 offset:8704
  v_mfma_f32_16x16x32_bf16 v[24:27], a[212:215], a[164:167], v[24:27]
  ds_read_b64_tr_b16 a[206:207], v10 offset:9728
  v_mfma_f32_16x16x32_bf16 v[56:59], a[208:211], a[168:171], v[56:59]
  buffer_load_dwordx4 v219, s[4:7], s66 offen offset:3072 lds
  v_mfma_f32_16x16x32_bf16 v[56:59], a[212:215], a[172:175], v[56:59]
  s_add_u32 m0, s68, 0x1b000
  v_mfma_f32_16x16x32_bf16 v[88:91], a[208:211], a[176:179], v[88:91]
  buffer_load_dwordx4 v220, s[4:7], s66 offen lds
  v_mfma_f32_16x16x32_bf16 v[88:91], a[212:215], a[180:183], v[88:91]
  v_mfma_f32_16x16x32_bf16 v[120:123], a[208:211], a[184:187], v[120:123]
  v_mfma_f32_16x16x32_bf16 v[120:123], a[212:215], a[188:191], v[120:123]
  buffer_load_dwordx4 v221, s[4:7], s66 offen offset:1024 lds
  v_mfma_f32_16x16x32_bf16 v[152:155], a[208:211], v[232:235], v[152:155]
  s_waitcnt lgkmcnt(8)
  v_mfma_f32_16x16x32_bf16 v[152:155], a[212:215], v[236:239], v[152:155]
  ds_read_b64_tr_b16 a[208:209], v9 offset:768
  ds_read_b64_tr_b16 a[210:211], v9 offset:1792
  v_mfma_f32_16x16x32_bf16 v[28:31], a[216:219], a[160:163], v[28:31]
  ds_read_b64_tr_b16 a[212:213], v9 offset:8960
  v_mfma_f32_16x16x32_bf16 v[28:31], a[220:223], a[164:167], v[28:31]
  ds_read_b64_tr_b16 a[214:215], v9 offset:9984
  v_mfma_f32_16x16x32_bf16 v[60:63], a[216:219], a[168:171], v[60:63]
  buffer_load_dwordx4 v222, s[4:7], s66 offen offset:2048 lds
  v_mfma_f32_16x16x32_bf16 v[60:63], a[220:223], a[172:175], v[60:63]
  v_mfma_f32_16x16x32_bf16 v[92:95], a[216:219], a[176:179], v[92:95]
  v_mfma_f32_16x16x32_bf16 v[92:95], a[220:223], a[180:183], v[92:95]
  v_mfma_f32_16x16x32_bf16 v[124:127], a[216:219], a[184:187], v[124:127]
  v_mfma_f32_16x16x32_bf16 v[124:127], a[220:223], a[188:191], v[124:127]
  buffer_load_dwordx4 v223, s[4:7], s66 offen offset:3072 lds
  v_mfma_f32_16x16x32_bf16 v[156:159], a[216:219], v[232:235], v[156:159]
  s_waitcnt lgkmcnt(8)
  v_mfma_f32_16x16x32_bf16 v[156:159], a[220:223], v[236:239], v[156:159]
  ds_read_b64_tr_b16 a[216:217], v10 offset:768
  ds_read_b64_tr_b16 a[218:219], v10 offset:1792
  v_mfma_f32_16x16x32_bf16 v[32:35], a[192:195], a[160:163], v[32:35]
  ds_read_b64_tr_b16 a[220:221], v10 offset:8960
  s_add_u32 m0, s69, 0x22000
  v_mfma_f32_16x16x32_bf16 v[32:35], a[196:199], a[164:167], v[32:35]
  ds_read_b64_tr_b16 a[222:223], v10 offset:9984
  v_mfma_f32_16x16x32_bf16 v[64:67], a[192:195], a[168:171], v[64:67]
  buffer_load_dwordx4 v246, s[4:7], s66 offen lds
  v_mfma_f32_16x16x32_bf16 v[64:67], a[196:199], a[172:175], v[64:67]
  v_mfma_f32_16x16x32_bf16 v[96:99], a[192:195], a[176:179], v[96:99]
  v_mfma_f32_16x16x32_bf16 v[96:99], a[196:199], a[180:183], v[96:99]
  v_add_u32 v242, 0xd000, v242
  v_add_u32 v243, 0xd000, v243
  v_add_u32 v9, 0xd000, v9
  v_mfma_f32_16x16x32_bf16 v[128:131], a[192:195], a[184:187], v[128:131]
  s_waitcnt lgkmcnt(8)
  v_add_u32 v10, 0xd000, v10
  v_mfma_f32_16x16x32_bf16 v[128:131], a[196:199], a[188:191], v[128:131]
  v_mfma_f32_16x16x32_bf16 v[36:39], a[200:203], a[160:163], v[36:39]
  v_mfma_f32_16x16x32_bf16 v[36:39], a[204:207], a[164:167], v[36:39]
  s_waitcnt vmcnt(13) lgkmcnt(0)
  v_mfma_f32_16x16x32_bf16 v[68:71], a[200:203], a[168:171], v[68:71]
  s_barrier
  v_mfma_f32_16x16x32_bf16 v[68:71], a[204:207], a[172:175], v[68:71]
  ds_read_b64_tr_b16 a[192:193], v242
  ds_read_b64_tr_b16 a[194:195], v242 offset:1024
  v_mfma_f32_16x16x32_bf16 v[100:103], a[200:203], a[176:179], v[100:103]
  ds_read_b64_tr_b16 a[196:197], v242 offset:8192
  s_add_u32 s24, s56, 0
  s_addc_u32 s25, s57, 0
  v_mfma_f32_16x16x32_bf16 v[100:103], a[204:207], a[180:183], v[100:103]
  ds_read_b64_tr_b16 a[198:199], v242 offset:9216
  s_mov_b32 s26, 0x400000
  v_mfma_f32_16x16x32_bf16 v[132:135], a[200:203], a[184:187], v[132:135]
  ds_read_b128 v[176:179], v240
  s_waitcnt lgkmcnt(15)
  v_mfma_f32_16x16x32_bf16 v[132:135], a[204:207], a[188:191], v[132:135]
  ds_read_b128 v[180:183], v240 offset:512
  s_mov_b32 s27, 0x20000
  v_mfma_f32_16x16x32_bf16 v[40:43], a[208:211], a[160:163], v[40:43]
  ds_read_b128 v[184:187], v240 offset:2048
  s_lshl2_add_u32 s47, s2, s3
  v_mfma_f32_16x16x32_bf16 v[40:43], a[212:215], a[164:167], v[40:43]
  ds_read_b128 v[188:191], v240 offset:2560
  s_add_u32 s66, s66, 0x80
  v_mfma_f32_16x16x32_bf16 v[72:75], a[208:211], a[168:171], v[72:75]
  ds_read_b128 v[192:195], v240 offset:4096
  s_cmp_eq_u32 s66, 0x400
  s_cselect_b32 s66, 0x80, s66
  v_mfma_f32_16x16x32_bf16 v[72:75], a[212:215], a[172:175], v[72:75]
  ds_read_b128 v[196:199], v240 offset:4608
  s_lshl_b32 s67, s66, 12
  v_mfma_f32_16x16x32_bf16 v[104:107], a[208:211], a[176:179], v[104:107]
  ds_read_b128 v[200:203], v240 offset:6144
  s_add_u32 m0, s75, 0x9000
  v_mfma_f32_16x16x32_bf16 v[104:107], a[212:215], a[180:183], v[104:107]
  ds_read_b128 v[204:207], v240 offset:6656
  s_lshl_b32 s47, s47, 12
  v_mfma_f32_16x16x32_bf16 v[136:139], a[208:211], a[184:187], v[136:139]
  ds_read_b128 v[208:211], v241
  s_waitcnt lgkmcnt(15)
  v_mfma_f32_16x16x32_bf16 v[136:139], a[212:215], a[188:191], v[136:139]
  ds_read_b128 v[212:215], v241 offset:512
  v_min_u32 v253, 15, v14
  v_mfma_f32_16x16x32_bf16 v[44:47], a[216:219], a[160:163], v[44:47]
  v_lshlrev_b32 v253, 7, v253
  v_mfma_f32_16x16x32_bf16 v[44:47], a[220:223], a[164:167], v[44:47]
  buffer_load_dwordx4 v224, s[8:11], s67 offen lds
  v_mfma_f32_16x16x32_bf16 v[76:79], a[216:219], a[168:171], v[76:79]
  v_mfma_f32_16x16x32_bf16 v[76:79], a[220:223], a[172:175], v[76:79]
  buffer_load_dwordx4 v225, s[8:11], s67 offen offset:1024 lds
  v_mfma_f32_16x16x32_bf16 v[108:111], a[216:219], a[176:179], v[108:111]
  v_mfma_f32_16x16x32_bf16 v[108:111], a[220:223], a[180:183], v[108:111]
  buffer_load_dwordx4 v226, s[8:11], s67 offen offset:2048 lds
  v_mfma_f32_16x16x32_bf16 v[140:143], a[216:219], a[184:187], v[140:143]
  v_mfma_f32_16x16x32_bf16 v[140:143], a[220:223], a[188:191], v[140:143]
  buffer_load_dwordx4 v227, s[8:11], s67 offen offset:3072 lds
  buffer_load_dword a236, v253, s[24:27], s47 offen
  s_waitcnt lgkmcnt(0)
  v_mfma_f32_16x16x32_bf16 v[16:19], a[192:195], v[176:179], v[16:19]
  ds_read_b64_tr_b16 a[200:201], v243
  s_add_u32 m0, s68, 0
  v_mfma_f32_16x16x32_bf16 v[16:19], a[196:199], v[180:183], v[16:19]
  ds_read_b64_tr_b16 a[202:203], v243 offset:1024
  v_add_u32 v240, 0xd000, v240
  v_mfma_f32_16x16x32_bf16 v[48:51], a[192:195], v[184:187], v[48:51]
  ds_read_b64_tr_b16 a[204:205], v243 offset:8192
  v_add_u32 v241, 0xd000, v241
  v_mfma_f32_16x16x32_bf16 v[48:51], a[196:199], v[188:191], v[48:51]
  ds_read_b64_tr_b16 a[206:207], v243 offset:9216
  v_mfma_f32_16x16x32_bf16 v[80:83], a[192:195], v[192:195], v[80:83]
  ds_read_b64_tr_b16 a[208:209], v242 offset:256
  ds_read_b64_tr_b16 a[210:211], v242 offset:1280
  v_mfma_f32_16x16x32_bf16 v[80:83], a[196:199], v[196:199], v[80:83]
  ds_read_b64_tr_b16 a[212:213], v242 offset:8448
  v_mfma_f32_16x16x32_bf16 v[112:115], a[192:195], v[200:203], v[112:115]
  ds_read_b64_tr_b16 a[214:215], v242 offset:9472
  ds_read_b64_tr_b16 a[216:217], v243 offset:256
  v_mfma_f32_16x16x32_bf16 v[112:115], a[196:199], v[204:207], v[112:115]
  ds_read_b64_tr_b16 a[218:219], v243 offset:1280
  v_mfma_f32_16x16x32_bf16 v[144:147], a[192:195], v[208:211], v[144:147]
  ds_read_b64_tr_b16 a[220:221], v243 offset:8448
  s_waitcnt lgkmcnt(7)
  v_mfma_f32_16x16x32_bf16 v[144:147], a[196:199], v[212:215], v[144:147]
  ds_read_b64_tr_b16 a[222:223], v243 offset:9472
  ds_read_b64_tr_b16 a[192:193], v9 offset:512
  v_mfma_f32_16x16x32_bf16 v[20:23], a[200:203], v[176:179], v[20:23]
  ds_read_b64_tr_b16 a[194:195], v9 offset:1536
  v_mfma_f32_16x16x32_bf16 v[20:23], a[204:207], v[180:183], v[20:23]
  ds_read_b64_tr_b16 a[196:197], v9 offset:8704
  ds_read_b64_tr_b16 a[198:199], v9 offset:9728
  v_mfma_f32_16x16x32_bf16 v[52:55], a[200:203], v[184:187], v[52:55]
  v_mfma_f32_16x16x32_bf16 v[52:55], a[204:207], v[188:191], v[52:55]
  buffer_load_dwordx4 v216, s[4:7], s66 offen lds
  v_mfma_f32_16x16x32_bf16 v[84:87], a[200:203], v[192:195], v[84:87]
  v_mfma_f32_16x16x32_bf16 v[84:87], a[204:207], v[196:199], v[84:87]
  buffer_load_dwordx4 v217, s[4:7], s66 offen offset:1024 lds
  v_mfma_f32_16x16x32_bf16 v[116:119], a[200:203], v[200:203], v[116:119]
  v_mfma_f32_16x16x32_bf16 v[116:119], a[204:207], v[204:207], v[116:119]
  buffer_load_dwordx4 v218, s[4:7], s66 offen offset:2048 lds
  v_mfma_f32_16x16x32_bf16 v[148:151], a[200:203], v[208:211], v[148:151]
  s_waitcnt lgkmcnt(8)
  v_mfma_f32_16x16x32_bf16 v[148:151], a[204:207], v[212:215], v[148:151]
  ds_read_b64_tr_b16 a[200:201], v10 offset:512
  ds_read_b64_tr_b16 a[202:203], v10 offset:1536
  v_mfma_f32_16x16x32_bf16 v[24:27], a[208:211], v[176:179], v[24:27]
  ds_read_b64_tr_b16 a[204:205], v10 offset:8704
  v_mfma_f32_16x16x32_bf16 v[24:27], a[212:215], v[180:183], v[24:27]
  ds_read_b64_tr_b16 a[206:207], v10 offset:9728
  v_mfma_f32_16x16x32_bf16 v[56:59], a[208:211], v[184:187], v[56:59]
  buffer_load_dwordx4 v219, s[4:7], s66 offen offset:3072 lds
  v_mfma_f32_16x16x32_bf16 v[56:59], a[212:215], v[188:191], v[56:59]
  s_add_u32 m0, s68, 0x1000
  v_mfma_f32_16x16x32_bf16 v[88:91], a[208:211], v[192:195], v[88:91]
  buffer_load_dwordx4 v220, s[4:7], s66 offen lds
  v_mfma_f32_16x16x32_bf16 v[88:91], a[212:215], v[196:199], v[88:91]
  v_mfma_f32_16x16x32_bf16 v[120:123], a[208:211], v[200:203], v[120:123]
  v_mfma_f32_16x16x32_bf16 v[120:123], a[212:215], v[204:207], v[120:123]
  buffer_load_dwordx4 v221, s[4:7], s66 offen offset:1024 lds
  v_mfma_f32_16x16x32_bf16 v[152:155], a[208:211], v[208:211], v[152:155]
  s_waitcnt lgkmcnt(8)
  v_mfma_f32_16x16x32_bf16 v[152:155], a[212:215], v[212:215], v[152:155]
  ds_read_b64_tr_b16 a[208:209], v9 offset:768
  ds_read_b64_tr_b16 a[210:211], v9 offset:1792
  v_mfma_f32_16x16x32_bf16 v[28:31], a[216:219], v[176:179], v[28:31]
  ds_read_b64_tr_b16 a[212:213], v9 offset:8960
  v_mfma_f32_16x16x32_bf16 v[28:31], a[220:223], v[180:183], v[28:31]
  ds_read_b64_tr_b16 a[214:215], v9 offset:9984
  v_mfma_f32_16x16x32_bf16 v[60:63], a[216:219], v[184:187], v[60:63]
  buffer_load_dwordx4 v222, s[4:7], s66 offen offset:2048 lds
  v_mfma_f32_16x16x32_bf16 v[60:63], a[220:223], v[188:191], v[60:63]
  v_mfma_f32_16x16x32_bf16 v[92:95], a[216:219], v[192:195], v[92:95]
  v_mfma_f32_16x16x32_bf16 v[92:95], a[220:223], v[196:199], v[92:95]
  v_mfma_f32_16x16x32_bf16 v[124:127], a[216:219], v[200:203], v[124:127]
  v_mfma_f32_16x16x32_bf16 v[124:127], a[220:223], v[204:207], v[124:127]
  buffer_load_dwordx4 v223, s[4:7], s66 offen offset:3072 lds
  v_mfma_f32_16x16x32_bf16 v[156:159], a[216:219], v[208:211], v[156:159]
  s_waitcnt lgkmcnt(8)
  v_mfma_f32_16x16x32_bf16 v[156:159], a[220:223], v[212:215], v[156:159]
  ds_read_b64_tr_b16 a[216:217], v10 offset:768
  ds_read_b64_tr_b16 a[218:219], v10 offset:1792
  v_mfma_f32_16x16x32_bf16 v[32:35], a[192:195], v[176:179], v[32:35]
  ds_read_b64_tr_b16 a[220:221], v10 offset:8960
  s_add_u32 m0, s69, 0x8000
  v_mfma_f32_16x16x32_bf16 v[32:35], a[196:199], v[180:183], v[32:35]
  ds_read_b64_tr_b16 a[222:223], v10 offset:9984
  v_mfma_f32_16x16x32_bf16 v[64:67], a[192:195], v[184:187], v[64:67]
  buffer_load_dwordx4 v246, s[4:7], s66 offen lds
  v_mfma_f32_16x16x32_bf16 v[64:67], a[196:199], v[188:191], v[64:67]
  v_mfma_f32_16x16x32_bf16 v[96:99], a[192:195], v[192:195], v[96:99]
  v_mfma_f32_16x16x32_bf16 v[96:99], a[196:199], v[196:199], v[96:99]
  v_add_u32 v242, 0xd000, v242
  v_add_u32 v243, 0xd000, v243
  v_add_u32 v9, 0xd000, v9
  v_mfma_f32_16x16x32_bf16 v[128:131], a[192:195], v[200:203], v[128:131]
  s_waitcnt lgkmcnt(8)
  v_add_u32 v10, 0xd000, v10
  v_mfma_f32_16x16x32_bf16 v[128:131], a[196:199], v[204:207], v[128:131]
  v_mfma_f32_16x16x32_bf16 v[36:39], a[200:203], v[176:179], v[36:39]
  v_mfma_f32_16x16x32_bf16 v[36:39], a[204:207], v[180:183], v[36:39]
  s_waitcnt vmcnt(14) lgkmcnt(0)
  v_mfma_f32_16x16x32_bf16 v[68:71], a[200:203], v[184:187], v[68:71]
  s_barrier
  v_mfma_f32_16x16x32_bf16 v[68:71], a[204:207], v[188:191], v[68:71]
  ds_read_b64_tr_b16 a[192:193], v242
  ds_read_b64_tr_b16 a[194:195], v242 offset:1024
  v_mfma_f32_16x16x32_bf16 v[100:103], a[200:203], v[192:195], v[100:103]
  ds_read_b64_tr_b16 a[196:197], v242 offset:8192
  s_add_u32 s47, s47, 0x800
  v_mfma_f32_16x16x32_bf16 v[100:103], a[204:207], v[196:199], v[100:103]
  ds_read_b64_tr_b16 a[198:199], v242 offset:9216
  v_mfma_f32_16x16x32_bf16 v[132:135], a[200:203], v[200:203], v[132:135]
  ds_read_b128 a[160:163], v240
  ds_read_b128 a[164:167], v240 offset:512
  v_mfma_f32_16x16x32_bf16 v[132:135], a[204:207], v[204:207], v[132:135]
  ds_read_b128 a[168:171], v240 offset:2048
  s_waitcnt lgkmcnt(15)
  v_mfma_f32_16x16x32_bf16 v[40:43], a[208:211], v[176:179], v[40:43]
  ds_read_b128 a[172:175], v240 offset:2560
  v_mfma_f32_16x16x32_bf16 v[40:43], a[212:215], v[180:183], v[40:43]
  ds_read_b128 a[176:179], v240 offset:4096
  s_add_u32 s66, s66, 0x80
  s_cmp_eq_u32 s66, 0x400
  s_cselect_b32 s66, 0x80, s66
  v_mfma_f32_16x16x32_bf16 v[72:75], a[208:211], v[184:187], v[72:75]
  ds_read_b128 a[180:183], v240 offset:4608
  s_lshl_b32 s67, s66, 12
  v_mfma_f32_16x16x32_bf16 v[72:75], a[212:215], v[188:191], v[72:75]
  ds_read_b128 a[184:187], v240 offset:6144
  s_add_u32 m0, s75, 0x16000
  v_mfma_f32_16x16x32_bf16 v[104:107], a[208:211], v[192:195], v[104:107]
  ds_read_b128 a[188:191], v240 offset:6656
  v_mfma_f32_16x16x32_bf16 v[104:107], a[212:215], v[196:199], v[104:107]
  ds_read_b128 v[232:235], v241
  ds_read_b128 v[236:239], v241 offset:512
  v_mfma_f32_16x16x32_bf16 v[136:139], a[208:211], v[200:203], v[136:139]
  s_waitcnt lgkmcnt(15)
  v_mfma_f32_16x16x32_bf16 v[136:139], a[212:215], v[204:207], v[136:139]
  buffer_load_dwordx4 v224, s[8:11], s67 offen lds
  v_mfma_f32_16x16x32_bf16 v[44:47], a[216:219], v[176:179], v[44:47]
  v_mfma_f32_16x16x32_bf16 v[44:47], a[220:223], v[180:183], v[44:47]
  buffer_load_dwordx4 v225, s[8:11], s67 offen offset:1024 lds
  v_mfma_f32_16x16x32_bf16 v[76:79], a[216:219], v[184:187], v[76:79]
  v_mfma_f32_16x16x32_bf16 v[76:79], a[220:223], v[188:191], v[76:79]
  buffer_load_dwordx4 v226, s[8:11], s67 offen offset:2048 lds
  v_mfma_f32_16x16x32_bf16 v[108:111], a[216:219], v[192:195], v[108:111]
  v_mfma_f32_16x16x32_bf16 v[108:111], a[220:223], v[196:199], v[108:111]
  buffer_load_dwordx4 v227, s[8:11], s67 offen offset:3072 lds
  v_mfma_f32_16x16x32_bf16 v[140:143], a[216:219], v[200:203], v[140:143]
  v_mfma_f32_16x16x32_bf16 v[140:143], a[220:223], v[204:207], v[140:143]
  buffer_load_dword a236, v253, s[24:27], s47 offen
  s_waitcnt lgkmcnt(0)
  v_mfma_f32_16x16x32_bf16 v[16:19], a[192:195], a[160:163], v[16:19]
  ds_read_b64_tr_b16 a[200:201], v243
  s_add_u32 m0, s68, 0xd000
  v_mfma_f32_16x16x32_bf16 v[16:19], a[196:199], a[164:167], v[16:19]
  ds_read_b64_tr_b16 a[202:203], v243 offset:1024
  v_add_u32 v240, 0xfffe6000, v240
  v_mfma_f32_16x16x32_bf16 v[48:51], a[192:195], a[168:171], v[48:51]
  ds_read_b64_tr_b16 a[204:205], v243 offset:8192
  v_add_u32 v241, 0xfffe6000, v241
  v_mfma_f32_16x16x32_bf16 v[48:51], a[196:199], a[172:175], v[48:51]
  ds_read_b64_tr_b16 a[206:207], v243 offset:9216
  v_mfma_f32_16x16x32_bf16 v[80:83], a[192:195], a[176:179], v[80:83]
  ds_read_b64_tr_b16 a[208:209], v242 offset:256
  ds_read_b64_tr_b16 a[210:211], v242 offset:1280
  v_mfma_f32_16x16x32_bf16 v[80:83], a[196:199], a[180:183], v[80:83]
  ds_read_b64_tr_b16 a[212:213], v242 offset:8448
  v_mfma_f32_16x16x32_bf16 v[112:115], a[192:195], a[184:187], v[112:115]
  ds_read_b64_tr_b16 a[214:215], v242 offset:9472
  ds_read_b64_tr_b16 a[216:217], v243 offset:256
  v_mfma_f32_16x16x32_bf16 v[112:115], a[196:199], a[188:191], v[112:115]
  ds_read_b64_tr_b16 a[218:219], v243 offset:1280
  v_mfma_f32_16x16x32_bf16 v[144:147], a[192:195], v[232:235], v[144:147]
  ds_read_b64_tr_b16 a[220:221], v243 offset:8448
  s_waitcnt lgkmcnt(7)
  v_mfma_f32_16x16x32_bf16 v[144:147], a[196:199], v[236:239], v[144:147]
  ds_read_b64_tr_b16 a[222:223], v243 offset:9472
  ds_read_b64_tr_b16 a[192:193], v9 offset:512
  v_mfma_f32_16x16x32_bf16 v[20:23], a[200:203], a[160:163], v[20:23]
  ds_read_b64_tr_b16 a[194:195], v9 offset:1536
  v_mfma_f32_16x16x32_bf16 v[20:23], a[204:207], a[164:167], v[20:23]
  ds_read_b64_tr_b16 a[196:197], v9 offset:8704
  ds_read_b64_tr_b16 a[198:199], v9 offset:9728
  v_mfma_f32_16x16x32_bf16 v[52:55], a[200:203], a[168:171], v[52:55]
  v_mfma_f32_16x16x32_bf16 v[52:55], a[204:207], a[172:175], v[52:55]
  buffer_load_dwordx4 v216, s[4:7], s66 offen lds
  v_mfma_f32_16x16x32_bf16 v[84:87], a[200:203], a[176:179], v[84:87]
  v_mfma_f32_16x16x32_bf16 v[84:87], a[204:207], a[180:183], v[84:87]
  buffer_load_dwordx4 v217, s[4:7], s66 offen offset:1024 lds
  v_mfma_f32_16x16x32_bf16 v[116:119], a[200:203], a[184:187], v[116:119]
  v_mfma_f32_16x16x32_bf16 v[116:119], a[204:207], a[188:191], v[116:119]
  buffer_load_dwordx4 v218, s[4:7], s66 offen offset:2048 lds
  v_mfma_f32_16x16x32_bf16 v[148:151], a[200:203], v[232:235], v[148:151]
  s_waitcnt lgkmcnt(8)
  v_mfma_f32_16x16x32_bf16 v[148:151], a[204:207], v[236:239], v[148:151]
  ds_read_b64_tr_b16 a[200:201], v10 offset:512
  ds_read_b64_tr_b16 a[202:203], v10 offset:1536
  v_mfma_f32_16x16x32_bf16 v[24:27], a[208:211], a[160:163], v[24:27]
  ds_read_b64_tr_b16 a[204:205], v10 offset:8704
  v_mfma_f32_16x16x32_bf16 v[24:27], a[212:215], a[164:167], v[24:27]
  ds_read_b64_tr_b16 a[206:207], v10 offset:9728
  v_mfma_f32_16x16x32_bf16 v[56:59], a[208:211], a[168:171], v[56:59]
  buffer_load_dwordx4 v219, s[4:7], s66 offen offset:3072 lds
  v_mfma_f32_16x16x32_bf16 v[56:59], a[212:215], a[172:175], v[56:59]
  s_add_u32 m0, s68, 0xe000
  v_mfma_f32_16x16x32_bf16 v[88:91], a[208:211], a[176:179], v[88:91]
  buffer_load_dwordx4 v220, s[4:7], s66 offen lds
  v_mfma_f32_16x16x32_bf16 v[88:91], a[212:215], a[180:183], v[88:91]
  v_mfma_f32_16x16x32_bf16 v[120:123], a[208:211], a[184:187], v[120:123]
  v_mfma_f32_16x16x32_bf16 v[120:123], a[212:215], a[188:191], v[120:123]
  buffer_load_dwordx4 v221, s[4:7], s66 offen offset:1024 lds
  v_mfma_f32_16x16x32_bf16 v[152:155], a[208:211], v[232:235], v[152:155]
  s_waitcnt lgkmcnt(8)
  v_mfma_f32_16x16x32_bf16 v[152:155], a[212:215], v[236:239], v[152:155]
  ds_read_b64_tr_b16 a[208:209], v9 offset:768
  ds_read_b64_tr_b16 a[210:211], v9 offset:1792
  v_mfma_f32_16x16x32_bf16 v[28:31], a[216:219], a[160:163], v[28:31]
  ds_read_b64_tr_b16 a[212:213], v9 offset:8960
  v_mfma_f32_16x16x32_bf16 v[28:31], a[220:223], a[164:167], v[28:31]
  ds_read_b64_tr_b16 a[214:215], v9 offset:9984
  v_mfma_f32_16x16x32_bf16 v[60:63], a[216:219], a[168:171], v[60:63]
  buffer_load_dwordx4 v222, s[4:7], s66 offen offset:2048 lds
  v_mfma_f32_16x16x32_bf16 v[60:63], a[220:223], a[172:175], v[60:63]
  v_mfma_f32_16x16x32_bf16 v[92:95], a[216:219], a[176:179], v[92:95]
  v_mfma_f32_16x16x32_bf16 v[92:95], a[220:223], a[180:183], v[92:95]
  v_mfma_f32_16x16x32_bf16 v[124:127], a[216:219], a[184:187], v[124:127]
  v_mfma_f32_16x16x32_bf16 v[124:127], a[220:223], a[188:191], v[124:127]
  buffer_load_dwordx4 v223, s[4:7], s66 offen offset:3072 lds
  v_mfma_f32_16x16x32_bf16 v[156:159], a[216:219], v[232:235], v[156:159]
  s_waitcnt lgkmcnt(8)
  v_mfma_f32_16x16x32_bf16 v[156:159], a[220:223], v[236:239], v[156:159]
  ds_read_b64_tr_b16 a[216:217], v10 offset:768
  ds_read_b64_tr_b16 a[218:219], v10 offset:1792
  v_mfma_f32_16x16x32_bf16 v[32:35], a[192:195], a[160:163], v[32:35]
  ds_read_b64_tr_b16 a[220:221], v10 offset:8960
  s_add_u32 m0, s69, 0x15000
  v_mfma_f32_16x16x32_bf16 v[32:35], a[196:199], a[164:167], v[32:35]
  ds_read_b64_tr_b16 a[222:223], v10 offset:9984
  v_mfma_f32_16x16x32_bf16 v[64:67], a[192:195], a[168:171], v[64:67]
  buffer_load_dwordx4 v246, s[4:7], s66 offen lds
  v_mfma_f32_16x16x32_bf16 v[64:67], a[196:199], a[172:175], v[64:67]
  v_mfma_f32_16x16x32_bf16 v[96:99], a[192:195], a[176:179], v[96:99]
  v_mfma_f32_16x16x32_bf16 v[96:99], a[196:199], a[180:183], v[96:99]
  v_add_u32 v242, 0xfffe6000, v242
  v_add_u32 v243, 0xfffe6000, v243
  v_add_u32 v9, 0xfffe6000, v9
  v_mfma_f32_16x16x32_bf16 v[128:131], a[192:195], a[184:187], v[128:131]
  s_waitcnt lgkmcnt(8)
  v_add_u32 v10, 0xfffe6000, v10
  v_mfma_f32_16x16x32_bf16 v[128:131], a[196:199], a[188:191], v[128:131]
  v_mfma_f32_16x16x32_bf16 v[36:39], a[200:203], a[160:163], v[36:39]
  v_mfma_f32_16x16x32_bf16 v[36:39], a[204:207], a[164:167], v[36:39]
  s_waitcnt vmcnt(14) lgkmcnt(0)
  v_mfma_f32_16x16x32_bf16 v[68:71], a[200:203], a[168:171], v[68:71]
  s_barrier
  v_mfma_f32_16x16x32_bf16 v[68:71], a[204:207], a[172:175], v[68:71]
  ds_read_b64_tr_b16 a[192:193], v242
  ds_read_b64_tr_b16 a[194:195], v242 offset:1024
  v_mfma_f32_16x16x32_bf16 v[100:103], a[200:203], a[176:179], v[100:103]
  ds_read_b64_tr_b16 a[196:197], v242 offset:8192
  v_mfma_f32_16x16x32_bf16 v[100:103], a[204:207], a[180:183], v[100:103]
  ds_read_b64_tr_b16 a[198:199], v242 offset:9216
  ds_read_b128 v[176:179], v240
  v_mfma_f32_16x16x32_bf16 v[132:135], a[200:203], a[184:187], v[132:135]
  ds_read_b128 v[180:183], v240 offset:512
  s_waitcnt lgkmcnt(15)
  v_mfma_f32_16x16x32_bf16 v[132:135], a[204:207], a[188:191], v[132:135]
  ds_read_b128 v[184:187], v240 offset:2048
  v_mfma_f32_16x16x32_bf16 v[40:43], a[208:211], a[160:163], v[40:43]
  ds_read_b128 v[188:191], v240 offset:2560
  ds_read_b128 v[192:195], v240 offset:4096
  v_mfma_f32_16x16x32_bf16 v[40:43], a[212:215], a[164:167], v[40:43]
  ds_read_b128 v[196:199], v240 offset:4608
  s_add_u32 s66, s66, 0x80
  v_mfma_f32_16x16x32_bf16 v[72:75], a[208:211], a[168:171], v[72:75]
  ds_read_b128 v[200:203], v240 offset:6144
  s_cmp_eq_u32 s66, 0x400
  s_cselect_b32 s66, 0x80, s66
  v_mfma_f32_16x16x32_bf16 v[72:75], a[212:215], a[172:175], v[72:75]
  ds_read_b128 v[204:207], v240 offset:6656
  s_lshl_b32 s67, s66, 12
  v_mfma_f32_16x16x32_bf16 v[104:107], a[208:211], a[176:179], v[104:107]
  ds_read_b128 v[208:211], v241
  s_add_u32 m0, s75, 0x23000
  v_mfma_f32_16x16x32_bf16 v[104:107], a[212:215], a[180:183], v[104:107]
  ds_read_b128 v[212:215], v241 offset:512
  v_mfma_f32_16x16x32_bf16 v[136:139], a[208:211], a[184:187], v[136:139]
  buffer_load_dwordx4 v224, s[8:11], s67 offen lds
  v_mfma_f32_16x16x32_bf16 v[136:139], a[212:215], a[188:191], v[136:139]
  s_waitcnt lgkmcnt(15)
  v_mfma_f32_16x16x32_bf16 v[44:47], a[216:219], a[160:163], v[44:47]
  buffer_load_dwordx4 v225, s[8:11], s67 offen offset:1024 lds
  v_mfma_f32_16x16x32_bf16 v[44:47], a[220:223], a[164:167], v[44:47]
  v_mfma_f32_16x16x32_bf16 v[76:79], a[216:219], a[168:171], v[76:79]
  buffer_load_dwordx4 v226, s[8:11], s67 offen offset:2048 lds
  v_mfma_f32_16x16x32_bf16 v[76:79], a[220:223], a[172:175], v[76:79]
  v_mfma_f32_16x16x32_bf16 v[108:111], a[216:219], a[176:179], v[108:111]
  buffer_load_dwordx4 v227, s[8:11], s67 offen offset:3072 lds
  v_mfma_f32_16x16x32_bf16 v[108:111], a[220:223], a[180:183], v[108:111]
  v_mfma_f32_16x16x32_bf16 v[140:143], a[216:219], a[184:187], v[140:143]
  v_mfma_f32_16x16x32_bf16 v[140:143], a[220:223], a[188:191], v[140:143]
  s_waitcnt lgkmcnt(0)
  v_mfma_f32_16x16x32_bf16 v[16:19], a[192:195], v[176:179], v[16:19]
  ds_read_b64_tr_b16 a[200:201], v243
  s_add_u32 m0, s68, 0x1a000
  v_mfma_f32_16x16x32_bf16 v[16:19], a[196:199], v[180:183], v[16:19]
  ds_read_b64_tr_b16 a[202:203], v243 offset:1024
  v_add_u32 v240, 0xd000, v240
  v_mfma_f32_16x16x32_bf16 v[48:51], a[192:195], v[184:187], v[48:51]
  ds_read_b64_tr_b16 a[204:205], v243 offset:8192
  v_add_u32 v241, 0xd000, v241
  v_mfma_f32_16x16x32_bf16 v[48:51], a[196:199], v[188:191], v[48:51]
  ds_read_b64_tr_b16 a[206:207], v243 offset:9216
  v_mfma_f32_16x16x32_bf16 v[80:83], a[192:195], v[192:195], v[80:83]
  ds_read_b64_tr_b16 a[208:209], v242 offset:256
  ds_read_b64_tr_b16 a[210:211], v242 offset:1280
  v_mfma_f32_16x16x32_bf16 v[80:83], a[196:199], v[196:199], v[80:83]
  ds_read_b64_tr_b16 a[212:213], v242 offset:8448
  v_mfma_f32_16x16x32_bf16 v[112:115], a[192:195], v[200:203], v[112:115]
  ds_read_b64_tr_b16 a[214:215], v242 offset:9472
  ds_read_b64_tr_b16 a[216:217], v243 offset:256
  v_mfma_f32_16x16x32_bf16 v[112:115], a[196:199], v[204:207], v[112:115]
  ds_read_b64_tr_b16 a[218:219], v243 offset:1280
  v_mfma_f32_16x16x32_bf16 v[144:147], a[192:195], v[208:211], v[144:147]
  ds_read_b64_tr_b16 a[220:221], v243 offset:8448
  s_waitcnt lgkmcnt(7)
  v_mfma_f32_16x16x32_bf16 v[144:147], a[196:199], v[212:215], v[144:147]
  ds_read_b64_tr_b16 a[222:223], v243 offset:9472
  ds_read_b64_tr_b16 a[192:193], v9 offset:512
  v_mfma_f32_16x16x32_bf16 v[20:23], a[200:203], v[176:179], v[20:23]
  ds_read_b64_tr_b16 a[194:195], v9 offset:1536
  v_mfma_f32_16x16x32_bf16 v[20:23], a[204:207], v[180:183], v[20:23]
  ds_read_b64_tr_b16 a[196:197], v9 offset:8704
  ds_read_b64_tr_b16 a[198:199], v9 offset:9728
  v_mfma_f32_16x16x32_bf16 v[52:55], a[200:203], v[184:187], v[52:55]
  v_mfma_f32_16x16x32_bf16 v[52:55], a[204:207], v[188:191], v[52:55]
  buffer_load_dwordx4 v216, s[4:7], s66 offen lds
  v_mfma_f32_16x16x32_bf16 v[84:87], a[200:203], v[192:195], v[84:87]
  v_mfma_f32_16x16x32_bf16 v[84:87], a[204:207], v[196:199], v[84:87]
  buffer_load_dwordx4 v217, s[4:7], s66 offen offset:1024 lds
  v_mfma_f32_16x16x32_bf16 v[116:119], a[200:203], v[200:203], v[116:119]
  v_mfma_f32_16x16x32_bf16 v[116:119], a[204:207], v[204:207], v[116:119]
  buffer_load_dwordx4 v218, s[4:7], s66 offen offset:2048 lds
  v_mfma_f32_16x16x32_bf16 v[148:151], a[200:203], v[208:211], v[148:151]
  s_waitcnt lgkmcnt(8)
  v_mfma_f32_16x16x32_bf16 v[148:151], a[204:207], v[212:215], v[148:151]
  ds_read_b64_tr_b16 a[200:201], v10 offset:512
  ds_read_b64_tr_b16 a[202:203], v10 offset:1536
  v_mfma_f32_16x16x32_bf16 v[24:27], a[208:211], v[176:179], v[24:27]
  ds_read_b64_tr_b16 a[204:205], v10 offset:8704
  v_mfma_f32_16x16x32_bf16 v[24:27], a[212:215], v[180:183], v[24:27]
  ds_read_b64_tr_b16 a[206:207], v10 offset:9728
  v_mfma_f32_16x16x32_bf16 v[56:59], a[208:211], v[184:187], v[56:59]
  buffer_load_dwordx4 v219, s[4:7], s66 offen offset:3072 lds
  v_mfma_f32_16x16x32_bf16 v[56:59], a[212:215], v[188:191], v[56:59]
  s_add_u32 m0, s68, 0x1b000
  v_mfma_f32_16x16x32_bf16 v[88:91], a[208:211], v[192:195], v[88:91]
  buffer_load_dwordx4 v220, s[4:7], s66 offen lds
  v_mfma_f32_16x16x32_bf16 v[88:91], a[212:215], v[196:199], v[88:91]
  v_mfma_f32_16x16x32_bf16 v[120:123], a[208:211], v[200:203], v[120:123]
  v_mfma_f32_16x16x32_bf16 v[120:123], a[212:215], v[204:207], v[120:123]
  buffer_load_dwordx4 v221, s[4:7], s66 offen offset:1024 lds
  v_mfma_f32_16x16x32_bf16 v[152:155], a[208:211], v[208:211], v[152:155]
  s_waitcnt lgkmcnt(8)
  v_mfma_f32_16x16x32_bf16 v[152:155], a[212:215], v[212:215], v[152:155]
  ds_read_b64_tr_b16 a[208:209], v9 offset:768
  ds_read_b64_tr_b16 a[210:211], v9 offset:1792
  v_mfma_f32_16x16x32_bf16 v[28:31], a[216:219], v[176:179], v[28:31]
  ds_read_b64_tr_b16 a[212:213], v9 offset:8960
  v_mfma_f32_16x16x32_bf16 v[28:31], a[220:223], v[180:183], v[28:31]
  ds_read_b64_tr_b16 a[214:215], v9 offset:9984
  v_mfma_f32_16x16x32_bf16 v[60:63], a[216:219], v[184:187], v[60:63]
  buffer_load_dwordx4 v222, s[4:7], s66 offen offset:2048 lds
  v_mfma_f32_16x16x32_bf16 v[60:63], a[220:223], v[188:191], v[60:63]
  v_mfma_f32_16x16x32_bf16 v[92:95], a[216:219], v[192:195], v[92:95]
  v_mfma_f32_16x16x32_bf16 v[92:95], a[220:223], v[196:199], v[92:95]
  v_mfma_f32_16x16x32_bf16 v[124:127], a[216:219], v[200:203], v[124:127]
  v_mfma_f32_16x16x32_bf16 v[124:127], a[220:223], v[204:207], v[124:127]
  buffer_load_dwordx4 v223, s[4:7], s66 offen offset:3072 lds
  v_mfma_f32_16x16x32_bf16 v[156:159], a[216:219], v[208:211], v[156:159]
  s_waitcnt lgkmcnt(8)
  v_mfma_f32_16x16x32_bf16 v[156:159], a[220:223], v[212:215], v[156:159]
  ds_read_b64_tr_b16 a[216:217], v10 offset:768
  ds_read_b64_tr_b16 a[218:219], v10 offset:1792
  v_mfma_f32_16x16x32_bf16 v[32:35], a[192:195], v[176:179], v[32:35]
  ds_read_b64_tr_b16 a[220:221], v10 offset:8960
  s_add_u32 m0, s69, 0x22000
  v_mfma_f32_16x16x32_bf16 v[32:35], a[196:199], v[180:183], v[32:35]
  ds_read_b64_tr_b16 a[222:223], v10 offset:9984
  v_mfma_f32_16x16x32_bf16 v[64:67], a[192:195], v[184:187], v[64:67]
  buffer_load_dwordx4 v246, s[4:7], s66 offen lds
  v_mfma_f32_16x16x32_bf16 v[64:67], a[196:199], v[188:191], v[64:67]
  v_mfma_f32_16x16x32_bf16 v[96:99], a[192:195], v[192:195], v[96:99]
  v_mfma_f32_16x16x32_bf16 v[96:99], a[196:199], v[196:199], v[96:99]
  v_add_u32 v242, 0xd000, v242
  v_add_u32 v243, 0xd000, v243
  v_add_u32 v9, 0xd000, v9
  v_mfma_f32_16x16x32_bf16 v[128:131], a[192:195], v[200:203], v[128:131]
  s_waitcnt lgkmcnt(8)
  v_add_u32 v10, 0xd000, v10
  v_mfma_f32_16x16x32_bf16 v[128:131], a[196:199], v[204:207], v[128:131]
  v_mfma_f32_16x16x32_bf16 v[36:39], a[200:203], v[176:179], v[36:39]
  v_mfma_f32_16x16x32_bf16 v[36:39], a[204:207], v[180:183], v[36:39]
  s_waitcnt vmcnt(13) lgkmcnt(0)
  v_mfma_f32_16x16x32_bf16 v[68:71], a[200:203], v[184:187], v[68:71]
  s_barrier
  v_mfma_f32_16x16x32_bf16 v[68:71], a[204:207], v[188:191], v[68:71]
  ds_read_b64_tr_b16 a[192:193], v242
  ds_read_b64_tr_b16 a[194:195], v242 offset:1024
  v_mfma_f32_16x16x32_bf16 v[100:103], a[200:203], v[192:195], v[100:103]
  ds_read_b64_tr_b16 a[196:197], v242 offset:8192
  s_add_u32 s42, s98, 0
  v_mfma_f32_16x16x32_bf16 v[100:103], a[204:207], v[196:199], v[100:103]
  ds_read_b64_tr_b16 a[198:199], v242 offset:9216
  s_and_b32 s42, s42, 0x3ffff
  v_mfma_f32_16x16x32_bf16 v[132:135], a[200:203], v[200:203], v[132:135]
  ds_read_b128 a[160:163], v240
  s_waitcnt lgkmcnt(15)
  v_mfma_f32_16x16x32_bf16 v[132:135], a[204:207], v[204:207], v[132:135]
  ds_read_b128 a[164:167], v240 offset:512
  s_add_u32 m0, s75, 0
  v_mfma_f32_16x16x32_bf16 v[40:43], a[208:211], v[176:179], v[40:43]
  ds_read_b128 a[168:171], v240 offset:2048
  v_mfma_f32_16x16x32_bf16 v[40:43], a[212:215], v[180:183], v[40:43]
  ds_read_b128 a[172:175], v240 offset:2560
  ds_read_b128 a[176:179], v240 offset:4096
  v_mfma_f32_16x16x32_bf16 v[72:75], a[208:211], v[184:187], v[72:75]
  ds_read_b128 a[180:183], v240 offset:4608
  v_mfma_f32_16x16x32_bf16 v[72:75], a[212:215], v[188:191], v[72:75]
  ds_read_b128 a[184:187], v240 offset:6144
  ds_read_b128 a[188:191], v240 offset:6656
  v_mfma_f32_16x16x32_bf16 v[104:107], a[208:211], v[192:195], v[104:107]
  ds_read_b128 v[232:235], v241
  v_mfma_f32_16x16x32_bf16 v[104:107], a[212:215], v[196:199], v[104:107]
  buffer_load_dwordx4 v7, s[12:15], s42 offen nt lds
  v_mfma_f32_16x16x32_bf16 v[136:139], a[208:211], v[200:203], v[136:139]
  ds_read_b128 v[236:239], v241 offset:512
  s_waitcnt lgkmcnt(15)
  v_mfma_f32_16x16x32_bf16 v[136:139], a[212:215], v[204:207], v[136:139]
  v_mfma_f32_16x16x32_bf16 v[44:47], a[216:219], v[176:179], v[44:47]
  buffer_load_dwordx4 v7, s[12:15], s42 offen offset:1024 nt lds
  v_mfma_f32_16x16x32_bf16 v[44:47], a[220:223], v[180:183], v[44:47]
  v_mfma_f32_16x16x32_bf16 v[76:79], a[216:219], v[184:187], v[76:79]
  buffer_load_dwordx4 v8, s[12:15], s42 offen offset:2048 nt lds
  v_mfma_f32_16x16x32_bf16 v[76:79], a[220:223], v[188:191], v[76:79]
  v_mfma_f32_16x16x32_bf16 v[108:111], a[216:219], v[192:195], v[108:111]
  buffer_load_dwordx4 v8, s[12:15], s42 offen offset:3072 nt lds
  v_mfma_f32_16x16x32_bf16 v[108:111], a[220:223], v[196:199], v[108:111]
  v_mfma_f32_16x16x32_bf16 v[140:143], a[216:219], v[200:203], v[140:143]
  v_mfma_f32_16x16x32_bf16 v[140:143], a[220:223], v[204:207], v[140:143]
  s_waitcnt lgkmcnt(0)
  v_mfma_f32_16x16x32_bf16 v[16:19], a[192:195], a[160:163], v[16:19]
  ds_read_b64_tr_b16 a[200:201], v243
  v_lshlrev_b32 v249, 4, v14
  v_mfma_f32_16x16x32_bf16 v[16:19], a[196:199], a[164:167], v[16:19]
  ds_read_b64_tr_b16 a[202:203], v243 offset:1024
  v_add_u32 v249, s75, v249
  v_mfma_f32_16x16x32_bf16 v[48:51], a[192:195], a[168:171], v[48:51]
  ds_read_b64_tr_b16 a[204:205], v243 offset:8192
  s_add_u32 s42, s98, 0x4000
  v_mfma_f32_16x16x32_bf16 v[48:51], a[196:199], a[172:175], v[48:51]
  ds_read_b64_tr_b16 a[206:207], v243 offset:9216
  s_and_b32 s42, s42, 0x3ffff
  v_mfma_f32_16x16x32_bf16 v[80:83], a[192:195], a[176:179], v[80:83]
  ds_read_b64_tr_b16 a[208:209], v242 offset:256
  s_add_u32 m0, s75, 0x4000
  v_mfma_f32_16x16x32_bf16 v[80:83], a[196:199], a[180:183], v[80:83]
  ds_read_b64_tr_b16 a[210:211], v242 offset:1280
  v_add_u32 v240, 0xd000, v240
  v_mfma_f32_16x16x32_bf16 v[112:115], a[192:195], a[184:187], v[112:115]
  ds_read_b64_tr_b16 a[212:213], v242 offset:8448
  v_add_u32 v241, 0xd000, v241
  v_mfma_f32_16x16x32_bf16 v[112:115], a[196:199], a[188:191], v[112:115]
  ds_read_b64_tr_b16 a[214:215], v242 offset:9472
  v_mfma_f32_16x16x32_bf16 v[144:147], a[192:195], v[232:235], v[144:147]
  ds_read_b64_tr_b16 a[216:217], v243 offset:256
  s_waitcnt lgkmcnt(5)
  v_mfma_f32_16x16x32_bf16 v[144:147], a[196:199], v[236:239], v[144:147]
  ds_read_b64_tr_b16 a[218:219], v243 offset:1280
  ds_read_b64_tr_b16 a[220:221], v243 offset:8448
  v_mfma_f32_16x16x32_bf16 v[20:23], a[200:203], a[160:163], v[20:23]
  ds_read_b64_tr_b16 a[222:223], v243 offset:9472
  v_mfma_f32_16x16x32_bf16 v[20:23], a[204:207], a[164:167], v[20:23]
  ds_read_b64_tr_b16 a[192:193], v9 offset:512
  ds_read_b64_tr_b16 a[194:195], v9 offset:1536
  v_mfma_f32_16x16x32_bf16 v[52:55], a[200:203], a[168:171], v[52:55]
  ds_read_b64_tr_b16 a[196:197], v9 offset:8704
  v_mfma_f32_16x16x32_bf16 v[52:55], a[204:207], a[172:175], v[52:55]
  ds_read_b64_tr_b16 a[198:199], v9 offset:9728
  v_mfma_f32_16x16x32_bf16 v[84:87], a[200:203], a[176:179], v[84:87]
  buffer_load_dwordx4 v7, s[12:15], s42 offen nt lds
  v_mfma_f32_16x16x32_bf16 v[84:87], a[204:207], a[180:183], v[84:87]
  v_mfma_f32_16x16x32_bf16 v[116:119], a[200:203], a[184:187], v[116:119]
  buffer_load_dwordx4 v7, s[12:15], s42 offen offset:1024 nt lds
  v_mfma_f32_16x16x32_bf16 v[116:119], a[204:207], a[188:191], v[116:119]
  v_mfma_f32_16x16x32_bf16 v[148:151], a[200:203], v[232:235], v[148:151]
  s_waitcnt lgkmcnt(8)
  v_mfma_f32_16x16x32_bf16 v[148:151], a[204:207], v[236:239], v[148:151]
  ds_read_b64_tr_b16 a[200:201], v10 offset:512
  ds_read_b64_tr_b16 a[202:203], v10 offset:1536
  v_mfma_f32_16x16x32_bf16 v[24:27], a[208:211], a[160:163], v[24:27]
  ds_read_b64_tr_b16 a[204:205], v10 offset:8704
  v_mfma_f32_16x16x32_bf16 v[24:27], a[212:215], a[164:167], v[24:27]
  ds_read_b64_tr_b16 a[206:207], v10 offset:9728
  v_mfma_f32_16x16x32_bf16 v[56:59], a[208:211], a[168:171], v[56:59]
  v_mfma_f32_16x16x32_bf16 v[56:59], a[212:215], a[172:175], v[56:59]
  v_mfma_f32_16x16x32_bf16 v[88:91], a[208:211], a[176:179], v[88:91]
  buffer_load_dwordx4 v8, s[12:15], s42 offen offset:2048 nt lds
  v_mfma_f32_16x16x32_bf16 v[88:91], a[212:215], a[180:183], v[88:91]
  v_mfma_f32_16x16x32_bf16 v[120:123], a[208:211], a[184:187], v[120:123]
  v_mfma_f32_16x16x32_bf16 v[120:123], a[212:215], a[188:191], v[120:123]
  v_mfma_f32_16x16x32_bf16 v[152:155], a[208:211], v[232:235], v[152:155]
  s_waitcnt lgkmcnt(8)
  v_mfma_f32_16x16x32_bf16 v[152:155], a[212:215], v[236:239], v[152:155]
  ds_read_b64_tr_b16 a[208:209], v9 offset:768
  ds_read_b64_tr_b16 a[210:211], v9 offset:1792
  v_mfma_f32_16x16x32_bf16 v[28:31], a[216:219], a[160:163], v[28:31]
  ds_read_b64_tr_b16 a[212:213], v9 offset:8960
  v_mfma_f32_16x16x32_bf16 v[28:31], a[220:223], a[164:167], v[28:31]
  ds_read_b64_tr_b16 a[214:215], v9 offset:9984
  v_mfma_f32_16x16x32_bf16 v[60:63], a[216:219], a[168:171], v[60:63]
  v_mfma_f32_16x16x32_bf16 v[60:63], a[220:223], a[172:175], v[60:63]
  v_mfma_f32_16x16x32_bf16 v[92:95], a[216:219], a[176:179], v[92:95]
  v_mfma_f32_16x16x32_bf16 v[92:95], a[220:223], a[180:183], v[92:95]
  v_mfma_f32_16x16x32_bf16 v[124:127], a[216:219], a[184:187], v[124:127]
  buffer_load_dwordx4 v8, s[12:15], s42 offen offset:3072 nt lds
  v_mfma_f32_16x16x32_bf16 v[124:127], a[220:223], a[188:191], v[124:127]
  v_mfma_f32_16x16x32_bf16 v[156:159], a[216:219], v[232:235], v[156:159]
  s_waitcnt lgkmcnt(8)
  v_mfma_f32_16x16x32_bf16 v[156:159], a[220:223], v[236:239], v[156:159]
  ds_read_b64_tr_b16 a[216:217], v10 offset:768
  ds_read_b64_tr_b16 a[218:219], v10 offset:1792
  v_mfma_f32_16x16x32_bf16 v[32:35], a[192:195], a[160:163], v[32:35]
  ds_read_b64_tr_b16 a[220:221], v10 offset:8960
  v_mfma_f32_16x16x32_bf16 v[32:35], a[196:199], a[164:167], v[32:35]
  ds_read_b64_tr_b16 a[222:223], v10 offset:9984
  v_mfma_f32_16x16x32_bf16 v[64:67], a[192:195], a[168:171], v[64:67]
  v_mfma_f32_16x16x32_bf16 v[64:67], a[196:199], a[172:175], v[64:67]
  v_mfma_f32_16x16x32_bf16 v[96:99], a[192:195], a[176:179], v[96:99]
  v_mfma_f32_16x16x32_bf16 v[96:99], a[196:199], a[180:183], v[96:99]
  v_add_u32 v242, 0xd000, v242
  v_add_u32 v243, 0xd000, v243
  v_add_u32 v9, 0xd000, v9
  v_mfma_f32_16x16x32_bf16 v[128:131], a[192:195], a[184:187], v[128:131]
  s_waitcnt lgkmcnt(8)
  v_add_u32 v10, 0xd000, v10
  v_mfma_f32_16x16x32_bf16 v[128:131], a[196:199], a[188:191], v[128:131]
  v_mfma_f32_16x16x32_bf16 v[36:39], a[200:203], a[160:163], v[36:39]
  v_mfma_f32_16x16x32_bf16 v[36:39], a[204:207], a[164:167], v[36:39]
  s_waitcnt vmcnt(8) lgkmcnt(0)
  v_mfma_f32_16x16x32_bf16 v[68:71], a[200:203], a[168:171], v[68:71]
  s_barrier
  v_mfma_f32_16x16x32_bf16 v[68:71], a[204:207], a[172:175], v[68:71]
  ds_read_b64_tr_b16 a[192:193], v242
  ds_read_b64_tr_b16 a[194:195], v242 offset:1024
  v_mfma_f32_16x16x32_bf16 v[100:103], a[200:203], a[176:179], v[100:103]
  ds_read_b64_tr_b16 a[196:197], v242 offset:8192
  s_add_u32 s42, s98, 0
  v_mfma_f32_16x16x32_bf16 v[100:103], a[204:207], a[180:183], v[100:103]
  ds_read_b64_tr_b16 a[198:199], v242 offset:9216
  s_and_b32 s42, s42, 0x3ffff
  v_mfma_f32_16x16x32_bf16 v[132:135], a[200:203], a[184:187], v[132:135]
  ds_read_b128 v[176:179], v240
  s_waitcnt lgkmcnt(15)
  v_mfma_f32_16x16x32_bf16 v[132:135], a[204:207], a[188:191], v[132:135]
  ds_read_b128 v[180:183], v240 offset:512
  s_add_u32 m0, s75, 0x10000
  v_mfma_f32_16x16x32_bf16 v[40:43], a[208:211], a[160:163], v[40:43]
  ds_read_b128 v[184:187], v240 offset:2048
  v_mfma_f32_16x16x32_bf16 v[40:43], a[212:215], a[164:167], v[40:43]
  ds_read_b128 v[188:191], v240 offset:2560
  ds_read_b128 v[192:195], v240 offset:4096
  v_mfma_f32_16x16x32_bf16 v[72:75], a[208:211], a[168:171], v[72:75]
  ds_read_b128 v[196:199], v240 offset:4608
  v_mfma_f32_16x16x32_bf16 v[72:75], a[212:215], a[172:175], v[72:75]
  ds_read_b128 v[200:203], v240 offset:6144
  ds_read_b128 v[204:207], v240 offset:6656
  v_mfma_f32_16x16x32_bf16 v[104:107], a[208:211], a[176:179], v[104:107]
  ds_read_b128 v[208:211], v241
  v_mfma_f32_16x16x32_bf16 v[104:107], a[212:215], a[180:183], v[104:107]
  ds_read_b128 v[212:215], v241 offset:512
  v_mfma_f32_16x16x32_bf16 v[136:139], a[208:211], a[184:187], v[136:139]
  buffer_load_dwordx4 v7, s[16:19], s42 offen nt lds
  v_mfma_f32_16x16x32_bf16 v[136:139], a[212:215], a[188:191], v[136:139]
  s_waitcnt lgkmcnt(15)
  v_mfma_f32_16x16x32_bf16 v[44:47], a[216:219], a[160:163], v[44:47]
  buffer_load_dwordx4 v8, s[16:19], s42 offen offset:1024 nt lds
  v_mfma_f32_16x16x32_bf16 v[44:47], a[220:223], a[164:167], v[44:47]
  v_mfma_f32_16x16x32_bf16 v[76:79], a[216:219], a[168:171], v[76:79]
  v_mfma_f32_16x16x32_bf16 v[76:79], a[220:223], a[172:175], v[76:79]
  v_mfma_f32_16x16x32_bf16 v[108:111], a[216:219], a[176:179], v[108:111]
  v_mfma_f32_16x16x32_bf16 v[108:111], a[220:223], a[180:183], v[108:111]
  v_mfma_f32_16x16x32_bf16 v[140:143], a[216:219], a[184:187], v[140:143]
  v_mfma_f32_16x16x32_bf16 v[140:143], a[220:223], a[188:191], v[140:143]
  s_waitcnt lgkmcnt(0)
  v_mfma_f32_16x16x32_bf16 v[16:19], a[192:195], v[176:179], v[16:19]
  ds_read_b64_tr_b16 a[200:201], v243
  v_add_u32 v249, 0x10000, v249
  v_mfma_f32_16x16x32_bf16 v[16:19], a[196:199], v[180:183], v[16:19]
  ds_read_b64_tr_b16 a[202:203], v243 offset:1024
  s_add_u32 s42, s98, 0
  v_mfma_f32_16x16x32_bf16 v[48:51], a[192:195], v[184:187], v[48:51]
  ds_read_b64_tr_b16 a[204:205], v243 offset:8192
  s_and_b32 s42, s42, 0x3ffff
  v_mfma_f32_16x16x32_bf16 v[48:51], a[196:199], v[188:191], v[48:51]
  ds_read_b64_tr_b16 a[206:207], v243 offset:9216
  s_add_u32 m0, s75, 0x10000
  v_mfma_f32_16x16x32_bf16 v[80:83], a[192:195], v[192:195], v[80:83]
  ds_read_b64_tr_b16 a[208:209], v242 offset:256
  v_mfma_f32_16x16x32_bf16 v[80:83], a[196:199], v[196:199], v[80:83]
  ds_read_b64_tr_b16 a[210:211], v242 offset:1280
  ds_read_b64_tr_b16 a[212:213], v242 offset:8448
  v_mfma_f32_16x16x32_bf16 v[112:115], a[192:195], v[200:203], v[112:115]
  ds_read_b64_tr_b16 a[214:215], v242 offset:9472
  v_mfma_f32_16x16x32_bf16 v[112:115], a[196:199], v[204:207], v[112:115]
  ds_read_b64_tr_b16 a[216:217], v243 offset:256
  ds_read_b64_tr_b16 a[218:219], v243 offset:1280
  v_mfma_f32_16x16x32_bf16 v[144:147], a[192:195], v[208:211], v[144:147]
  ds_read_b64_tr_b16 a[220:221], v243 offset:8448
  s_waitcnt lgkmcnt(7)
  v_mfma_f32_16x16x32_bf16 v[144:147], a[196:199], v[212:215], v[144:147]
  ds_read_b64_tr_b16 a[222:223], v243 offset:9472
  v_mfma_f32_16x16x32_bf16 v[20:23], a[200:203], v[176:179], v[20:23]
  ds_read_b64_tr_b16 a[192:193], v9 offset:512
  ds_read_b64_tr_b16 a[194:195], v9 offset:1536
  v_mfma_f32_16x16x32_bf16 v[20:23], a[204:207], v[180:183], v[20:23]
  ds_read_b64_tr_b16 a[196:197], v9 offset:8704
  v_mfma_f32_16x16x32_bf16 v[52:55], a[200:203], v[184:187], v[52:55]
  ds_read_b64_tr_b16 a[198:199], v9 offset:9728
  v_mfma_f32_16x16x32_bf16 v[52:55], a[204:207], v[188:191], v[52:55]
  buffer_load_dwordx4 v7, s[16:19], s42 offen offset:2048 nt lds
  v_mfma_f32_16x16x32_bf16 v[84:87], a[200:203], v[192:195], v[84:87]
  v_mfma_f32_16x16x32_bf16 v[84:87], a[204:207], v[196:199], v[84:87]
  buffer_load_dwordx4 v8, s[16:19], s42 offen offset:3072 nt lds
  v_mfma_f32_16x16x32_bf16 v[116:119], a[200:203], v[200:203], v[116:119]
  v_mfma_f32_16x16x32_bf16 v[116:119], a[204:207], v[204:207], v[116:119]
  v_mfma_f32_16x16x32_bf16 v[148:151], a[200:203], v[208:211], v[148:151]
  s_waitcnt lgkmcnt(8)
  v_mfma_f32_16x16x32_bf16 v[148:151], a[204:207], v[212:215], v[148:151]
  ds_read_b64_tr_b16 a[200:201], v10 offset:512
  ds_read_b64_tr_b16 a[202:203], v10 offset:1536
  v_mfma_f32_16x16x32_bf16 v[24:27], a[208:211], v[176:179], v[24:27]
  ds_read_b64_tr_b16 a[204:205], v10 offset:8704
  v_mfma_f32_16x16x32_bf16 v[24:27], a[212:215], v[180:183], v[24:27]
  ds_read_b64_tr_b16 a[206:207], v10 offset:9728
  s_add_u32 s42, s98, 0x8000
  s_and_b32 s42, s42, 0x3ffff
  v_mfma_f32_16x16x32_bf16 v[56:59], a[208:211], v[184:187], v[56:59]
  s_add_u32 m0, s75, 0x8000
  v_mfma_f32_16x16x32_bf16 v[56:59], a[212:215], v[188:191], v[56:59]
  v_mfma_f32_16x16x32_bf16 v[88:91], a[208:211], v[192:195], v[88:91]
  buffer_load_dwordx4 v7, s[12:15], s42 offen nt lds
  v_mfma_f32_16x16x32_bf16 v[88:91], a[212:215], v[196:199], v[88:91]
  v_mfma_f32_16x16x32_bf16 v[120:123], a[208:211], v[200:203], v[120:123]
  v_mfma_f32_16x16x32_bf16 v[120:123], a[212:215], v[204:207], v[120:123]
  v_mfma_f32_16x16x32_bf16 v[152:155], a[208:211], v[208:211], v[152:155]
  s_waitcnt lgkmcnt(8)
  v_mfma_f32_16x16x32_bf16 v[152:155], a[212:215], v[212:215], v[152:155]
  ds_read_b64_tr_b16 a[208:209], v9 offset:768
  ds_read_b64_tr_b16 a[210:211], v9 offset:1792
  v_mfma_f32_16x16x32_bf16 v[28:31], a[216:219], v[176:179], v[28:31]
  ds_read_b64_tr_b16 a[212:213], v9 offset:8960
  v_mfma_f32_16x16x32_bf16 v[28:31], a[220:223], v[180:183], v[28:31]
  ds_read_b64_tr_b16 a[214:215], v9 offset:9984
  v_mfma_f32_16x16x32_bf16 v[60:63], a[216:219], v[184:187], v[60:63]
  v_mfma_f32_16x16x32_bf16 v[60:63], a[220:223], v[188:191], v[60:63]
  v_mfma_f32_16x16x32_bf16 v[92:95], a[216:219], v[192:195], v[92:95]
  v_mfma_f32_16x16x32_bf16 v[92:95], a[220:223], v[196:199], v[92:95]
  buffer_load_dwordx4 v7, s[12:15], s42 offen offset:1024 nt lds
  v_mfma_f32_16x16x32_bf16 v[124:127], a[216:219], v[200:203], v[124:127]
  v_mfma_f32_16x16x32_bf16 v[124:127], a[220:223], v[204:207], v[124:127]
  v_mfma_f32_16x16x32_bf16 v[156:159], a[216:219], v[208:211], v[156:159]
  s_waitcnt lgkmcnt(8)
  v_mfma_f32_16x16x32_bf16 v[156:159], a[220:223], v[212:215], v[156:159]
  ds_read_b64_tr_b16 a[216:217], v10 offset:768
  ds_read_b64_tr_b16 a[218:219], v10 offset:1792
  v_mfma_f32_16x16x32_bf16 v[32:35], a[192:195], v[176:179], v[32:35]
  ds_read_b64_tr_b16 a[220:221], v10 offset:8960
  v_xor_b32 v240, 0x200, v1
  v_mfma_f32_16x16x32_bf16 v[32:35], a[196:199], v[180:183], v[32:35]
  ds_read_b64_tr_b16 a[222:223], v10 offset:9984
  v_xor_b32 v241, 0x200, v2
  v_mfma_f32_16x16x32_bf16 v[64:67], a[192:195], v[184:187], v[64:67]
  v_mfma_f32_16x16x32_bf16 v[64:67], a[196:199], v[188:191], v[64:67]
  v_mfma_f32_16x16x32_bf16 v[96:99], a[192:195], v[192:195], v[96:99]
  v_mfma_f32_16x16x32_bf16 v[96:99], a[196:199], v[196:199], v[96:99]
  v_mfma_f32_16x16x32_bf16 v[128:131], a[192:195], v[200:203], v[128:131]
  s_waitcnt lgkmcnt(8)
  v_mfma_f32_16x16x32_bf16 v[128:131], a[196:199], v[204:207], v[128:131]
  buffer_load_dwordx4 v8, s[12:15], s42 offen offset:2048 nt lds
  v_mfma_f32_16x16x32_bf16 v[36:39], a[200:203], v[176:179], v[36:39]
  v_mfma_f32_16x16x32_bf16 v[36:39], a[204:207], v[180:183], v[36:39]
  v_mfma_f32_16x16x32_bf16 v[68:71], a[200:203], v[184:187], v[68:71]
  v_mfma_f32_16x16x32_bf16 v[68:71], a[204:207], v[188:191], v[68:71]
  v_mfma_f32_16x16x32_bf16 v[100:103], a[200:203], v[192:195], v[100:103]
  v_mfma_f32_16x16x32_bf16 v[100:103], a[204:207], v[196:199], v[100:103]
  v_mfma_f32_16x16x32_bf16 v[132:135], a[200:203], v[200:203], v[132:135]
  s_waitcnt lgkmcnt(4)
  v_mfma_f32_16x16x32_bf16 v[132:135], a[204:207], v[204:207], v[132:135]
  v_mfma_f32_16x16x32_bf16 v[40:43], a[208:211], v[176:179], v[40:43]
  v_mfma_f32_16x16x32_bf16 v[40:43], a[212:215], v[180:183], v[40:43]
  v_mfma_f32_16x16x32_bf16 v[72:75], a[208:211], v[184:187], v[72:75]
  buffer_load_dwordx4 v8, s[12:15], s42 offen offset:3072 nt lds
  v_mfma_f32_16x16x32_bf16 v[72:75], a[212:215], v[188:191], v[72:75]
  v_mfma_f32_16x16x32_bf16 v[104:107], a[208:211], v[192:195], v[104:107]
  v_mfma_f32_16x16x32_bf16 v[104:107], a[212:215], v[196:199], v[104:107]
  v_mfma_f32_16x16x32_bf16 v[136:139], a[208:211], v[200:203], v[136:139]
  s_waitcnt lgkmcnt(0)
  v_mfma_f32_16x16x32_bf16 v[136:139], a[212:215], v[204:207], v[136:139]
  v_mfma_f32_16x16x32_bf16 v[44:47], a[216:219], v[176:179], v[44:47]
  v_mfma_f32_16x16x32_bf16 v[44:47], a[220:223], v[180:183], v[44:47]
  v_mfma_f32_16x16x32_bf16 v[76:79], a[216:219], v[184:187], v[76:79]
  v_mfma_f32_16x16x32_bf16 v[76:79], a[220:223], v[188:191], v[76:79]
  v_mfma_f32_16x16x32_bf16 v[108:111], a[216:219], v[192:195], v[108:111]
  v_mfma_f32_16x16x32_bf16 v[108:111], a[220:223], v[196:199], v[108:111]
  v_mfma_f32_16x16x32_bf16 v[140:143], a[216:219], v[200:203], v[140:143]
  v_mfma_f32_16x16x32_bf16 v[140:143], a[220:223], v[204:207], v[140:143]
  s_add_u32 s4, s60, 0
  s_addc_u32 s5, s61, 0
  s_mov_b32 s6, 32
  s_mov_b32 s7, 0x20000
  v_lshlrev_b32 v255, 2, v14
  buffer_load_dword v15, v255, s[4:7], 0 offen sc1
  s_lshl_b32 s42, s3, 11
  s_add_u32 s42, s42, 0x18000
  v_lshl_add_u32 v249, v14, 4, s42
  v_pk_mul_f32 v[144:145], v[144:145], s[64:65]
  v_pk_mul_f32 v[146:147], v[146:147], s[64:65]
  v_pk_mul_f32 v[148:149], v[148:149], s[64:65]
  v_pk_mul_f32 v[150:151], v[150:151], s[64:65]
  v_cvt_pk_bf16_f32 v144, v144, v145
  v_cvt_pk_bf16_f32 v145, v146, v147
  v_cvt_pk_bf16_f32 v146, v148, v149
  v_cvt_pk_bf16_f32 v147, v150, v151
  v_pk_mul_f32 v[152:153], v[152:153], s[64:65]
  v_pk_mul_f32 v[154:155], v[154:155], s[64:65]
  v_pk_mul_f32 v[156:157], v[156:157], s[64:65]
  v_pk_mul_f32 v[158:159], v[158:159], s[64:65]
  v_cvt_pk_bf16_f32 v152, v152, v153
  v_cvt_pk_bf16_f32 v153, v154, v155
  v_cvt_pk_bf16_f32 v154, v156, v157
  v_cvt_pk_bf16_f32 v155, v158, v159
  ds_write_b128 v249, v[144:147]
  ds_write_b128 v249, v[152:155] offset:1024
  v_xor_b32 v249, 0x1000, v249
  v_pk_mul_f32 v[16:17], v[16:17], s[64:65]
  v_pk_mul_f32 v[18:19], v[18:19], s[64:65]
  v_pk_mul_f32 v[20:21], v[20:21], s[64:65]
  v_pk_mul_f32 v[22:23], v[22:23], s[64:65]
  v_cvt_pk_bf16_f32 v16, v16, v17
  v_cvt_pk_bf16_f32 v17, v18, v19
  v_cvt_pk_bf16_f32 v18, v20, v21
  v_cvt_pk_bf16_f32 v19, v22, v23
  v_pk_mul_f32 v[24:25], v[24:25], s[64:65]
  v_pk_mul_f32 v[26:27], v[26:27], s[64:65]
  v_pk_mul_f32 v[28:29], v[28:29], s[64:65]
  v_pk_mul_f32 v[30:31], v[30:31], s[64:65]
  v_cvt_pk_bf16_f32 v24, v24, v25
  v_cvt_pk_bf16_f32 v25, v26, v27
  v_cvt_pk_bf16_f32 v26, v28, v29
  v_cvt_pk_bf16_f32 v27, v30, v31
  v_pk_mul_f32 v[32:33], v[32:33], s[64:65]
  v_pk_mul_f32 v[34:35], v[34:35], s[64:65]
  v_pk_mul_f32 v[36:37], v[36:37], s[64:65]
  v_pk_mul_f32 v[38:39], v[38:39], s[64:65]
  v_cvt_pk_bf16_f32 v32, v32, v33
  v_cvt_pk_bf16_f32 v33, v34, v35
  v_cvt_pk_bf16_f32 v34, v36, v37
  v_cvt_pk_bf16_f32 v35, v38, v39
  v_pk_mul_f32 v[40:41], v[40:41], s[64:65]
  v_pk_mul_f32 v[42:43], v[42:43], s[64:65]
  v_pk_mul_f32 v[44:45], v[44:45], s[64:65]
  v_pk_mul_f32 v[46:47], v[46:47], s[64:65]
  v_cvt_pk_bf16_f32 v40, v40, v41
  v_cvt_pk_bf16_f32 v41, v42, v43
  v_cvt_pk_bf16_f32 v42, v44, v45
  v_cvt_pk_bf16_f32 v43, v46, v47
  v_pk_mul_f32 v[48:49], v[48:49], s[64:65]
  v_pk_mul_f32 v[50:51], v[50:51], s[64:65]
  v_pk_mul_f32 v[52:53], v[52:53], s[64:65]
  v_pk_mul_f32 v[54:55], v[54:55], s[64:65]
  v_cvt_pk_bf16_f32 v48, v48, v49
  v_cvt_pk_bf16_f32 v49, v50, v51
  v_cvt_pk_bf16_f32 v50, v52, v53
  v_cvt_pk_bf16_f32 v51, v54, v55
  v_pk_mul_f32 v[56:57], v[56:57], s[64:65]
  v_pk_mul_f32 v[58:59], v[58:59], s[64:65]
  v_pk_mul_f32 v[60:61], v[60:61], s[64:65]
  v_pk_mul_f32 v[62:63], v[62:63], s[64:65]
  v_cvt_pk_bf16_f32 v56, v56, v57
  v_cvt_pk_bf16_f32 v57, v58, v59
  v_cvt_pk_bf16_f32 v58, v60, v61
  v_cvt_pk_bf16_f32 v59, v62, v63
  v_pk_mul_f32 v[64:65], v[64:65], s[64:65]
  v_pk_mul_f32 v[66:67], v[66:67], s[64:65]
  v_pk_mul_f32 v[68:69], v[68:69], s[64:65]
  v_pk_mul_f32 v[70:71], v[70:71], s[64:65]
  v_cvt_pk_bf16_f32 v64, v64, v65
  v_cvt_pk_bf16_f32 v65, v66, v67
  v_cvt_pk_bf16_f32 v66, v68, v69
  v_cvt_pk_bf16_f32 v67, v70, v71
  v_pk_mul_f32 v[72:73], v[72:73], s[64:65]
  v_pk_mul_f32 v[74:75], v[74:75], s[64:65]
  v_pk_mul_f32 v[76:77], v[76:77], s[64:65]
  v_pk_mul_f32 v[78:79], v[78:79], s[64:65]
  v_cvt_pk_bf16_f32 v72, v72, v73
  v_cvt_pk_bf16_f32 v73, v74, v75
  v_cvt_pk_bf16_f32 v74, v76, v77
  v_cvt_pk_bf16_f32 v75, v78, v79
  s_waitcnt vmcnt(13) lgkmcnt(0)
  s_barrier
  ds_read_b128 v[160:163], v249
  ds_read_b128 v[168:171], v249 offset:1024
  ds_read_b128 a[160:163], v1
  ds_read_b128 a[164:167], v1 offset:256
  ds_read_b128 a[168:171], v240
  ds_read_b128 a[172:175], v240 offset:256
  ds_read_b128 a[176:179], v1 offset:4096
  ds_read_b128 a[180:183], v1 offset:4352
  ds_read_b128 a[184:187], v240 offset:4096
  ds_read_b128 a[188:191], v240 offset:4352
  s_add_u32 s42, s98, 0x4000
  s_and_b32 s42, s42, 0x3ffff
  s_add_u32 m0, s75, 0x14000
  s_nop 0
  buffer_load_dwordx4 v7, s[16:19], s42 offen nt lds
  v_pk_mul_f32 v[80:81], v[80:81], s[64:65]
  v_pk_mul_f32 v[82:83], v[82:83], s[64:65]
  v_pk_mul_f32 v[84:85], v[84:85], s[64:65]
  v_pk_mul_f32 v[86:87], v[86:87], s[64:65]
  v_cvt_pk_bf16_f32 v80, v80, v81
  v_cvt_pk_bf16_f32 v81, v82, v83
  v_cvt_pk_bf16_f32 v82, v84, v85
  v_cvt_pk_bf16_f32 v83, v86, v87
  v_pk_mul_f32 v[88:89], v[88:89], s[64:65]
  v_pk_mul_f32 v[90:91], v[90:91], s[64:65]
  v_pk_mul_f32 v[92:93], v[92:93], s[64:65]
  v_pk_mul_f32 v[94:95], v[94:95], s[64:65]
  v_cvt_pk_bf16_f32 v88, v88, v89
  v_cvt_pk_bf16_f32 v89, v90, v91
  v_cvt_pk_bf16_f32 v90, v92, v93
  v_cvt_pk_bf16_f32 v91, v94, v95
  buffer_load_dwordx4 v8, s[16:19], s42 offen offset:1024 nt lds
  v_pk_mul_f32 v[96:97], v[96:97], s[64:65]
  v_pk_mul_f32 v[98:99], v[98:99], s[64:65]
  v_pk_mul_f32 v[100:101], v[100:101], s[64:65]
  v_pk_mul_f32 v[102:103], v[102:103], s[64:65]
  v_cvt_pk_bf16_f32 v96, v96, v97
  v_cvt_pk_bf16_f32 v97, v98, v99
  v_cvt_pk_bf16_f32 v98, v100, v101
  v_cvt_pk_bf16_f32 v99, v102, v103
  v_pk_mul_f32 v[104:105], v[104:105], s[64:65]
  v_pk_mul_f32 v[106:107], v[106:107], s[64:65]
  v_pk_mul_f32 v[108:109], v[108:109], s[64:65]
  v_pk_mul_f32 v[110:111], v[110:111], s[64:65]
  v_cvt_pk_bf16_f32 v104, v104, v105
  v_cvt_pk_bf16_f32 v105, v106, v107
  v_cvt_pk_bf16_f32 v106, v108, v109
  v_cvt_pk_bf16_f32 v107, v110, v111
  buffer_load_dwordx4 v7, s[16:19], s42 offen offset:2048 nt lds
  v_pk_mul_f32 v[112:113], v[112:113], s[64:65]
  v_pk_mul_f32 v[114:115], v[114:115], s[64:65]
  v_pk_mul_f32 v[116:117], v[116:117], s[64:65]
  v_pk_mul_f32 v[118:119], v[118:119], s[64:65]
  v_cvt_pk_bf16_f32 v112, v112, v113
  v_cvt_pk_bf16_f32 v113, v114, v115
  v_cvt_pk_bf16_f32 v114, v116, v117
  v_cvt_pk_bf16_f32 v115, v118, v119
  v_pk_mul_f32 v[120:121], v[120:121], s[64:65]
  v_pk_mul_f32 v[122:123], v[122:123], s[64:65]
  v_pk_mul_f32 v[124:125], v[124:125], s[64:65]
  v_pk_mul_f32 v[126:127], v[126:127], s[64:65]
  v_cvt_pk_bf16_f32 v120, v120, v121
  v_cvt_pk_bf16_f32 v121, v122, v123
  v_cvt_pk_bf16_f32 v122, v124, v125
  v_cvt_pk_bf16_f32 v123, v126, v127
  buffer_load_dwordx4 v8, s[16:19], s42 offen offset:3072 nt lds
  v_pk_mul_f32 v[128:129], v[128:129], s[64:65]
  v_pk_mul_f32 v[130:131], v[130:131], s[64:65]
  v_pk_mul_f32 v[132:133], v[132:133], s[64:65]
  v_pk_mul_f32 v[134:135], v[134:135], s[64:65]
  v_cvt_pk_bf16_f32 v128, v128, v129
  v_cvt_pk_bf16_f32 v129, v130, v131
  v_cvt_pk_bf16_f32 v130, v132, v133
  v_cvt_pk_bf16_f32 v131, v134, v135
  v_pk_mul_f32 v[136:137], v[136:137], s[64:65]
  v_pk_mul_f32 v[138:139], v[138:139], s[64:65]
  v_pk_mul_f32 v[140:141], v[140:141], s[64:65]
  v_pk_mul_f32 v[142:143], v[142:143], s[64:65]
  v_cvt_pk_bf16_f32 v136, v136, v137
  v_cvt_pk_bf16_f32 v137, v138, v139
  v_cvt_pk_bf16_f32 v138, v140, v141
  v_cvt_pk_bf16_f32 v139, v142, v143
  v_mov_b32 v9, 0
  v_mov_b32 v10, 0
  v_mov_b32 v11, 0
  v_mov_b32 v12, 0
  v_mov_b32 v13, 0
  s_mov_b32 s72, 0xc000
  s_mov_b32 s73, 0x8000
  s_mov_b32 s74, s75
  s_mov_b32 s71, 7
  s_add_u32 s96, s72, s98
  s_and_b32 s96, s96, 0x3ffff
  s_and_b32 s47, s72, 0x40000
  s_or_b32 s96, s96, s47
  s_add_u32 s97, s73, s98
  s_and_b32 s97, s97, 0x3ffff
  s_and_b32 s47, s73, 0x40000
  s_or_b32 s97, s97, s47
  s_bfe_u32 s68, s2, 0x10000
  s_and_b32 s70, s2, 6
  s_bfe_u32 s42, s2, 0x10003
  s_add_u32 s70, s70, s42
  s_bfe_u32 s66, s2, 0x10004
  s_bfe_u32 s67, s2, 0x30005
  s_mov_b32 s69, s2
  v_mov_b32 v248, 1
  s_cmp_lg_u32 s39, 0
  s_cbranch_scc1 L_safe
  s_waitcnt lgkmcnt(0)
  v_mfma_f32_16x16x32_bf16 v[176:179], a[160:163], v[16:19], 0
  v_mfma_f32_16x16x32_bf16 v[176:179], a[164:167], v[24:27], v[176:179]
  v_mfma_f32_16x16x32_bf16 v[176:179], a[168:171], v[32:35], v[176:179]
  v_mfma_f32_16x16x32_bf16 v[176:179], a[172:175], v[40:43], v[176:179]
  v_mfma_f32_16x16x32_bf16 v[180:183], a[160:163], v[48:51], 0
  v_mfma_f32_16x16x32_bf16 v[180:183], a[164:167], v[56:59], v[180:183]
  v_mfma_f32_16x16x32_bf16 v[180:183], a[168:171], v[64:67], v[180:183]
  v_mfma_f32_16x16x32_bf16 v[180:183], a[172:175], v[72:75], v[180:183]
  v_mfma_f32_16x16x32_bf16 v[184:187], a[160:163], v[80:83], 0
  s_nop 2
  v_exp_f32 v176, v176
  v_mfma_f32_16x16x32_bf16 v[184:187], a[164:167], v[88:91], v[184:187]
  v_add_f32 v9, v176, v9
  v_mfma_f32_16x16x32_bf16 v[184:187], a[168:171], v[96:99], v[184:187]
  v_exp_f32 v177, v177
  v_mfma_f32_16x16x32_bf16 v[184:187], a[172:175], v[104:107], v[184:187]
  v_add_f32 v9, v177, v9
  v_mfma_f32_16x16x32_bf16 v[188:191], a[160:163], v[112:115], 0
  v_exp_f32 v178, v178
  v_mfma_f32_16x16x32_bf16 v[188:191], a[164:167], v[120:123], v[188:191]
  v_cvt_pk_bf16_f32 v36, v176, v177
  v_mfma_f32_16x16x32_bf16 v[188:191], a[168:171], v[128:131], v[188:191]
  v_exp_f32 v179, v179
  v_mfma_f32_16x16x32_bf16 v[188:191], a[172:175], v[136:139], v[188:191]
  v_add_f32 v9, v178, v9
  v_mfma_f32_16x16x32_bf16 v[192:195], a[160:163], v[144:147], 0
  v_add_f32 v9, v179, v9
  v_mfma_f32_16x16x32_bf16 v[192:195], a[164:167], v[152:155], v[192:195]
  v_mfma_f32_16x16x32_bf16 v[192:195], a[168:171], v[160:163], v[192:195]
  s_waitcnt lgkmcnt(15)
  v_exp_f32 v180, v180
  v_mfma_f32_16x16x32_bf16 v[192:195], a[172:175], v[168:171], v[192:195]
  v_exp_f32 v181, v181
  v_mfma_f32_16x16x32_bf16 v[196:199], a[176:179], v[16:19], 0
  v_exp_f32 v182, v182
  v_mfma_f32_16x16x32_bf16 v[196:199], a[180:183], v[24:27], v[196:199]
  ds_read_b128 a[160:163], v2
  v_cvt_pk_bf16_f32 v37, v178, v179
  v_mfma_f32_16x16x32_bf16 v[196:199], a[184:187], v[32:35], v[196:199]
  v_exp_f32 v183, v183
  v_mfma_f32_16x16x32_bf16 v[196:199], a[188:191], v[40:43], v[196:199]
  ds_read_b128 a[164:167], v2 offset:256
  v_cvt_pk_bf16_f32 v52, v180, v181
  v_mfma_f32_16x16x32_bf16 v[200:203], a[176:179], v[48:51], 0
  v_exp_f32 v184, v184
  v_mfma_f32_16x16x32_bf16 v[200:203], a[180:183], v[56:59], v[200:203]
  ds_read_b128 a[168:171], v241
  v_cvt_pk_bf16_f32 v53, v182, v183
  v_mfma_f32_16x16x32_bf16 v[200:203], a[184:187], v[64:67], v[200:203]
  v_exp_f32 v185, v185
  v_mfma_f32_16x16x32_bf16 v[200:203], a[188:191], v[72:75], v[200:203]
  ds_read_b128 a[172:175], v241 offset:256
  v_add_f32 v11, v184, v11
  v_mfma_f32_16x16x32_bf16 v[204:207], a[176:179], v[80:83], 0
  v_exp_f32 v186, v186
  v_mfma_f32_16x16x32_bf16 v[204:207], a[180:183], v[88:91], v[204:207]
  v_add_f32 v11, v185, v11
  v_mfma_f32_16x16x32_bf16 v[204:207], a[184:187], v[96:99], v[204:207]
  v_exp_f32 v187, v187
  v_mfma_f32_16x16x32_bf16 v[204:207], a[188:191], v[104:107], v[204:207]
  v_cvt_pk_bf16_f32 v68, v184, v185
  v_mfma_f32_16x16x32_bf16 v[208:211], a[176:179], v[112:115], 0
  v_exp_f32 v188, v188
  v_mfma_f32_16x16x32_bf16 v[208:211], a[180:183], v[120:123], v[208:211]
  v_add_f32 v11, v186, v11
  v_mfma_f32_16x16x32_bf16 v[208:211], a[184:187], v[128:131], v[208:211]
  v_add_f32 v11, v187, v11
  v_mfma_f32_16x16x32_bf16 v[208:211], a[188:191], v[136:139], v[208:211]
  v_mfma_f32_16x16x32_bf16 v[212:215], a[176:179], v[144:147], 0
  v_exp_f32 v189, v189
  v_mfma_f32_16x16x32_bf16 v[212:215], a[180:183], v[152:155], v[212:215]
  v_cvt_pk_bf16_f32 v69, v186, v187
  v_mfma_f32_16x16x32_bf16 v[212:215], a[184:187], v[160:163], v[212:215]
  s_waitcnt lgkmcnt(0)
  v_exp_f32 v190, v190
  v_mfma_f32_16x16x32_bf16 v[212:215], a[188:191], v[168:171], v[212:215]
  v_exp_f32 v191, v191
  v_mfma_f32_16x16x32_bf16 v[216:219], a[160:163], v[16:19], 0
  v_exp_f32 v192, v192
  v_mfma_f32_16x16x32_bf16 v[216:219], a[164:167], v[24:27], v[216:219]
  ds_read_b128 a[176:179], v2 offset:4096
  v_cvt_pk_bf16_f32 v84, v188, v189
  v_mfma_f32_16x16x32_bf16 v[216:219], a[168:171], v[32:35], v[216:219]
  v_exp_f32 v193, v193
  v_mfma_f32_16x16x32_bf16 v[216:219], a[172:175], v[40:43], v[216:219]
  ds_read_b128 a[180:183], v2 offset:4352
  v_cvt_pk_bf16_f32 v85, v190, v191
  v_mfma_f32_16x16x32_bf16 v[220:223], a[160:163], v[48:51], 0
  v_exp_f32 v194, v194
  v_mfma_f32_16x16x32_bf16 v[220:223], a[164:167], v[56:59], v[220:223]
  ds_read_b128 a[184:187], v241 offset:4096
  v_add_f32 v13, v192, v13
  v_mfma_f32_16x16x32_bf16 v[220:223], a[168:171], v[64:67], v[220:223]
  v_exp_f32 v195, v195
  v_mfma_f32_16x16x32_bf16 v[220:223], a[172:175], v[72:75], v[220:223]
  ds_read_b128 a[188:191], v241 offset:4352
  v_add_f32 v13, v193, v13
  v_mfma_f32_16x16x32_bf16 v[224:227], a[160:163], v[80:83], 0
  v_exp_f32 v196, v196
  v_mfma_f32_16x16x32_bf16 v[224:227], a[164:167], v[88:91], v[224:227]
  v_cvt_pk_bf16_f32 v100, v192, v193
  v_add_f32 v13, v194, v13
  v_mfma_f32_16x16x32_bf16 v[224:227], a[168:171], v[96:99], v[224:227]
  v_exp_f32 v197, v197
  v_mfma_f32_16x16x32_bf16 v[224:227], a[172:175], v[104:107], v[224:227]
  v_exp_f32 v198, v198
  v_mfma_f32_16x16x32_bf16 v[228:231], a[160:163], v[112:115], 0
  v_add_f32 v13, v195, v13
  v_mfma_f32_16x16x32_bf16 v[228:231], a[164:167], v[120:123], v[228:231]
  v_mfma_f32_16x16x32_bf16 v[228:231], a[168:171], v[128:131], v[228:231]
  s_waitcnt lgkmcnt(0)
  v_exp_f32 v199, v199
  v_mfma_f32_16x16x32_bf16 v[228:231], a[172:175], v[136:139], v[228:231]
  v_cvt_pk_bf16_f32 v101, v194, v195
  v_mfma_f32_16x16x32_bf16 v[232:235], a[176:179], v[16:19], 0
  v_exp_f32 v200, v200
  v_mfma_f32_16x16x32_bf16 v[232:235], a[180:183], v[24:27], v[232:235]
  v_add_f32 v9, v196, v9
  v_mfma_f32_16x16x32_bf16 v[232:235], a[184:187], v[32:35], v[232:235]
  v_exp_f32 v201, v201
  v_mfma_f32_16x16x32_bf16 v[232:235], a[188:191], v[40:43], v[232:235]
  v_add_f32 v9, v197, v9
  v_mfma_f32_16x16x32_bf16 v[236:239], a[176:179], v[48:51], 0
  v_exp_f32 v202, v202
  v_mfma_f32_16x16x32_bf16 v[236:239], a[180:183], v[56:59], v[236:239]
  v_cvt_pk_bf16_f32 v38, v196, v197
  v_mfma_f32_16x16x32_bf16 v[236:239], a[184:187], v[64:67], v[236:239]
  v_exp_f32 v203, v203
  v_mfma_f32_16x16x32_bf16 v[236:239], a[188:191], v[72:75], v[236:239]
  v_add_f32 v9, v198, v9
  v_add_f32 v9, v199, v9
  v_mfma_f32_16x16x32_bf16 v[20:23], a[176:179], v[80:83], 0
  v_exp_f32 v204, v204
  v_mfma_f32_16x16x32_bf16 v[20:23], a[180:183], v[88:91], v[20:23]
  v_cvt_pk_bf16_f32 v39, v198, v199
  v_cvt_pk_bf16_f32 v54, v200, v201
  v_mfma_f32_16x16x32_bf16 v[20:23], a[184:187], v[96:99], v[20:23]
  v_exp_f32 v205, v205
  v_mfma_f32_16x16x32_bf16 v[20:23], a[188:191], v[104:107], v[20:23]
  v_cvt_pk_bf16_f32 v55, v202, v203
  v_add_f32 v11, v204, v11
  v_mfma_f32_16x16x32_bf16 v[28:31], a[176:179], v[112:115], 0
  v_exp_f32 v206, v206
  v_mfma_f32_16x16x32_bf16 v[28:31], a[180:183], v[120:123], v[28:31]
  v_exp_f32 v207, v207
  v_mfma_f32_16x16x32_bf16 v[28:31], a[184:187], v[128:131], v[28:31]
  s_waitcnt vmcnt(9)
  v_exp_f32 v208, v208
  v_mfma_f32_16x16x32_bf16 v[28:31], a[188:191], v[136:139], v[28:31]
  v_exp_f32 v209, v209
  s_barrier
  v_exp_f32 v210, v210
  ds_read_b128 a[160:163], v1 offset:16384
  v_add_f32 v11, v205, v11
  s_xor_b32 m0, s74, 0x18000
  v_cvt_pk_bf16_f32 v70, v204, v205
  buffer_load_dwordx4 v7, s[16:19], s97 offen nt lds
  v_exp_f32 v211, v211
  ds_read_b128 a[164:167], v1 offset:16640
  v_add_f32 v11, v206, v11
  v_exp_f32 v212, v212
  ds_read_b128 a[168:171], v240 offset:16384
  v_add_f32 v11, v207, v11
  v_exp_f32 v213, v213
  v_cvt_pk_bf16_f32 v71, v206, v207
  v_exp_f32 v214, v214
  v_cvt_pk_bf16_f32 v86, v208, v209
  v_exp_f32 v215, v215
  v_cvt_pk_bf16_f32 v87, v210, v211
  v_exp_f32 v216, v216
  v_add_f32 v13, v212, v13
  v_exp_f32 v217, v217
  ds_read_b128 a[172:175], v240 offset:16640
  v_add_f32 v13, v213, v13
  v_exp_f32 v218, v218
  v_cvt_pk_bf16_f32 v102, v212, v213
  v_add_f32 v13, v214, v13
  buffer_load_dwordx4 v8, s[16:19], s97 offen offset:1024 nt lds
  v_exp_f32 v219, v219
  v_add_f32 v13, v215, v13
  v_exp_f32 v220, v220
  v_cvt_pk_bf16_f32 v103, v214, v215
  v_exp_f32 v221, v221
  v_add_f32 v9, v216, v9
  v_exp_f32 v222, v222
  v_add_f32 v9, v217, v9
  v_exp_f32 v223, v223
  v_cvt_pk_bf16_f32 v44, v216, v217
  v_exp_f32 v224, v224
  v_add_f32 v9, v218, v9
  v_exp_f32 v225, v225
  v_add_f32 v9, v219, v9
  v_exp_f32 v226, v226
  v_cvt_pk_bf16_f32 v45, v218, v219
  v_cvt_pk_bf16_f32 v60, v220, v221
  buffer_load_dwordx4 v7, s[16:19], s97 offen offset:2048 nt lds
  v_exp_f32 v227, v227
  v_cvt_pk_bf16_f32 v61, v222, v223
  v_exp_f32 v228, v228
  v_add_f32 v11, v224, v11
  v_exp_f32 v229, v229
  v_add_f32 v11, v225, v11
  v_exp_f32 v230, v230
  v_exp_f32 v231, v231
  v_exp_f32 v232, v232
  v_cvt_pk_bf16_f32 v76, v224, v225
  v_add_f32 v11, v226, v11
  v_exp_f32 v233, v233
  ds_read_b128 a[176:179], v1 offset:20480
  v_add_f32 v11, v227, v11
  v_exp_f32 v234, v234
  ds_read_b128 a[180:183], v1 offset:20736
  v_cvt_pk_bf16_f32 v77, v226, v227
  v_exp_f32 v235, v235
  ds_read_b128 a[184:187], v240 offset:20480
  v_cvt_pk_bf16_f32 v92, v228, v229
  v_cvt_pk_bf16_f32 v93, v230, v231
  buffer_load_dwordx4 v8, s[16:19], s97 offen offset:3072 nt lds
  v_exp_f32 v236, v236
  ds_read_b128 a[188:191], v240 offset:20736
  v_add_f32 v9, v232, v9
  s_add_u32 s97, s97, 0x4000
  v_exp_f32 v237, v237
  v_add_f32 v9, v233, v9
  v_cvt_pk_bf16_f32 v46, v232, v233
  v_exp_f32 v238, v238
  v_add_f32 v9, v234, v9
  v_add_f32 v9, v235, v9
  v_exp_f32 v239, v239
  v_cvt_pk_bf16_f32 v47, v234, v235
  v_cvt_pk_bf16_f32 v62, v236, v237
  v_exp_f32 v20, v20
  v_cvt_pk_bf16_f32 v63, v238, v239
  v_add_f32 v11, v20, v11
  s_waitcnt vmcnt(8)
  v_cmp_ne_u32 vcc, 0, v15
  s_nop 0
  s_cmp_eq_u32 vcc_lo, 255
  s_cbranch_scc1 L_z_ok
L_z_spin:
  s_sleep 2
  buffer_load_dword v15, v255, s[4:7], 0 offen sc1
  s_waitcnt vmcnt(0)
  v_cmp_ne_u32 vcc, 0, v15
  s_nop 0
  s_cmp_eq_u32 vcc_lo, 255
  s_cbranch_scc0 L_z_spin
L_z_ok:
  v_exp_f32 v21, v21
  s_nop 0
  v_add_f32 v11, v21, v11
  v_cvt_pk_bf16_f32 v78, v20, v21
  v_exp_f32 v22, v22
  s_nop 0
  v_add_f32 v11, v22, v11
  s_waitcnt lgkmcnt(4)
  v_exp_f32 v23, v23
  s_nop 0
  v_add_f32 v11, v23, v11
  v_cvt_pk_bf16_f32 v79, v22, v23
  s_xor_b32 m0, s74, 0xc000
  s_nop 0
  buffer_load_dwordx4 v7, s[12:15], s96 offen nt lds
  v_mfma_f32_16x16x32_bf16 v[176:179], a[160:163], v[16:19], 0
  v_exp_f32 v28, v28
  v_mfma_f32_16x16x32_bf16 v[176:179], a[164:167], v[24:27], v[176:179]
  ds_read_b64_tr_b16 a[192:193], v3
  v_mfma_f32_16x16x32_bf16 v[176:179], a[168:171], v[32:35], v[176:179]
  v_exp_f32 v29, v29
  v_mfma_f32_16x16x32_bf16 v[176:179], a[172:175], v[40:43], v[176:179]
  ds_read_b64_tr_b16 a[194:195], v3 offset:4096
  v_cvt_pk_bf16_f32 v94, v28, v29
  v_mfma_f32_16x16x32_bf16 v[180:183], a[160:163], v[48:51], 0
  v_exp_f32 v30, v30
  v_mfma_f32_16x16x32_bf16 v[180:183], a[164:167], v[56:59], v[180:183]
  ds_read_b64_tr_b16 a[196:197], v5
  v_mfma_f32_16x16x32_bf16 v[180:183], a[168:171], v[64:67], v[180:183]
  v_exp_f32 v31, v31
  v_mfma_f32_16x16x32_bf16 v[180:183], a[172:175], v[72:75], v[180:183]
  ds_read_b64_tr_b16 a[198:199], v5 offset:4096
  v_cvt_pk_bf16_f32 v95, v30, v31
  v_mfma_f32_16x16x32_bf16 v[184:187], a[160:163], v[80:83], 0
  v_exp_f32 v176, v176
  v_mfma_f32_16x16x32_bf16 v[184:187], a[164:167], v[88:91], v[184:187]
  ds_read_b64_tr_b16 a[200:201], v4
  v_add_f32 v9, v176, v9
  v_mfma_f32_16x16x32_bf16 v[184:187], a[168:171], v[96:99], v[184:187]
  v_exp_f32 v177, v177
  v_mfma_f32_16x16x32_bf16 v[184:187], a[172:175], v[104:107], v[184:187]
  ds_read_b64_tr_b16 a[202:203], v4 offset:4096
  v_add_f32 v9, v177, v9
  v_mfma_f32_16x16x32_bf16 v[188:191], a[160:163], v[112:115], 0
  v_exp_f32 v178, v178
  v_mfma_f32_16x16x32_bf16 v[188:191], a[164:167], v[120:123], v[188:191]
  ds_read_b64_tr_b16 a[204:205], v6
  v_cvt_pk_bf16_f32 v108, v176, v177
  v_mfma_f32_16x16x32_bf16 v[188:191], a[168:171], v[128:131], v[188:191]
  v_exp_f32 v179, v179
  v_mfma_f32_16x16x32_bf16 v[188:191], a[172:175], v[136:139], v[188:191]
  ds_read_b64_tr_b16 a[206:207], v6 offset:4096
  v_add_f32 v9, v178, v9
  v_mfma_f32_16x16x32_bf16 v[192:195], a[160:163], v[144:147], 0
  v_add_f32 v9, v179, v9
  v_mfma_f32_16x16x32_bf16 v[192:195], a[164:167], v[152:155], v[192:195]
  buffer_load_dwordx4 v7, s[12:15], s96 offen offset:1024 nt lds
  v_mfma_f32_16x16x32_bf16 v[192:195], a[168:171], v[160:163], v[192:195]
  s_waitcnt lgkmcnt(8)
  v_exp_f32 v180, v180
  v_mfma_f32_16x16x32_bf16 v[192:195], a[172:175], v[168:171], v[192:195]
  v_exp_f32 v181, v181
  v_mfma_f32_16x16x32_bf16 v[196:199], a[176:179], v[16:19], 0
  v_exp_f32 v182, v182
  v_mfma_f32_16x16x32_bf16 v[196:199], a[180:183], v[24:27], v[196:199]
  ds_read_b128 a[160:163], v2 offset:16384
  v_cvt_pk_bf16_f32 v109, v178, v179
  v_mfma_f32_16x16x32_bf16 v[196:199], a[184:187], v[32:35], v[196:199]
  v_exp_f32 v183, v183
  v_mfma_f32_16x16x32_bf16 v[196:199], a[188:191], v[40:43], v[196:199]
  ds_read_b128 a[164:167], v2 offset:16640
  v_cvt_pk_bf16_f32 v124, v180, v181
  v_mfma_f32_16x16x32_bf16 v[200:203], a[176:179], v[48:51], 0
  v_exp_f32 v184, v184
  v_mfma_f32_16x16x32_bf16 v[200:203], a[180:183], v[56:59], v[200:203]
  ds_read_b128 a[168:171], v241 offset:16384
  v_cvt_pk_bf16_f32 v125, v182, v183
  v_mfma_f32_16x16x32_bf16 v[200:203], a[184:187], v[64:67], v[200:203]
  v_exp_f32 v185, v185
  v_mfma_f32_16x16x32_bf16 v[200:203], a[188:191], v[72:75], v[200:203]
  ds_read_b128 a[172:175], v241 offset:16640
  v_add_f32 v11, v184, v11
  v_mfma_f32_16x16x32_bf16 v[204:207], a[176:179], v[80:83], 0
  v_exp_f32 v186, v186
  v_mfma_f32_16x16x32_bf16 v[204:207], a[180:183], v[88:91], v[204:207]
  ds_read_b64_tr_b16 a[208:209], v3 offset:256
  v_add_f32 v11, v185, v11
  v_mfma_f32_16x16x32_bf16 v[204:207], a[184:187], v[96:99], v[204:207]
  v_exp_f32 v187, v187
  v_mfma_f32_16x16x32_bf16 v[204:207], a[188:191], v[104:107], v[204:207]
  ds_read_b64_tr_b16 a[210:211], v3 offset:4352
  v_cvt_pk_bf16_f32 v140, v184, v185
  v_mfma_f32_16x16x32_bf16 v[208:211], a[176:179], v[112:115], 0
  v_exp_f32 v188, v188
  v_mfma_f32_16x16x32_bf16 v[208:211], a[180:183], v[120:123], v[208:211]
  ds_read_b64_tr_b16 a[212:213], v5 offset:256
  v_add_f32 v11, v186, v11
  v_mfma_f32_16x16x32_bf16 v[208:211], a[184:187], v[128:131], v[208:211]
  v_add_f32 v11, v187, v11
  v_mfma_f32_16x16x32_bf16 v[208:211], a[188:191], v[136:139], v[208:211]
  buffer_load_dwordx4 v8, s[12:15], s96 offen offset:2048 nt lds
  v_mfma_f32_16x16x32_bf16 v[212:215], a[176:179], v[144:147], 0
  v_exp_f32 v189, v189
  v_mfma_f32_16x16x32_bf16 v[212:215], a[180:183], v[152:155], v[212:215]
  ds_read_b64_tr_b16 a[214:215], v5 offset:4352
  v_cvt_pk_bf16_f32 v141, v186, v187
  v_mfma_f32_16x16x32_bf16 v[212:215], a[184:187], v[160:163], v[212:215]
  s_waitcnt lgkmcnt(4)
  v_exp_f32 v190, v190
  v_mfma_f32_16x16x32_bf16 v[212:215], a[188:191], v[168:171], v[212:215]
  v_exp_f32 v191, v191
  v_mfma_f32_16x16x32_bf16 v[216:219], a[160:163], v[16:19], 0
  v_exp_f32 v192, v192
  v_mfma_f32_16x16x32_bf16 v[216:219], a[164:167], v[24:27], v[216:219]
  ds_read_b128 a[176:179], v2 offset:20480
  v_cvt_pk_bf16_f32 v156, v188, v189
  v_mfma_f32_16x16x32_bf16 v[216:219], a[168:171], v[32:35], v[216:219]
  v_exp_f32 v193, v193
  v_mfma_f32_16x16x32_bf16 v[216:219], a[172:175], v[40:43], v[216:219]
  ds_read_b128 a[180:183], v2 offset:20736
  v_cvt_pk_bf16_f32 v157, v190, v191
  v_mfma_f32_16x16x32_bf16 v[220:223], a[160:163], v[48:51], 0
  v_exp_f32 v194, v194
  v_mfma_f32_16x16x32_bf16 v[220:223], a[164:167], v[56:59], v[220:223]
  ds_read_b128 a[184:187], v241 offset:20480
  v_add_f32 v13, v192, v13
  v_mfma_f32_16x16x32_bf16 v[220:223], a[168:171], v[64:67], v[220:223]
  v_exp_f32 v195, v195
  v_mfma_f32_16x16x32_bf16 v[220:223], a[172:175], v[72:75], v[220:223]
  ds_read_b128 a[188:191], v241 offset:20736
  v_add_f32 v13, v193, v13
  v_mfma_f32_16x16x32_bf16 v[224:227], a[160:163], v[80:83], 0
  v_exp_f32 v196, v196
  v_mfma_f32_16x16x32_bf16 v[224:227], a[164:167], v[88:91], v[224:227]
  v_cvt_pk_bf16_f32 v172, v192, v193
  v_add_f32 v13, v194, v13
  v_mfma_f32_16x16x32_bf16 v[224:227], a[168:171], v[96:99], v[224:227]
  v_exp_f32 v197, v197
  v_mfma_f32_16x16x32_bf16 v[224:227], a[172:175], v[104:107], v[224:227]
  v_exp_f32 v198, v198
  v_mfma_f32_16x16x32_bf16 v[228:231], a[160:163], v[112:115], 0
  v_add_f32 v13, v195, v13
  v_mfma_f32_16x16x32_bf16 v[228:231], a[164:167], v[120:123], v[228:231]
  buffer_load_dwordx4 v8, s[12:15], s96 offen offset:3072 nt lds
  v_mfma_f32_16x16x32_bf16 v[228:231], a[168:171], v[128:131], v[228:231]
  s_waitcnt lgkmcnt(0)
  v_exp_f32 v199, v199
  v_mfma_f32_16x16x32_bf16 v[228:231], a[172:175], v[136:139], v[228:231]
  ds_read_b64_tr_b16 a[216:217], v4 offset:256
  v_cvt_pk_bf16_f32 v173, v194, v195
  v_mfma_f32_16x16x32_bf16 v[232:235], a[176:179], v[16:19], 0
  s_add_u32 s96, s96, 0x4000
  v_xor_b32 v1, 0x8000, v1
  v_xor_b32 v2, 0x8000, v2
  v_exp_f32 v200, v200
  v_mfma_f32_16x16x32_bf16 v[232:235], a[180:183], v[24:27], v[232:235]
  ds_read_b64_tr_b16 a[218:219], v4 offset:4352
  v_add_f32 v9, v196, v9
  v_mfma_f32_16x16x32_bf16 v[232:235], a[184:187], v[32:35], v[232:235]
  v_xor_b32 v240, 0x8000, v240
  v_xor_b32 v241, 0x8000, v241
  v_exp_f32 v201, v201
  v_mfma_f32_16x16x32_bf16 v[232:235], a[188:191], v[40:43], v[232:235]
  ds_read_b64_tr_b16 a[220:221], v6 offset:256
  v_add_f32 v9, v197, v9
  v_mfma_f32_16x16x32_bf16 v[236:239], a[176:179], v[48:51], 0
  v_exp_f32 v202, v202
  v_mfma_f32_16x16x32_bf16 v[236:239], a[180:183], v[56:59], v[236:239]
  ds_read_b64_tr_b16 a[222:223], v6 offset:4352
  v_cvt_pk_bf16_f32 v110, v196, v197
  v_mfma_f32_16x16x32_bf16 v[236:239], a[184:187], v[64:67], v[236:239]
  v_exp_f32 v203, v203
  v_mfma_f32_16x16x32_bf16 v[236:239], a[188:191], v[72:75], v[236:239]
  v_add_f32 v9, v198, v9
  v_add_f32 v9, v199, v9
  v_mfma_f32_16x16x32_bf16 v[20:23], a[176:179], v[80:83], 0
  v_exp_f32 v204, v204
  v_mfma_f32_16x16x32_bf16 v[20:23], a[180:183], v[88:91], v[20:23]
  v_cvt_pk_bf16_f32 v111, v198, v199
  v_cvt_pk_bf16_f32 v126, v200, v201
  v_mfma_f32_16x16x32_bf16 v[20:23], a[184:187], v[96:99], v[20:23]
  v_exp_f32 v205, v205
  v_mfma_f32_16x16x32_bf16 v[20:23], a[188:191], v[104:107], v[20:23]
  v_cvt_pk_bf16_f32 v127, v202, v203
  v_add_f32 v11, v204, v11
  v_mfma_f32_16x16x32_bf16 v[28:31], a[176:179], v[112:115], 0
  s_waitcnt lgkmcnt(15)
  v_exp_f32 v206, v206
  v_mfma_f32_16x16x32_bf16 v[28:31], a[180:183], v[120:123], v[28:31]
  v_exp_f32 v207, v207
L_aloop:
  v_mfma_f32_16x16x32_bf16 v[28:31], a[184:187], v[128:131], v[28:31]
  s_waitcnt vmcnt(8)
  v_exp_f32 v208, v208
  v_mfma_f32_16x16x32_bf16 v[28:31], a[188:191], v[136:139], v[28:31]
  v_exp_f32 v209, v209
  v_mfma_f32_16x16x32_bf16 a[0:3], a[192:195], v[36:39], a[0:3]
  s_barrier
  v_exp_f32 v210, v210
  v_mfma_f32_16x16x32_bf16 a[0:3], a[196:199], v[44:47], a[0:3]
  ds_read_b128 a[160:163], v1
  v_add_f32 v11, v205, v11
  v_mfma_f32_16x16x32_bf16 a[32:35], a[192:195], v[52:55], a[32:35]
  s_xor_b32 m0, s74, 0x1c000
  v_cvt_pk_bf16_f32 v142, v204, v205
  v_mfma_f32_16x16x32_bf16 a[32:35], a[196:199], v[60:63], a[32:35]
  buffer_load_dwordx4 v7, s[16:19], s97 offen nt lds
  v_mfma_f32_16x16x32_bf16 a[64:67], a[192:195], v[68:71], a[64:67]
  v_exp_f32 v211, v211
  v_mfma_f32_16x16x32_bf16 a[64:67], a[196:199], v[76:79], a[64:67]
  ds_read_b128 a[164:167], v1 offset:256
  v_add_f32 v11, v206, v11
  v_mfma_f32_16x16x32_bf16 a[96:99], a[192:195], v[84:87], a[96:99]
  v_exp_f32 v212, v212
  v_mfma_f32_16x16x32_bf16 a[96:99], a[196:199], v[92:95], a[96:99]
  ds_read_b128 a[168:171], v240
  v_add_f32 v11, v207, v11
  v_mfma_f32_16x16x32_bf16 a[128:131], a[192:195], v[100:103], a[128:131]
  s_waitcnt lgkmcnt(15)
  v_exp_f32 v213, v213
  v_mfma_f32_16x16x32_bf16 a[4:7], a[200:203], v[36:39], a[4:7]
  ds_read_b64_tr_b16 a[192:193], v3 offset:512
  v_cvt_pk_bf16_f32 v143, v206, v207
  v_mfma_f32_16x16x32_bf16 a[4:7], a[204:207], v[44:47], a[4:7]
  v_exp_f32 v214, v214
  v_mfma_f32_16x16x32_bf16 a[36:39], a[200:203], v[52:55], a[36:39]
  ds_read_b64_tr_b16 a[194:195], v3 offset:4608
  v_cvt_pk_bf16_f32 v158, v208, v209
  v_mfma_f32_16x16x32_bf16 a[36:39], a[204:207], v[60:63], a[36:39]
  v_exp_f32 v215, v215
  v_mfma_f32_16x16x32_bf16 a[68:71], a[200:203], v[68:71], a[68:71]
  ds_read_b64_tr_b16 a[196:197], v5 offset:512
  v_cvt_pk_bf16_f32 v159, v210, v211
  v_mfma_f32_16x16x32_bf16 a[68:71], a[204:207], v[76:79], a[68:71]
  v_exp_f32 v216, v216
  v_mfma_f32_16x16x32_bf16 a[100:103], a[200:203], v[84:87], a[100:103]
  ds_read_b64_tr_b16 a[198:199], v5 offset:4608
  v_add_f32 v13, v212, v13
  v_mfma_f32_16x16x32_bf16 a[100:103], a[204:207], v[92:95], a[100:103]
  s_waitcnt lgkmcnt(15)
  v_exp_f32 v217, v217
  v_mfma_f32_16x16x32_bf16 a[132:135], a[200:203], v[100:103], a[132:135]
  ds_read_b128 a[172:175], v240 offset:256
  v_add_f32 v13, v213, v13
  v_mfma_f32_16x16x32_bf16 a[8:11], a[208:211], v[36:39], a[8:11]
  v_exp_f32 v218, v218
  v_mfma_f32_16x16x32_bf16 a[8:11], a[212:215], v[44:47], a[8:11]
  ds_read_b64_tr_b16 a[200:201], v4 offset:512
  v_cvt_pk_bf16_f32 v174, v212, v213
  v_mfma_f32_16x16x32_bf16 a[40:43], a[208:211], v[52:55], a[40:43]
  v_add_f32 v13, v214, v13
  v_mfma_f32_16x16x32_bf16 a[40:43], a[212:215], v[60:63], a[40:43]
  buffer_load_dwordx4 v8, s[16:19], s97 offen offset:1024 nt lds
  v_mfma_f32_16x16x32_bf16 a[72:75], a[208:211], v[68:71], a[72:75]
  v_exp_f32 v219, v219
  v_mfma_f32_16x16x32_bf16 a[72:75], a[212:215], v[76:79], a[72:75]
  ds_read_b64_tr_b16 a[202:203], v4 offset:4608
  v_add_f32 v13, v215, v13
  v_mfma_f32_16x16x32_bf16 a[104:107], a[208:211], v[84:87], a[104:107]
  v_exp_f32 v220, v220
  v_mfma_f32_16x16x32_bf16 a[104:107], a[212:215], v[92:95], a[104:107]
  ds_read_b64_tr_b16 a[204:205], v6 offset:512
  v_cvt_pk_bf16_f32 v175, v214, v215
  v_mfma_f32_16x16x32_bf16 a[136:139], a[208:211], v[100:103], a[136:139]
  s_waitcnt lgkmcnt(11)
  v_exp_f32 v221, v221
  v_mfma_f32_16x16x32_bf16 a[12:15], a[216:219], v[36:39], a[12:15]
  ds_read_b64_tr_b16 a[206:207], v6 offset:4608
  v_add_f32 v9, v216, v9
  v_mfma_f32_16x16x32_bf16 a[12:15], a[220:223], v[44:47], a[12:15]
  v_exp_f32 v222, v222
  v_mfma_f32_16x16x32_bf16 a[44:47], a[216:219], v[52:55], a[44:47]
  ds_read_b64_tr_b16 a[208:209], v3 offset:768
  v_add_f32 v9, v217, v9
  v_mfma_f32_16x16x32_bf16 a[44:47], a[220:223], v[60:63], a[44:47]
  v_exp_f32 v223, v223
  v_mfma_f32_16x16x32_bf16 a[76:79], a[216:219], v[68:71], a[76:79]
  ds_read_b64_tr_b16 a[210:211], v3 offset:4864
  v_cvt_pk_bf16_f32 v116, v216, v217
  v_mfma_f32_16x16x32_bf16 a[76:79], a[220:223], v[76:79], a[76:79]
  v_exp_f32 v224, v224
  v_mfma_f32_16x16x32_bf16 a[108:111], a[216:219], v[84:87], a[108:111]
  ds_read_b64_tr_b16 a[212:213], v5 offset:768
  v_add_f32 v9, v218, v9
  v_mfma_f32_16x16x32_bf16 a[108:111], a[220:223], v[92:95], a[108:111]
  s_waitcnt lgkmcnt(8)
  v_exp_f32 v225, v225
  v_mfma_f32_16x16x32_bf16 a[140:143], a[216:219], v[100:103], a[140:143]
  ds_read_b64_tr_b16 a[214:215], v5 offset:4864
  v_add_f32 v9, v219, v9
  v_mfma_f32_16x16x32_bf16 a[16:19], a[192:195], v[36:39], a[16:19]
  v_exp_f32 v226, v226
  v_mfma_f32_16x16x32_bf16 a[16:19], a[196:199], v[44:47], a[16:19]
  ds_read_b64_tr_b16 a[216:217], v4 offset:768
  v_cvt_pk_bf16_f32 v117, v218, v219
  v_mfma_f32_16x16x32_bf16 a[48:51], a[192:195], v[52:55], a[48:51]
  v_cvt_pk_bf16_f32 v132, v220, v221
  v_mfma_f32_16x16x32_bf16 a[48:51], a[196:199], v[60:63], a[48:51]
  buffer_load_dwordx4 v7, s[16:19], s97 offen offset:2048 nt lds
  v_mfma_f32_16x16x32_bf16 a[80:83], a[192:195], v[68:71], a[80:83]
  v_exp_f32 v227, v227
  v_mfma_f32_16x16x32_bf16 a[80:83], a[196:199], v[76:79], a[80:83]
  ds_read_b64_tr_b16 a[218:219], v4 offset:4864
  v_cvt_pk_bf16_f32 v133, v222, v223
  v_mfma_f32_16x16x32_bf16 a[112:115], a[192:195], v[84:87], a[112:115]
  v_exp_f32 v228, v228
  v_mfma_f32_16x16x32_bf16 a[112:115], a[196:199], v[92:95], a[112:115]
  ds_read_b64_tr_b16 a[220:221], v6 offset:768
  v_add_f32 v11, v224, v11
  v_mfma_f32_16x16x32_bf16 a[144:147], a[192:195], v[100:103], a[144:147]
  s_waitcnt lgkmcnt(7)
  v_exp_f32 v229, v229
  v_mfma_f32_16x16x32_bf16 a[20:23], a[200:203], v[36:39], a[20:23]
  ds_read_b64_tr_b16 a[222:223], v6 offset:4864
  v_add_f32 v11, v225, v11
  v_mfma_f32_16x16x32_bf16 a[20:23], a[204:207], v[44:47], a[20:23]
  v_exp_f32 v230, v230
  v_mfma_f32_16x16x32_bf16 a[52:55], a[200:203], v[52:55], a[52:55]
  v_exp_f32 v231, v231
  v_mfma_f32_16x16x32_bf16 a[52:55], a[204:207], v[60:63], a[52:55]
  v_exp_f32 v232, v232
  v_mfma_f32_16x16x32_bf16 a[84:87], a[200:203], v[68:71], a[84:87]
  v_cvt_pk_bf16_f32 v148, v224, v225
  v_add_f32 v11, v226, v11
  v_mfma_f32_16x16x32_bf16 a[84:87], a[204:207], v[76:79], a[84:87]
  v_exp_f32 v233, v233
  v_mfma_f32_16x16x32_bf16 a[116:119], a[200:203], v[84:87], a[116:119]
  ds_read_b128 a[176:179], v1 offset:4096
  v_add_f32 v11, v227, v11
  v_mfma_f32_16x16x32_bf16 a[116:119], a[204:207], v[92:95], a[116:119]
  s_waitcnt lgkmcnt(5)
  v_exp_f32 v234, v234
  v_mfma_f32_16x16x32_bf16 a[148:151], a[200:203], v[100:103], a[148:151]
  ds_read_b128 a[180:183], v1 offset:4352
  v_cvt_pk_bf16_f32 v149, v226, v227
  v_mfma_f32_16x16x32_bf16 a[24:27], a[208:211], v[36:39], a[24:27]
  v_exp_f32 v235, v235
  v_mfma_f32_16x16x32_bf16 a[24:27], a[212:215], v[44:47], a[24:27]
  ds_read_b128 a[184:187], v240 offset:4096
  v_cvt_pk_bf16_f32 v164, v228, v229
  v_mfma_f32_16x16x32_bf16 a[56:59], a[208:211], v[52:55], a[56:59]
  v_cvt_pk_bf16_f32 v165, v230, v231
  v_mfma_f32_16x16x32_bf16 a[56:59], a[212:215], v[60:63], a[56:59]
  buffer_load_dwordx4 v8, s[16:19], s97 offen offset:3072 nt lds
  v_mfma_f32_16x16x32_bf16 a[88:91], a[208:211], v[68:71], a[88:91]
  v_exp_f32 v236, v236
  v_mfma_f32_16x16x32_bf16 a[88:91], a[212:215], v[76:79], a[88:91]
  ds_read_b128 a[188:191], v240 offset:4352
  v_add_f32 v9, v232, v9
  v_mfma_f32_16x16x32_bf16 a[120:123], a[208:211], v[84:87], a[120:123]
  s_add_u32 s97, s97, 0x4000
  v_exp_f32 v237, v237
  v_mfma_f32_16x16x32_bf16 a[120:123], a[212:215], v[92:95], a[120:123]
  v_add_f32 v9, v233, v9
  v_cvt_pk_bf16_f32 v118, v232, v233
  v_mfma_f32_16x16x32_bf16 a[152:155], a[208:211], v[100:103], a[152:155]
  s_waitcnt lgkmcnt(4)
  v_exp_f32 v238, v238
  v_mfma_f32_16x16x32_bf16 a[28:31], a[216:219], v[36:39], a[28:31]
  v_add_f32 v9, v234, v9
  v_add_f32 v9, v235, v9
  v_mfma_f32_16x16x32_bf16 a[28:31], a[220:223], v[44:47], a[28:31]
  v_exp_f32 v239, v239
  v_mfma_f32_16x16x32_bf16 a[60:63], a[216:219], v[52:55], a[60:63]
  v_cvt_pk_bf16_f32 v119, v234, v235
  v_cvt_pk_bf16_f32 v134, v236, v237
  v_mfma_f32_16x16x32_bf16 a[60:63], a[220:223], v[60:63], a[60:63]
  v_exp_f32 v20, v20
  v_mfma_f32_16x16x32_bf16 a[92:95], a[216:219], v[68:71], a[92:95]
  v_cvt_pk_bf16_f32 v135, v238, v239
  v_add_f32 v11, v20, v11
  v_mfma_f32_16x16x32_bf16 a[92:95], a[220:223], v[76:79], a[92:95]
  v_exp_f32 v21, v21
  v_mfma_f32_16x16x32_bf16 a[124:127], a[216:219], v[84:87], a[124:127]
  v_add_f32 v11, v21, v11
  v_cvt_pk_bf16_f32 v150, v20, v21
  v_mfma_f32_16x16x32_bf16 a[124:127], a[220:223], v[92:95], a[124:127]
  v_exp_f32 v22, v22
  v_mfma_f32_16x16x32_bf16 a[156:159], a[216:219], v[100:103], a[156:159]
  v_add_f32 v11, v22, v11
  v_mfma_f32_16x16x32_bf16 a[244:247], a[240:243], v[52:55], a[244:247]
  s_waitcnt lgkmcnt(15)
  v_exp_f32 v23, v23
  v_mfma_f32_16x16x32_bf16 a[244:247], a[240:243], v[60:63], a[244:247]
  v_add_f32 v11, v23, v11
  v_cvt_pk_bf16_f32 v151, v22, v23
  v_mfma_f32_16x16x32_bf16 a[248:251], a[240:243], v[84:87], a[248:251]
  s_xor_b32 m0, s74, 0
  v_mfma_f32_16x16x32_bf16 a[248:251], a[240:243], v[92:95], a[248:251]
  buffer_load_dwordx4 v7, s[12:15], s96 offen nt lds
  v_mfma_f32_16x16x32_bf16 v[176:179], a[160:163], v[16:19], 0
  s_xor_b32 s74, s74, 0x8000
  v_exp_f32 v28, v28
  v_mfma_f32_16x16x32_bf16 v[176:179], a[164:167], v[24:27], v[176:179]
  ds_read_b64_tr_b16 a[192:193], v3 offset:16384
  v_mfma_f32_16x16x32_bf16 v[176:179], a[168:171], v[32:35], v[176:179]
  v_exp_f32 v29, v29
  v_mfma_f32_16x16x32_bf16 v[176:179], a[172:175], v[40:43], v[176:179]
  ds_read_b64_tr_b16 a[194:195], v3 offset:20480
  v_cvt_pk_bf16_f32 v166, v28, v29
  v_mfma_f32_16x16x32_bf16 v[180:183], a[160:163], v[48:51], 0
  v_exp_f32 v30, v30
  v_mfma_f32_16x16x32_bf16 v[180:183], a[164:167], v[56:59], v[180:183]
  ds_read_b64_tr_b16 a[196:197], v5 offset:16384
  v_mfma_f32_16x16x32_bf16 v[180:183], a[168:171], v[64:67], v[180:183]
  v_exp_f32 v31, v31
  v_mfma_f32_16x16x32_bf16 v[180:183], a[172:175], v[72:75], v[180:183]
  ds_read_b64_tr_b16 a[198:199], v5 offset:20480
  v_cvt_pk_bf16_f32 v167, v30, v31
  v_mfma_f32_16x16x32_bf16 v[184:187], a[160:163], v[80:83], 0
  v_exp_f32 v176, v176
  v_mfma_f32_16x16x32_bf16 v[184:187], a[164:167], v[88:91], v[184:187]
  ds_read_b64_tr_b16 a[200:201], v4 offset:16384
  v_add_f32 v9, v176, v9
  v_mfma_f32_16x16x32_bf16 v[184:187], a[168:171], v[96:99], v[184:187]
  v_exp_f32 v177, v177
  v_mfma_f32_16x16x32_bf16 v[184:187], a[172:175], v[104:107], v[184:187]
  ds_read_b64_tr_b16 a[202:203], v4 offset:20480
  v_add_f32 v9, v177, v9
  v_mfma_f32_16x16x32_bf16 v[188:191], a[160:163], v[112:115], 0
  v_exp_f32 v178, v178
  v_mfma_f32_16x16x32_bf16 v[188:191], a[164:167], v[120:123], v[188:191]
  ds_read_b64_tr_b16 a[204:205], v6 offset:16384
  v_cvt_pk_bf16_f32 v36, v176, v177
  v_mfma_f32_16x16x32_bf16 v[188:191], a[168:171], v[128:131], v[188:191]
  v_exp_f32 v179, v179
  v_mfma_f32_16x16x32_bf16 v[188:191], a[172:175], v[136:139], v[188:191]
  ds_read_b64_tr_b16 a[206:207], v6 offset:20480
  v_add_f32 v9, v178, v9
  v_mfma_f32_16x16x32_bf16 v[192:195], a[160:163], v[144:147], 0
  v_add_f32 v9, v179, v9
  v_mfma_f32_16x16x32_bf16 v[192:195], a[164:167], v[152:155], v[192:195]
  buffer_load_dwordx4 v7, s[12:15], s96 offen offset:1024 nt lds
  v_mfma_f32_16x16x32_bf16 v[192:195], a[168:171], v[160:163], v[192:195]
  s_waitcnt lgkmcnt(8)
  v_exp_f32 v180, v180
  v_mfma_f32_16x16x32_bf16 v[192:195], a[172:175], v[168:171], v[192:195]
  v_exp_f32 v181, v181
  v_mfma_f32_16x16x32_bf16 v[196:199], a[176:179], v[16:19], 0
  v_exp_f32 v182, v182
  v_mfma_f32_16x16x32_bf16 v[196:199], a[180:183], v[24:27], v[196:199]
  ds_read_b128 a[160:163], v2
  v_cvt_pk_bf16_f32 v37, v178, v179
  v_mfma_f32_16x16x32_bf16 v[196:199], a[184:187], v[32:35], v[196:199]
  v_exp_f32 v183, v183
  v_mfma_f32_16x16x32_bf16 v[196:199], a[188:191], v[40:43], v[196:199]
  ds_read_b128 a[164:167], v2 offset:256
  v_cvt_pk_bf16_f32 v52, v180, v181
  v_mfma_f32_16x16x32_bf16 v[200:203], a[176:179], v[48:51], 0
  v_exp_f32 v184, v184
  v_mfma_f32_16x16x32_bf16 v[200:203], a[180:183], v[56:59], v[200:203]
  ds_read_b128 a[168:171], v241
  v_cvt_pk_bf16_f32 v53, v182, v183
  v_mfma_f32_16x16x32_bf16 v[200:203], a[184:187], v[64:67], v[200:203]
  v_exp_f32 v185, v185
  v_mfma_f32_16x16x32_bf16 v[200:203], a[188:191], v[72:75], v[200:203]
  ds_read_b128 a[172:175], v241 offset:256
  v_add_f32 v11, v184, v11
  v_mfma_f32_16x16x32_bf16 v[204:207], a[176:179], v[80:83], 0
  v_exp_f32 v186, v186
  v_mfma_f32_16x16x32_bf16 v[204:207], a[180:183], v[88:91], v[204:207]
  ds_read_b64_tr_b16 a[208:209], v3 offset:16640
  v_add_f32 v11, v185, v11
  v_mfma_f32_16x16x32_bf16 v[204:207], a[184:187], v[96:99], v[204:207]
  v_exp_f32 v187, v187
  v_mfma_f32_16x16x32_bf16 v[204:207], a[188:191], v[104:107], v[204:207]
  ds_read_b64_tr_b16 a[210:211], v3 offset:20736
  v_cvt_pk_bf16_f32 v68, v184, v185
  v_mfma_f32_16x16x32_bf16 v[208:211], a[176:179], v[112:115], 0
  v_exp_f32 v188, v188
  v_mfma_f32_16x16x32_bf16 v[208:211], a[180:183], v[120:123], v[208:211]
  ds_read_b64_tr_b16 a[212:213], v5 offset:16640
  v_add_f32 v11, v186, v11
  v_mfma_f32_16x16x32_bf16 v[208:211], a[184:187], v[128:131], v[208:211]
  v_add_f32 v11, v187, v11
  v_mfma_f32_16x16x32_bf16 v[208:211], a[188:191], v[136:139], v[208:211]
  buffer_load_dwordx4 v8, s[12:15], s96 offen offset:2048 nt lds
  v_mfma_f32_16x16x32_bf16 v[212:215], a[176:179], v[144:147], 0
  v_exp_f32 v189, v189
  v_mfma_f32_16x16x32_bf16 v[212:215], a[180:183], v[152:155], v[212:215]
  ds_read_b64_tr_b16 a[214:215], v5 offset:20736
  v_cvt_pk_bf16_f32 v69, v186, v187
  v_mfma_f32_16x16x32_bf16 v[212:215], a[184:187], v[160:163], v[212:215]
  s_waitcnt lgkmcnt(4)
  v_exp_f32 v190, v190
  v_mfma_f32_16x16x32_bf16 v[212:215], a[188:191], v[168:171], v[212:215]
  v_exp_f32 v191, v191
  v_mfma_f32_16x16x32_bf16 v[216:219], a[160:163], v[16:19], 0
  v_exp_f32 v192, v192
  v_mfma_f32_16x16x32_bf16 v[216:219], a[164:167], v[24:27], v[216:219]
  ds_read_b128 a[176:179], v2 offset:4096
  v_cvt_pk_bf16_f32 v84, v188, v189
  v_mfma_f32_16x16x32_bf16 v[216:219], a[168:171], v[32:35], v[216:219]
  v_exp_f32 v193, v193
  v_mfma_f32_16x16x32_bf16 v[216:219], a[172:175], v[40:43], v[216:219]
  ds_read_b128 a[180:183], v2 offset:4352
  v_cvt_pk_bf16_f32 v85, v190, v191
  v_mfma_f32_16x16x32_bf16 v[220:223], a[160:163], v[48:51], 0
  v_exp_f32 v194, v194
  v_mfma_f32_16x16x32_bf16 v[220:223], a[164:167], v[56:59], v[220:223]
  ds_read_b128 a[184:187], v241 offset:4096
  v_add_f32 v13, v192, v13
  v_mfma_f32_16x16x32_bf16 v[220:223], a[168:171], v[64:67], v[220:223]
  v_exp_f32 v195, v195
  v_mfma_f32_16x16x32_bf16 v[220:223], a[172:175], v[72:75], v[220:223]
  ds_read_b128 a[188:191], v241 offset:4352
  v_add_f32 v13, v193, v13
  v_mfma_f32_16x16x32_bf16 v[224:227], a[160:163], v[80:83], 0
  v_exp_f32 v196, v196
  v_mfma_f32_16x16x32_bf16 v[224:227], a[164:167], v[88:91], v[224:227]
  v_cvt_pk_bf16_f32 v100, v192, v193
  v_add_f32 v13, v194, v13
  v_mfma_f32_16x16x32_bf16 v[224:227], a[168:171], v[96:99], v[224:227]
  v_exp_f32 v197, v197
  v_mfma_f32_16x16x32_bf16 v[224:227], a[172:175], v[104:107], v[224:227]
  v_exp_f32 v198, v198
  v_mfma_f32_16x16x32_bf16 v[228:231], a[160:163], v[112:115], 0
  v_add_f32 v13, v195, v13
  v_mfma_f32_16x16x32_bf16 v[228:231], a[164:167], v[120:123], v[228:231]
  buffer_load_dwordx4 v8, s[12:15], s96 offen offset:3072 nt lds
  v_mfma_f32_16x16x32_bf16 v[228:231], a[168:171], v[128:131], v[228:231]
  s_waitcnt lgkmcnt(0)
  v_exp_f32 v199, v199
  v_mfma_f32_16x16x32_bf16 v[228:231], a[172:175], v[136:139], v[228:231]
  ds_read_b64_tr_b16 a[216:217], v4 offset:16640
  v_cvt_pk_bf16_f32 v101, v194, v195
  v_mfma_f32_16x16x32_bf16 v[232:235], a[176:179], v[16:19], 0
  s_add_u32 s96, s96, 0x4000
  v_exp_f32 v200, v200
  v_mfma_f32_16x16x32_bf16 v[232:235], a[180:183], v[24:27], v[232:235]
  ds_read_b64_tr_b16 a[218:219], v4 offset:20736
  v_add_f32 v9, v196, v9
  v_mfma_f32_16x16x32_bf16 v[232:235], a[184:187], v[32:35], v[232:235]
  v_exp_f32 v201, v201
  v_mfma_f32_16x16x32_bf16 v[232:235], a[188:191], v[40:43], v[232:235]
  ds_read_b64_tr_b16 a[220:221], v6 offset:16640
  v_add_f32 v9, v197, v9
  v_mfma_f32_16x16x32_bf16 v[236:239], a[176:179], v[48:51], 0
  v_exp_f32 v202, v202
  v_mfma_f32_16x16x32_bf16 v[236:239], a[180:183], v[56:59], v[236:239]
  ds_read_b64_tr_b16 a[222:223], v6 offset:20736
  v_cvt_pk_bf16_f32 v38, v196, v197
  v_mfma_f32_16x16x32_bf16 v[236:239], a[184:187], v[64:67], v[236:239]
  v_exp_f32 v203, v203
  v_mfma_f32_16x16x32_bf16 v[236:239], a[188:191], v[72:75], v[236:239]
  v_add_f32 v9, v198, v9
  v_add_f32 v9, v199, v9
  v_mfma_f32_16x16x32_bf16 v[20:23], a[176:179], v[80:83], 0
  v_exp_f32 v204, v204
  v_mfma_f32_16x16x32_bf16 v[20:23], a[180:183], v[88:91], v[20:23]
  v_cvt_pk_bf16_f32 v39, v198, v199
  v_cvt_pk_bf16_f32 v54, v200, v201
  v_mfma_f32_16x16x32_bf16 v[20:23], a[184:187], v[96:99], v[20:23]
  v_exp_f32 v205, v205
  v_mfma_f32_16x16x32_bf16 v[20:23], a[188:191], v[104:107], v[20:23]
  v_cvt_pk_bf16_f32 v55, v202, v203
  v_add_f32 v11, v204, v11
  v_mfma_f32_16x16x32_bf16 v[28:31], a[176:179], v[112:115], 0
  s_waitcnt lgkmcnt(15)
  v_exp_f32 v206, v206
  v_mfma_f32_16x16x32_bf16 v[28:31], a[180:183], v[120:123], v[28:31]
  v_exp_f32 v207, v207
  v_mfma_f32_16x16x32_bf16 v[28:31], a[184:187], v[128:131], v[28:31]
  s_waitcnt vmcnt(8)
  v_exp_f32 v208, v208
  v_mfma_f32_16x16x32_bf16 v[28:31], a[188:191], v[136:139], v[28:31]
  v_exp_f32 v209, v209
  v_mfma_f32_16x16x32_bf16 a[0:3], a[192:195], v[108:111], a[0:3]
  s_barrier
  v_exp_f32 v210, v210
  v_mfma_f32_16x16x32_bf16 a[0:3], a[196:199], v[116:119], a[0:3]
  ds_read_b128 a[160:163], v1 offset:16384
  v_add_f32 v11, v205, v11
  v_mfma_f32_16x16x32_bf16 a[32:35], a[192:195], v[124:127], a[32:35]
  s_xor_b32 m0, s74, 0x18000
  v_cvt_pk_bf16_f32 v70, v204, v205
  v_mfma_f32_16x16x32_bf16 a[32:35], a[196:199], v[132:135], a[32:35]
  buffer_load_dwordx4 v7, s[16:19], s97 offen nt lds
  v_mfma_f32_16x16x32_bf16 a[64:67], a[192:195], v[140:143], a[64:67]
  v_exp_f32 v211, v211
  v_mfma_f32_16x16x32_bf16 a[64:67], a[196:199], v[148:151], a[64:67]
  ds_read_b128 a[164:167], v1 offset:16640
  v_add_f32 v11, v206, v11
  v_mfma_f32_16x16x32_bf16 a[96:99], a[192:195], v[156:159], a[96:99]
  v_exp_f32 v212, v212
  v_mfma_f32_16x16x32_bf16 a[96:99], a[196:199], v[164:167], a[96:99]
  ds_read_b128 a[168:171], v240 offset:16384
  v_add_f32 v11, v207, v11
  v_mfma_f32_16x16x32_bf16 a[128:131], a[192:195], v[172:175], a[128:131]
  s_waitcnt lgkmcnt(15)
  v_exp_f32 v213, v213
  v_mfma_f32_16x16x32_bf16 a[4:7], a[200:203], v[108:111], a[4:7]
  ds_read_b64_tr_b16 a[192:193], v3 offset:16896
  v_cvt_pk_bf16_f32 v71, v206, v207
  v_mfma_f32_16x16x32_bf16 a[4:7], a[204:207], v[116:119], a[4:7]
  v_exp_f32 v214, v214
  v_mfma_f32_16x16x32_bf16 a[36:39], a[200:203], v[124:127], a[36:39]
  ds_read_b64_tr_b16 a[194:195], v3 offset:20992
  v_cvt_pk_bf16_f32 v86, v208, v209
  v_mfma_f32_16x16x32_bf16 a[36:39], a[204:207], v[132:135], a[36:39]
  v_exp_f32 v215, v215
  v_mfma_f32_16x16x32_bf16 a[68:71], a[200:203], v[140:143], a[68:71]
  ds_read_b64_tr_b16 a[196:197], v5 offset:16896
  v_cvt_pk_bf16_f32 v87, v210, v211
  v_mfma_f32_16x16x32_bf16 a[68:71], a[204:207], v[148:151], a[68:71]
  v_exp_f32 v216, v216
  v_mfma_f32_16x16x32_bf16 a[100:103], a[200:203], v[156:159], a[100:103]
  ds_read_b64_tr_b16 a[198:199], v5 offset:20992
  v_add_f32 v13, v212, v13
  v_mfma_f32_16x16x32_bf16 a[100:103], a[204:207], v[164:167], a[100:103]
  s_waitcnt lgkmcnt(15)
  v_exp_f32 v217, v217
  v_mfma_f32_16x16x32_bf16 a[132:135], a[200:203], v[172:175], a[132:135]
  ds_read_b128 a[172:175], v240 offset:16640
  v_add_f32 v13, v213, v13
  v_mfma_f32_16x16x32_bf16 a[8:11], a[208:211], v[108:111], a[8:11]
  v_exp_f32 v218, v218
  v_mfma_f32_16x16x32_bf16 a[8:11], a[212:215], v[116:119], a[8:11]
  ds_read_b64_tr_b16 a[200:201], v4 offset:16896
  v_cvt_pk_bf16_f32 v102, v212, v213
  v_mfma_f32_16x16x32_bf16 a[40:43], a[208:211], v[124:127], a[40:43]
  v_add_f32 v13, v214, v13
  v_mfma_f32_16x16x32_bf16 a[40:43], a[212:215], v[132:135], a[40:43]
  buffer_load_dwordx4 v8, s[16:19], s97 offen offset:1024 nt lds
  v_mfma_f32_16x16x32_bf16 a[72:75], a[208:211], v[140:143], a[72:75]
  v_exp_f32 v219, v219
  v_mfma_f32_16x16x32_bf16 a[72:75], a[212:215], v[148:151], a[72:75]
  ds_read_b64_tr_b16 a[202:203], v4 offset:20992
  v_add_f32 v13, v215, v13
  v_mfma_f32_16x16x32_bf16 a[104:107], a[208:211], v[156:159], a[104:107]
  v_exp_f32 v220, v220
  v_mfma_f32_16x16x32_bf16 a[104:107], a[212:215], v[164:167], a[104:107]
  ds_read_b64_tr_b16 a[204:205], v6 offset:16896
  v_cvt_pk_bf16_f32 v103, v214, v215
  v_mfma_f32_16x16x32_bf16 a[136:139], a[208:211], v[172:175], a[136:139]
  s_waitcnt lgkmcnt(11)
  v_exp_f32 v221, v221
  v_mfma_f32_16x16x32_bf16 a[12:15], a[216:219], v[108:111], a[12:15]
  ds_read_b64_tr_b16 a[206:207], v6 offset:20992
  v_add_f32 v9, v216, v9
  v_mfma_f32_16x16x32_bf16 a[12:15], a[220:223], v[116:119], a[12:15]
  v_exp_f32 v222, v222
  v_mfma_f32_16x16x32_bf16 a[44:47], a[216:219], v[124:127], a[44:47]
  ds_read_b64_tr_b16 a[208:209], v3 offset:17152
  v_add_f32 v9, v217, v9
  v_mfma_f32_16x16x32_bf16 a[44:47], a[220:223], v[132:135], a[44:47]
  v_exp_f32 v223, v223
  v_mfma_f32_16x16x32_bf16 a[76:79], a[216:219], v[140:143], a[76:79]
  ds_read_b64_tr_b16 a[210:211], v3 offset:21248
  v_cvt_pk_bf16_f32 v44, v216, v217
  v_mfma_f32_16x16x32_bf16 a[76:79], a[220:223], v[148:151], a[76:79]
  v_exp_f32 v224, v224
  v_mfma_f32_16x16x32_bf16 a[108:111], a[216:219], v[156:159], a[108:111]
  ds_read_b64_tr_b16 a[212:213], v5 offset:17152
  v_add_f32 v9, v218, v9
  v_mfma_f32_16x16x32_bf16 a[108:111], a[220:223], v[164:167], a[108:111]
  s_waitcnt lgkmcnt(8)
  v_exp_f32 v225, v225
  v_mfma_f32_16x16x32_bf16 a[140:143], a[216:219], v[172:175], a[140:143]
  ds_read_b64_tr_b16 a[214:215], v5 offset:21248
  v_add_f32 v9, v219, v9
  v_mfma_f32_16x16x32_bf16 a[16:19], a[192:195], v[108:111], a[16:19]
  v_exp_f32 v226, v226
  v_mfma_f32_16x16x32_bf16 a[16:19], a[196:199], v[116:119], a[16:19]
  ds_read_b64_tr_b16 a[216:217], v4 offset:17152
  v_cvt_pk_bf16_f32 v45, v218, v219
  v_mfma_f32_16x16x32_bf16 a[48:51], a[192:195], v[124:127], a[48:51]
  v_cvt_pk_bf16_f32 v60, v220, v221
  v_mfma_f32_16x16x32_bf16 a[48:51], a[196:199], v[132:135], a[48:51]
  buffer_load_dwordx4 v7, s[16:19], s97 offen offset:2048 nt lds
  v_mfma_f32_16x16x32_bf16 a[80:83], a[192:195], v[140:143], a[80:83]
  v_exp_f32 v227, v227
  v_mfma_f32_16x16x32_bf16 a[80:83], a[196:199], v[148:151], a[80:83]
  ds_read_b64_tr_b16 a[218:219], v4 offset:21248
  v_cvt_pk_bf16_f32 v61, v222, v223
  v_mfma_f32_16x16x32_bf16 a[112:115], a[192:195], v[156:159], a[112:115]
  v_exp_f32 v228, v228
  v_mfma_f32_16x16x32_bf16 a[112:115], a[196:199], v[164:167], a[112:115]
  ds_read_b64_tr_b16 a[220:221], v6 offset:17152
  v_add_f32 v11, v224, v11
  v_mfma_f32_16x16x32_bf16 a[144:147], a[192:195], v[172:175], a[144:147]
  s_waitcnt lgkmcnt(7)
  v_exp_f32 v229, v229
  v_mfma_f32_16x16x32_bf16 a[20:23], a[200:203], v[108:111], a[20:23]
  ds_read_b64_tr_b16 a[222:223], v6 offset:21248
  v_add_f32 v11, v225, v11
  v_mfma_f32_16x16x32_bf16 a[20:23], a[204:207], v[116:119], a[20:23]
  v_exp_f32 v230, v230
  v_mfma_f32_16x16x32_bf16 a[52:55], a[200:203], v[124:127], a[52:55]
  v_exp_f32 v231, v231
  v_mfma_f32_16x16x32_bf16 a[52:55], a[204:207], v[132:135], a[52:55]
  v_exp_f32 v232, v232
  v_mfma_f32_16x16x32_bf16 a[84:87], a[200:203], v[140:143], a[84:87]
  v_cvt_pk_bf16_f32 v76, v224, v225
  v_add_f32 v11, v226, v11
  v_mfma_f32_16x16x32_bf16 a[84:87], a[204:207], v[148:151], a[84:87]
  v_exp_f32 v233, v233
  v_mfma_f32_16x16x32_bf16 a[116:119], a[200:203], v[156:159], a[116:119]
  ds_read_b128 a[176:179], v1 offset:20480
  v_add_f32 v11, v227, v11
  v_mfma_f32_16x16x32_bf16 a[116:119], a[204:207], v[164:167], a[116:119]
  s_waitcnt lgkmcnt(5)
  v_exp_f32 v234, v234
  v_mfma_f32_16x16x32_bf16 a[148:151], a[200:203], v[172:175], a[148:151]
  ds_read_b128 a[180:183], v1 offset:20736
  v_cvt_pk_bf16_f32 v77, v226, v227
  v_mfma_f32_16x16x32_bf16 a[24:27], a[208:211], v[108:111], a[24:27]
  v_exp_f32 v235, v235
  v_mfma_f32_16x16x32_bf16 a[24:27], a[212:215], v[116:119], a[24:27]
  ds_read_b128 a[184:187], v240 offset:20480
  v_cvt_pk_bf16_f32 v92, v228, v229
  v_mfma_f32_16x16x32_bf16 a[56:59], a[208:211], v[124:127], a[56:59]
  v_cvt_pk_bf16_f32 v93, v230, v231
  v_mfma_f32_16x16x32_bf16 a[56:59], a[212:215], v[132:135], a[56:59]
  buffer_load_dwordx4 v8, s[16:19], s97 offen offset:3072 nt lds
  v_mfma_f32_16x16x32_bf16 a[88:91], a[208:211], v[140:143], a[88:91]
  v_exp_f32 v236, v236
  v_mfma_f32_16x16x32_bf16 a[88:91], a[212:215], v[148:151], a[88:91]
  ds_read_b128 a[188:191], v240 offset:20736
  v_add_f32 v9, v232, v9
  v_mfma_f32_16x16x32_bf16 a[120:123], a[208:211], v[156:159], a[120:123]
  s_add_u32 s97, s97, 0x4000
  v_exp_f32 v237, v237
  v_mfma_f32_16x16x32_bf16 a[120:123], a[212:215], v[164:167], a[120:123]
  v_add_f32 v9, v233, v9
  v_cvt_pk_bf16_f32 v46, v232, v233
  v_mfma_f32_16x16x32_bf16 a[152:155], a[208:211], v[172:175], a[152:155]
  s_waitcnt lgkmcnt(4)
  v_exp_f32 v238, v238
  v_mfma_f32_16x16x32_bf16 a[28:31], a[216:219], v[108:111], a[28:31]
  v_add_f32 v9, v234, v9
  v_add_f32 v9, v235, v9
  v_mfma_f32_16x16x32_bf16 a[28:31], a[220:223], v[116:119], a[28:31]
  v_xor_b32 v3, 0x8000, v3
  v_xor_b32 v4, 0x8000, v4
  v_exp_f32 v239, v239
  v_mfma_f32_16x16x32_bf16 a[60:63], a[216:219], v[124:127], a[60:63]
  v_cvt_pk_bf16_f32 v47, v234, v235
  v_cvt_pk_bf16_f32 v62, v236, v237
  v_mfma_f32_16x16x32_bf16 a[60:63], a[220:223], v[132:135], a[60:63]
  v_xor_b32 v5, 0x8000, v5
  v_xor_b32 v6, 0x8000, v6
  v_exp_f32 v20, v20
  v_mfma_f32_16x16x32_bf16 a[92:95], a[216:219], v[140:143], a[92:95]
  v_cvt_pk_bf16_f32 v63, v238, v239
  v_add_f32 v11, v20, v11
  v_mfma_f32_16x16x32_bf16 a[92:95], a[220:223], v[148:151], a[92:95]
  v_exp_f32 v21, v21
  v_mfma_f32_16x16x32_bf16 a[124:127], a[216:219], v[156:159], a[124:127]
  v_add_f32 v11, v21, v11
  v_cvt_pk_bf16_f32 v78, v20, v21
  v_mfma_f32_16x16x32_bf16 a[124:127], a[220:223], v[164:167], a[124:127]
  v_exp_f32 v22, v22
  v_mfma_f32_16x16x32_bf16 a[156:159], a[216:219], v[172:175], a[156:159]
  v_add_f32 v11, v22, v11
  v_mfma_f32_16x16x32_bf16 a[244:247], a[240:243], v[124:127], a[244:247]
  s_waitcnt lgkmcnt(15)
  v_exp_f32 v23, v23
  v_mfma_f32_16x16x32_bf16 a[244:247], a[240:243], v[132:135], a[244:247]
  v_add_f32 v11, v23, v11
  v_cvt_pk_bf16_f32 v79, v22, v23
  v_mfma_f32_16x16x32_bf16 a[248:251], a[240:243], v[156:159], a[248:251]
  s_xor_b32 m0, s74, 0xc000
  v_mfma_f32_16x16x32_bf16 a[248:251], a[240:243], v[164:167], a[248:251]
  buffer_load_dwordx4 v7, s[12:15], s96 offen nt lds
  v_mfma_f32_16x16x32_bf16 v[176:179], a[160:163], v[16:19], 0
  v_exp_f32 v28, v28
  v_mfma_f32_16x16x32_bf16 v[176:179], a[164:167], v[24:27], v[176:179]
  ds_read_b64_tr_b16 a[192:193], v3
  v_mfma_f32_16x16x32_bf16 v[176:179], a[168:171], v[32:35], v[176:179]
  v_exp_f32 v29, v29
  v_mfma_f32_16x16x32_bf16 v[176:179], a[172:175], v[40:43], v[176:179]
  ds_read_b64_tr_b16 a[194:195], v3 offset:4096
  v_cvt_pk_bf16_f32 v94, v28, v29
  v_mfma_f32_16x16x32_bf16 v[180:183], a[160:163], v[48:51], 0
  v_exp_f32 v30, v30
  v_mfma_f32_16x16x32_bf16 v[180:183], a[164:167], v[56:59], v[180:183]
  ds_read_b64_tr_b16 a[196:197], v5
  v_mfma_f32_16x16x32_bf16 v[180:183], a[168:171], v[64:67], v[180:183]
  v_exp_f32 v31, v31
  v_mfma_f32_16x16x32_bf16 v[180:183], a[172:175], v[72:75], v[180:183]
  ds_read_b64_tr_b16 a[198:199], v5 offset:4096
  v_cvt_pk_bf16_f32 v95, v30, v31
  v_mfma_f32_16x16x32_bf16 v[184:187], a[160:163], v[80:83], 0
  v_exp_f32 v176, v176
  v_mfma_f32_16x16x32_bf16 v[184:187], a[164:167], v[88:91], v[184:187]
  ds_read_b64_tr_b16 a[200:201], v4
  v_add_f32 v9, v176, v9
  v_mfma_f32_16x16x32_bf16 v[184:187], a[168:171], v[96:99], v[184:187]
  v_exp_f32 v177, v177
  v_mfma_f32_16x16x32_bf16 v[184:187], a[172:175], v[104:107], v[184:187]
  ds_read_b64_tr_b16 a[202:203], v4 offset:4096
  v_add_f32 v9, v177, v9
  v_mfma_f32_16x16x32_bf16 v[188:191], a[160:163], v[112:115], 0
  v_exp_f32 v178, v178
  v_mfma_f32_16x16x32_bf16 v[188:191], a[164:167], v[120:123], v[188:191]
  ds_read_b64_tr_b16 a[204:205], v6
  v_cvt_pk_bf16_f32 v108, v176, v177
  v_mfma_f32_16x16x32_bf16 v[188:191], a[168:171], v[128:131], v[188:191]
  v_exp_f32 v179, v179
  v_mfma_f32_16x16x32_bf16 v[188:191], a[172:175], v[136:139], v[188:191]
  ds_read_b64_tr_b16 a[206:207], v6 offset:4096
  v_add_f32 v9, v178, v9
  v_mfma_f32_16x16x32_bf16 v[192:195], a[160:163], v[144:147], 0
  v_add_f32 v9, v179, v9
  v_mfma_f32_16x16x32_bf16 v[192:195], a[164:167], v[152:155], v[192:195]
  buffer_load_dwordx4 v7, s[12:15], s96 offen offset:1024 nt lds
  v_mfma_f32_16x16x32_bf16 v[192:195], a[168:171], v[160:163], v[192:195]
  s_waitcnt lgkmcnt(8)
  v_exp_f32 v180, v180
  v_mfma_f32_16x16x32_bf16 v[192:195], a[172:175], v[168:171], v[192:195]
  v_exp_f32 v181, v181
  v_mfma_f32_16x16x32_bf16 v[196:199], a[176:179], v[16:19], 0
  v_exp_f32 v182, v182
  v_mfma_f32_16x16x32_bf16 v[196:199], a[180:183], v[24:27], v[196:199]
  ds_read_b128 a[160:163], v2 offset:16384
  v_cvt_pk_bf16_f32 v109, v178, v179
  v_mfma_f32_16x16x32_bf16 v[196:199], a[184:187], v[32:35], v[196:199]
  v_exp_f32 v183, v183
  v_mfma_f32_16x16x32_bf16 v[196:199], a[188:191], v[40:43], v[196:199]
  ds_read_b128 a[164:167], v2 offset:16640
  v_cvt_pk_bf16_f32 v124, v180, v181
  v_mfma_f32_16x16x32_bf16 v[200:203], a[176:179], v[48:51], 0
  v_exp_f32 v184, v184
  v_mfma_f32_16x16x32_bf16 v[200:203], a[180:183], v[56:59], v[200:203]
  ds_read_b128 a[168:171], v241 offset:16384
  v_cvt_pk_bf16_f32 v125, v182, v183
  v_mfma_f32_16x16x32_bf16 v[200:203], a[184:187], v[64:67], v[200:203]
  v_exp_f32 v185, v185
  v_mfma_f32_16x16x32_bf16 v[200:203], a[188:191], v[72:75], v[200:203]
  ds_read_b128 a[172:175], v241 offset:16640
  v_add_f32 v11, v184, v11
  v_mfma_f32_16x16x32_bf16 v[204:207], a[176:179], v[80:83], 0
  v_exp_f32 v186, v186
  v_mfma_f32_16x16x32_bf16 v[204:207], a[180:183], v[88:91], v[204:207]
  ds_read_b64_tr_b16 a[208:209], v3 offset:256
  v_add_f32 v11, v185, v11
  v_mfma_f32_16x16x32_bf16 v[204:207], a[184:187], v[96:99], v[204:207]
  v_exp_f32 v187, v187
  v_mfma_f32_16x16x32_bf16 v[204:207], a[188:191], v[104:107], v[204:207]
  ds_read_b64_tr_b16 a[210:211], v3 offset:4352
  v_cvt_pk_bf16_f32 v140, v184, v185
  v_mfma_f32_16x16x32_bf16 v[208:211], a[176:179], v[112:115], 0
  v_exp_f32 v188, v188
  v_mfma_f32_16x16x32_bf16 v[208:211], a[180:183], v[120:123], v[208:211]
  ds_read_b64_tr_b16 a[212:213], v5 offset:256
  v_add_f32 v11, v186, v11
  v_mfma_f32_16x16x32_bf16 v[208:211], a[184:187], v[128:131], v[208:211]
  v_add_f32 v11, v187, v11
  v_mfma_f32_16x16x32_bf16 v[208:211], a[188:191], v[136:139], v[208:211]
  buffer_load_dwordx4 v8, s[12:15], s96 offen offset:2048 nt lds
  v_mfma_f32_16x16x32_bf16 v[212:215], a[176:179], v[144:147], 0
  v_exp_f32 v189, v189
  v_mfma_f32_16x16x32_bf16 v[212:215], a[180:183], v[152:155], v[212:215]
  ds_read_b64_tr_b16 a[214:215], v5 offset:4352
  v_cvt_pk_bf16_f32 v141, v186, v187
  v_mfma_f32_16x16x32_bf16 v[212:215], a[184:187], v[160:163], v[212:215]
  s_waitcnt lgkmcnt(4)
  v_exp_f32 v190, v190
  v_mfma_f32_16x16x32_bf16 v[212:215], a[188:191], v[168:171], v[212:215]
  v_exp_f32 v191, v191
  v_mfma_f32_16x16x32_bf16 v[216:219], a[160:163], v[16:19], 0
  v_exp_f32 v192, v192
  v_mfma_f32_16x16x32_bf16 v[216:219], a[164:167], v[24:27], v[216:219]
  ds_read_b128 a[176:179], v2 offset:20480
  v_cvt_pk_bf16_f32 v156, v188, v189
  v_mfma_f32_16x16x32_bf16 v[216:219], a[168:171], v[32:35], v[216:219]
  v_exp_f32 v193, v193
  v_mfma_f32_16x16x32_bf16 v[216:219], a[172:175], v[40:43], v[216:219]
  ds_read_b128 a[180:183], v2 offset:20736
  v_cvt_pk_bf16_f32 v157, v190, v191
  v_mfma_f32_16x16x32_bf16 v[220:223], a[160:163], v[48:51], 0
  v_exp_f32 v194, v194
  v_mfma_f32_16x16x32_bf16 v[220:223], a[164:167], v[56:59], v[220:223]
  ds_read_b128 a[184:187], v241 offset:20480
  v_add_f32 v13, v192, v13
  v_mfma_f32_16x16x32_bf16 v[220:223], a[168:171], v[64:67], v[220:223]
  v_exp_f32 v195, v195
  v_mfma_f32_16x16x32_bf16 v[220:223], a[172:175], v[72:75], v[220:223]
  ds_read_b128 a[188:191], v241 offset:20736
  v_add_f32 v13, v193, v13
  v_mfma_f32_16x16x32_bf16 v[224:227], a[160:163], v[80:83], 0
  v_exp_f32 v196, v196
  v_mfma_f32_16x16x32_bf16 v[224:227], a[164:167], v[88:91], v[224:227]
  v_cvt_pk_bf16_f32 v172, v192, v193
  v_add_f32 v13, v194, v13
  v_mfma_f32_16x16x32_bf16 v[224:227], a[168:171], v[96:99], v[224:227]
  v_exp_f32 v197, v197
  v_mfma_f32_16x16x32_bf16 v[224:227], a[172:175], v[104:107], v[224:227]
  v_exp_f32 v198, v198
  v_mfma_f32_16x16x32_bf16 v[228:231], a[160:163], v[112:115], 0
  v_add_f32 v13, v195, v13
  v_mfma_f32_16x16x32_bf16 v[228:231], a[164:167], v[120:123], v[228:231]
  buffer_load_dwordx4 v8, s[12:15], s96 offen offset:3072 nt lds
  v_mfma_f32_16x16x32_bf16 v[228:231], a[168:171], v[128:131], v[228:231]
  s_waitcnt lgkmcnt(0)
  v_exp_f32 v199, v199
  v_mfma_f32_16x16x32_bf16 v[228:231], a[172:175], v[136:139], v[228:231]
  ds_read_b64_tr_b16 a[216:217], v4 offset:256
  v_cvt_pk_bf16_f32 v173, v194, v195
  v_mfma_f32_16x16x32_bf16 v[232:235], a[176:179], v[16:19], 0
  s_add_u32 s96, s96, 0x4000
  v_xor_b32 v1, 0x8000, v1
  v_xor_b32 v2, 0x8000, v2
  v_exp_f32 v200, v200
  v_mfma_f32_16x16x32_bf16 v[232:235], a[180:183], v[24:27], v[232:235]
  ds_read_b64_tr_b16 a[218:219], v4 offset:4352
  v_add_f32 v9, v196, v9
  v_mfma_f32_16x16x32_bf16 v[232:235], a[184:187], v[32:35], v[232:235]
  v_xor_b32 v240, 0x8000, v240
  v_xor_b32 v241, 0x8000, v241
  v_exp_f32 v201, v201
  v_mfma_f32_16x16x32_bf16 v[232:235], a[188:191], v[40:43], v[232:235]
  ds_read_b64_tr_b16 a[220:221], v6 offset:256
  v_add_f32 v9, v197, v9
  v_mfma_f32_16x16x32_bf16 v[236:239], a[176:179], v[48:51], 0
  v_exp_f32 v202, v202
  v_mfma_f32_16x16x32_bf16 v[236:239], a[180:183], v[56:59], v[236:239]
  ds_read_b64_tr_b16 a[222:223], v6 offset:4352
  v_cvt_pk_bf16_f32 v110, v196, v197
  v_mfma_f32_16x16x32_bf16 v[236:239], a[184:187], v[64:67], v[236:239]
  v_exp_f32 v203, v203
  v_mfma_f32_16x16x32_bf16 v[236:239], a[188:191], v[72:75], v[236:239]
  v_add_f32 v9, v198, v9
  v_add_f32 v9, v199, v9
  v_mfma_f32_16x16x32_bf16 v[20:23], a[176:179], v[80:83], 0
  v_exp_f32 v204, v204
  v_mfma_f32_16x16x32_bf16 v[20:23], a[180:183], v[88:91], v[20:23]
  v_cvt_pk_bf16_f32 v111, v198, v199
  v_cvt_pk_bf16_f32 v126, v200, v201
  v_mfma_f32_16x16x32_bf16 v[20:23], a[184:187], v[96:99], v[20:23]
  v_exp_f32 v205, v205
  v_mfma_f32_16x16x32_bf16 v[20:23], a[188:191], v[104:107], v[20:23]
  v_cvt_pk_bf16_f32 v127, v202, v203
  v_add_f32 v11, v204, v11
  v_mfma_f32_16x16x32_bf16 v[28:31], a[176:179], v[112:115], 0
  s_waitcnt lgkmcnt(15)
  v_exp_f32 v206, v206
  v_mfma_f32_16x16x32_bf16 v[28:31], a[180:183], v[120:123], v[28:31]
  v_exp_f32 v207, v207
  s_sub_u32 s71, s71, 1
  s_cmp_lg_u32 s71, 0
  s_cbranch_scc1 L_aloop
  v_mfma_f32_16x16x32_bf16 v[28:31], a[184:187], v[128:131], v[28:31]
  s_waitcnt vmcnt(0)
  v_exp_f32 v208, v208
  v_mfma_f32_16x16x32_bf16 v[28:31], a[188:191], v[136:139], v[28:31]
  v_exp_f32 v209, v209
  v_mfma_f32_16x16x32_bf16 a[0:3], a[192:195], v[36:39], a[0:3]
  s_barrier
  v_exp_f32 v210, v210
  v_lshrrev_b32 v249, 4, v14
  v_bfe_u32 v250, v14, 1, 2
  v_xor_b32 v250, v250, v249
  v_lshlrev_b32 v250, 5, v250
  v_lshrrev_b32 v249, 3, v14
  v_lshl_add_u32 v250, v249, 10, v250
  v_and_b32 v249, 1, v14
  v_lshl_add_u32 v250, v249, 4, v250
  s_lshl_b32 s42, s3, 19
  v_add_u32 v7, s42, v250
  v_add_u32 v8, 0x1c00, v7
  v_add_u32 v254, 0x3800, v7
  v_add_u32 v255, 0x5400, v7
  s_lshl_b32 s42, s68, 21
  s_lshl_b32 s43, s67, 7
  s_add_u32 s42, s42, s43
  s_sub_u32 s43, 0x400000, s42
  s_add_u32 s24, s56, s42
  s_addc_u32 s25, s57, 0
  s_mov_b32 s26, s43
  s_mov_b32 s27, 0x20000
  v_mfma_f32_16x16x32_bf16 a[0:3], a[196:199], v[44:47], a[0:3]
  v_add_f32 v11, v205, v11
  v_mfma_f32_16x16x32_bf16 a[32:35], a[192:195], v[52:55], a[32:35]
  ds_read_b64_tr_b16 a[160:161], v3 offset:16896
  v_cvt_pk_bf16_f32 v142, v204, v205
  v_mfma_f32_16x16x32_bf16 a[32:35], a[196:199], v[60:63], a[32:35]
  s_mov_b32 s100, 0
  s_add_u32 m0, s75, 0
  v_mfma_f32_16x16x32_bf16 a[64:67], a[192:195], v[68:71], a[64:67]
  buffer_load_dwordx4 v7, s[24:27], s100 offen lds
  v_exp_f32 v211, v211
  v_mfma_f32_16x16x32_bf16 a[64:67], a[196:199], v[76:79], a[64:67]
  ds_read_b64_tr_b16 a[162:163], v3 offset:20992
  v_add_f32 v11, v206, v11
  v_mfma_f32_16x16x32_bf16 a[96:99], a[192:195], v[84:87], a[96:99]
  v_exp_f32 v212, v212
  v_mfma_f32_16x16x32_bf16 a[96:99], a[196:199], v[92:95], a[96:99]
  buffer_load_dwordx4 v8, s[24:27], s100 offen offset:1024 lds
  v_add_f32 v11, v207, v11
  v_mfma_f32_16x16x32_bf16 a[128:131], a[192:195], v[100:103], a[128:131]
  s_waitcnt lgkmcnt(15)
  v_exp_f32 v213, v213
  v_mfma_f32_16x16x32_bf16 a[4:7], a[200:203], v[36:39], a[4:7]
  ds_read_b64_tr_b16 a[192:193], v3 offset:512
  v_cvt_pk_bf16_f32 v143, v206, v207
  v_mfma_f32_16x16x32_bf16 a[4:7], a[204:207], v[44:47], a[4:7]
  v_exp_f32 v214, v214
  v_mfma_f32_16x16x32_bf16 a[36:39], a[200:203], v[52:55], a[36:39]
  ds_read_b64_tr_b16 a[194:195], v3 offset:4608
  v_cvt_pk_bf16_f32 v158, v208, v209
  v_mfma_f32_16x16x32_bf16 a[36:39], a[204:207], v[60:63], a[36:39]
  ds_read_b64_tr_b16 a[168:169], v4 offset:16896
  v_exp_f32 v215, v215
  v_mfma_f32_16x16x32_bf16 a[68:71], a[200:203], v[68:71], a[68:71]
  ds_read_b64_tr_b16 a[196:197], v5 offset:512
  v_cvt_pk_bf16_f32 v159, v210, v211
  v_mfma_f32_16x16x32_bf16 a[68:71], a[204:207], v[76:79], a[68:71]
  buffer_load_dwordx4 v254, s[24:27], s100 offen offset:2048 lds
  v_exp_f32 v216, v216
  v_mfma_f32_16x16x32_bf16 a[100:103], a[200:203], v[84:87], a[100:103]
  ds_read_b64_tr_b16 a[198:199], v5 offset:4608
  v_add_f32 v13, v212, v13
  v_mfma_f32_16x16x32_bf16 a[100:103], a[204:207], v[92:95], a[100:103]
  s_waitcnt lgkmcnt(15)
  v_exp_f32 v217, v217
  v_mfma_f32_16x16x32_bf16 a[132:135], a[200:203], v[100:103], a[132:135]
  v_add_f32 v13, v213, v13
  v_mfma_f32_16x16x32_bf16 a[8:11], a[208:211], v[36:39], a[8:11]
  ds_read_b64_tr_b16 a[170:171], v4 offset:20992
  v_exp_f32 v218, v218
  v_mfma_f32_16x16x32_bf16 a[8:11], a[212:215], v[44:47], a[8:11]
  ds_read_b64_tr_b16 a[200:201], v4 offset:512
  v_cvt_pk_bf16_f32 v174, v212, v213
  v_mfma_f32_16x16x32_bf16 a[40:43], a[208:211], v[52:55], a[40:43]
  buffer_load_dwordx4 v255, s[24:27], s100 offen offset:3072 lds
  v_add_f32 v13, v214, v13
  v_mfma_f32_16x16x32_bf16 a[40:43], a[212:215], v[60:63], a[40:43]
  v_mfma_f32_16x16x32_bf16 a[72:75], a[208:211], v[68:71], a[72:75]
  ds_read_b64_tr_b16 a[176:177], v3 offset:17152
  v_exp_f32 v219, v219
  v_mfma_f32_16x16x32_bf16 a[72:75], a[212:215], v[76:79], a[72:75]
  ds_read_b64_tr_b16 a[202:203], v4 offset:4608
  v_add_f32 v13, v215, v13
  v_mfma_f32_16x16x32_bf16 a[104:107], a[208:211], v[84:87], a[104:107]
  v_exp_f32 v220, v220
  v_mfma_f32_16x16x32_bf16 a[104:107], a[212:215], v[92:95], a[104:107]
  ds_read_b64_tr_b16 a[204:205], v6 offset:512
  v_cvt_pk_bf16_f32 v175, v214, v215
  v_mfma_f32_16x16x32_bf16 a[136:139], a[208:211], v[100:103], a[136:139]
  s_waitcnt lgkmcnt(12)
  v_exp_f32 v221, v221
  v_mfma_f32_16x16x32_bf16 a[12:15], a[216:219], v[36:39], a[12:15]
  ds_read_b64_tr_b16 a[206:207], v6 offset:4608
  v_add_f32 v9, v216, v9
  s_mov_b32 s100, 0x8000
  s_add_u32 m0, s75, 0x4000
  v_mfma_f32_16x16x32_bf16 a[12:15], a[220:223], v[44:47], a[12:15]
  buffer_load_dwordx4 v7, s[24:27], s100 offen lds
  v_exp_f32 v222, v222
  v_mfma_f32_16x16x32_bf16 a[44:47], a[216:219], v[52:55], a[44:47]
  ds_read_b64_tr_b16 a[208:209], v3 offset:768
  v_add_f32 v9, v217, v9
  v_mfma_f32_16x16x32_bf16 a[44:47], a[220:223], v[60:63], a[44:47]
  ds_read_b64_tr_b16 a[178:179], v3 offset:21248
  v_exp_f32 v223, v223
  v_mfma_f32_16x16x32_bf16 a[76:79], a[216:219], v[68:71], a[76:79]
  ds_read_b64_tr_b16 a[210:211], v3 offset:4864
  v_cvt_pk_bf16_f32 v116, v216, v217
  v_mfma_f32_16x16x32_bf16 a[76:79], a[220:223], v[76:79], a[76:79]
  v_exp_f32 v224, v224
  v_mfma_f32_16x16x32_bf16 a[108:111], a[216:219], v[84:87], a[108:111]
  ds_read_b64_tr_b16 a[212:213], v5 offset:768
  v_add_f32 v9, v218, v9
  v_mfma_f32_16x16x32_bf16 a[108:111], a[220:223], v[92:95], a[108:111]
  s_waitcnt lgkmcnt(10)
  v_exp_f32 v225, v225
  v_mfma_f32_16x16x32_bf16 a[140:143], a[216:219], v[100:103], a[140:143]
  ds_read_b64_tr_b16 a[214:215], v5 offset:4864
  v_add_f32 v9, v219, v9
  v_mfma_f32_16x16x32_bf16 a[16:19], a[192:195], v[36:39], a[16:19]
  buffer_load_dwordx4 v8, s[24:27], s100 offen offset:1024 lds
  v_exp_f32 v226, v226
  v_mfma_f32_16x16x32_bf16 a[16:19], a[196:199], v[44:47], a[16:19]
  ds_read_b64_tr_b16 a[216:217], v4 offset:768
  v_cvt_pk_bf16_f32 v117, v218, v219
  v_mfma_f32_16x16x32_bf16 a[48:51], a[192:195], v[52:55], a[48:51]
  ds_read_b64_tr_b16 a[184:185], v4 offset:17152
  v_cvt_pk_bf16_f32 v132, v220, v221
  v_mfma_f32_16x16x32_bf16 a[48:51], a[196:199], v[60:63], a[48:51]
  v_mfma_f32_16x16x32_bf16 a[80:83], a[192:195], v[68:71], a[80:83]
  buffer_load_dwordx4 v254, s[24:27], s100 offen offset:2048 lds
  v_exp_f32 v227, v227
  v_mfma_f32_16x16x32_bf16 a[80:83], a[196:199], v[76:79], a[80:83]
  ds_read_b64_tr_b16 a[218:219], v4 offset:4864
  v_cvt_pk_bf16_f32 v133, v222, v223
  v_mfma_f32_16x16x32_bf16 a[112:115], a[192:195], v[84:87], a[112:115]
  v_exp_f32 v228, v228
  v_mfma_f32_16x16x32_bf16 a[112:115], a[196:199], v[92:95], a[112:115]
  ds_read_b64_tr_b16 a[220:221], v6 offset:768
  v_add_f32 v11, v224, v11
  v_mfma_f32_16x16x32_bf16 a[144:147], a[192:195], v[100:103], a[144:147]
  s_waitcnt lgkmcnt(9)
  v_exp_f32 v229, v229
  v_mfma_f32_16x16x32_bf16 a[20:23], a[200:203], v[36:39], a[20:23]
  ds_read_b64_tr_b16 a[222:223], v6 offset:4864
  v_add_f32 v11, v225, v11
  v_mfma_f32_16x16x32_bf16 a[20:23], a[204:207], v[44:47], a[20:23]
  ds_read_b64_tr_b16 a[186:187], v4 offset:21248
  v_exp_f32 v230, v230
  v_mfma_f32_16x16x32_bf16 a[52:55], a[200:203], v[52:55], a[52:55]
  buffer_load_dwordx4 v255, s[24:27], s100 offen offset:3072 lds
  v_exp_f32 v231, v231
  v_mfma_f32_16x16x32_bf16 a[52:55], a[204:207], v[60:63], a[52:55]
  v_exp_f32 v232, v232
  v_mfma_f32_16x16x32_bf16 a[84:87], a[200:203], v[68:71], a[84:87]
  ds_read_b64_tr_b16 a[164:165], v5 offset:16896
  v_cvt_pk_bf16_f32 v148, v224, v225
  v_add_f32 v11, v226, v11
  s_mov_b32 s100, 0x10000
  s_add_u32 m0, s75, 0x8000
  v_mfma_f32_16x16x32_bf16 a[84:87], a[204:207], v[76:79], a[84:87]
  buffer_load_dwordx4 v7, s[24:27], s100 offen lds
  v_exp_f32 v233, v233
  v_mfma_f32_16x16x32_bf16 a[116:119], a[200:203], v[84:87], a[116:119]
  v_add_f32 v11, v227, v11
  v_mfma_f32_16x16x32_bf16 a[116:119], a[204:207], v[92:95], a[116:119]
  s_waitcnt lgkmcnt(7)
  v_exp_f32 v234, v234
  v_mfma_f32_16x16x32_bf16 a[148:151], a[200:203], v[100:103], a[148:151]
  ds_read_b64_tr_b16 a[166:167], v5 offset:20992
  v_cvt_pk_bf16_f32 v149, v226, v227
  v_mfma_f32_16x16x32_bf16 a[24:27], a[208:211], v[36:39], a[24:27]
  v_exp_f32 v235, v235
  v_mfma_f32_16x16x32_bf16 a[24:27], a[212:215], v[44:47], a[24:27]
  buffer_load_dwordx4 v8, s[24:27], s100 offen offset:1024 lds
  v_cvt_pk_bf16_f32 v164, v228, v229
  v_mfma_f32_16x16x32_bf16 a[56:59], a[208:211], v[52:55], a[56:59]
  ds_read_b64_tr_b16 a[172:173], v6 offset:16896
  v_cvt_pk_bf16_f32 v165, v230, v231
  v_mfma_f32_16x16x32_bf16 a[56:59], a[212:215], v[60:63], a[56:59]
  v_mfma_f32_16x16x32_bf16 a[88:91], a[208:211], v[68:71], a[88:91]
  buffer_load_dwordx4 v254, s[24:27], s100 offen offset:2048 lds
  v_exp_f32 v236, v236
  v_mfma_f32_16x16x32_bf16 a[88:91], a[212:215], v[76:79], a[88:91]
  ds_read_b64_tr_b16 a[174:175], v6 offset:20992
  v_add_f32 v9, v232, v9
  v_mfma_f32_16x16x32_bf16 a[120:123], a[208:211], v[84:87], a[120:123]
  v_exp_f32 v237, v237
  v_mfma_f32_16x16x32_bf16 a[120:123], a[212:215], v[92:95], a[120:123]
  buffer_load_dwordx4 v255, s[24:27], s100 offen offset:3072 lds
  v_add_f32 v9, v233, v9
  v_cvt_pk_bf16_f32 v118, v232, v233
  v_mfma_f32_16x16x32_bf16 a[152:155], a[208:211], v[100:103], a[152:155]
  s_waitcnt lgkmcnt(5)
  v_exp_f32 v238, v238
  v_mfma_f32_16x16x32_bf16 a[28:31], a[216:219], v[36:39], a[28:31]
  v_add_f32 v9, v234, v9
  v_add_f32 v9, v235, v9
  v_mfma_f32_16x16x32_bf16 a[28:31], a[220:223], v[44:47], a[28:31]
  ds_read_b64_tr_b16 a[180:181], v5 offset:17152
  v_exp_f32 v239, v239
  s_mov_b32 s100, 0x18000
  s_add_u32 m0, s75, 0xc000
  v_mfma_f32_16x16x32_bf16 a[60:63], a[216:219], v[52:55], a[60:63]
  buffer_load_dwordx4 v7, s[24:27], s100 offen lds
  v_cvt_pk_bf16_f32 v119, v234, v235
  v_cvt_pk_bf16_f32 v134, v236, v237
  v_mfma_f32_16x16x32_bf16 a[60:63], a[220:223], v[60:63], a[60:63]
  v_exp_f32 v20, v20
  v_mfma_f32_16x16x32_bf16 a[92:95], a[216:219], v[68:71], a[92:95]
  ds_read_b64_tr_b16 a[182:183], v5 offset:21248
  v_cvt_pk_bf16_f32 v135, v238, v239
  v_add_f32 v11, v20, v11
  v_mfma_f32_16x16x32_bf16 a[92:95], a[220:223], v[76:79], a[92:95]
  buffer_load_dwordx4 v8, s[24:27], s100 offen offset:1024 lds
  v_exp_f32 v21, v21
  v_mfma_f32_16x16x32_bf16 a[124:127], a[216:219], v[84:87], a[124:127]
  v_add_f32 v11, v21, v11
  v_cvt_pk_bf16_f32 v150, v20, v21
  v_mfma_f32_16x16x32_bf16 a[124:127], a[220:223], v[92:95], a[124:127]
  ds_read_b64_tr_b16 a[188:189], v6 offset:17152
  v_exp_f32 v22, v22
  v_mfma_f32_16x16x32_bf16 a[156:159], a[216:219], v[100:103], a[156:159]
  v_add_f32 v11, v22, v11
  v_mfma_f32_16x16x32_bf16 a[244:247], a[240:243], v[52:55], a[244:247]
  buffer_load_dwordx4 v254, s[24:27], s100 offen offset:2048 lds
  v_exp_f32 v23, v23
  v_mfma_f32_16x16x32_bf16 a[244:247], a[240:243], v[60:63], a[244:247]
  ds_read_b64_tr_b16 a[190:191], v6 offset:21248
  v_add_f32 v11, v23, v11
  v_cvt_pk_bf16_f32 v151, v22, v23
  v_mfma_f32_16x16x32_bf16 a[248:251], a[240:243], v[84:87], a[248:251]
  v_mfma_f32_16x16x32_bf16 a[248:251], a[240:243], v[92:95], a[248:251]
  buffer_load_dwordx4 v255, s[24:27], s100 offen offset:3072 lds
  s_waitcnt lgkmcnt(8)
  v_mfma_f32_16x16x32_bf16 a[144:147], a[160:163], v[172:175], a[144:147]
  ds_read_b64_tr_b16 a[192:193], v3 offset:16384
  v_exp_f32 v28, v28
  v_exp_f32 v29, v29
  v_mfma_f32_16x16x32_bf16 a[148:151], a[168:171], v[172:175], a[148:151]
  ds_read_b64_tr_b16 a[194:195], v3 offset:20480
  v_cvt_pk_bf16_f32 v166, v28, v29
  v_exp_f32 v30, v30
  v_exp_f32 v31, v31
  v_mfma_f32_16x16x32_bf16 a[152:155], a[176:179], v[172:175], a[152:155]
  ds_read_b64_tr_b16 a[200:201], v4 offset:16384
  v_cvt_pk_bf16_f32 v167, v30, v31
  v_lshlrev_b32 v249, 4, v14
  s_add_u32 s42, s75, 0x20000
  v_add_u32 v250, s42, v249
  v_xor_b32 v251, 0x2000, v250
  v_mfma_f32_16x16x32_bf16 a[156:159], a[184:187], v[172:175], a[156:159]
  ds_read_b64_tr_b16 a[202:203], v4 offset:20480
  ds_read_b64_tr_b16 a[208:209], v3 offset:16640
  ds_read_b64_tr_b16 a[210:211], v3 offset:20736
  ds_read_b64_tr_b16 a[216:217], v4 offset:16640
  ds_read_b64_tr_b16 a[218:219], v4 offset:20736
  ds_read_b64_tr_b16 a[196:197], v5 offset:16384
  s_waitcnt lgkmcnt(1)
  s_lshl_b32 s42, s3, 8
  s_add_u32 s42, s42, 0x24000
  v_lshl_add_u32 v252, v14, 2, s42
  s_lshl_b32 s42, s3, 19
  v_add_u32 v1, s42, v249
  s_and_b32 s42, s3, 1
  s_add_u32 s42, s42, 16
  s_lshl_b32 s42, s42, 17
  s_lshr_b32 s43, s3, 1
  s_lshl_b32 s43, s43, 11
  s_add_u32 s42, s42, s43
  v_add_u32 v2, s42, v249
  v_mov_b32 v249, v9
  v_mfma_f32_16x16x32_bf16 a[128:131], a[192:195], v[172:175], a[128:131]
  ds_read_b64_tr_b16 a[198:199], v5 offset:20480
  s_nop 1
  v_permlane32_swap_b32 v9, v249
  v_add_f32 v9, v9, v249
  v_mov_b32 v249, v9
  s_nop 1
  v_permlane16_swap_b32 v9, v249
  v_mfma_f32_16x16x32_bf16 a[132:135], a[200:203], v[172:175], a[132:135]
  ds_read_b64_tr_b16 a[204:205], v6 offset:16384
  v_add_f32 v9, v9, v249
  v_subrev_u32 v240, 0x2b800000, v9
  v_rcp_f32 v9, v9
  v_mfma_f32_16x16x32_bf16 a[136:139], a[208:211], v[172:175], a[136:139]
  ds_read_b64_tr_b16 a[206:207], v6 offset:20480
  v_mov_b32 v249, v11
  s_nop 1
  v_permlane32_swap_b32 v11, v249
  v_add_f32 v11, v11, v249
  v_mov_b32 v249, v11
  v_mfma_f32_16x16x32_bf16 a[140:143], a[216:219], v[172:175], a[140:143]
  ds_read_b64_tr_b16 a[212:213], v5 offset:16640
  s_waitcnt lgkmcnt(15)
  s_nop 1
  v_permlane16_swap_b32 v11, v249
  v_add_f32 v11, v11, v249
  v_subrev_u32 v242, 0x2b800000, v11
  v_rcp_f32 v11, v11
  v_mfma_f32_16x16x32_bf16 a[16:19], a[160:163], v[108:111], a[16:19]
  ds_read_b64_tr_b16 a[214:215], v5 offset:20736
  v_mov_b32 v244, v13
  v_mov_b32 v249, v244
  s_nop 1
  v_permlane32_swap_b32 v244, v249
  v_add_f32 v244, v244, v249
  v_mfma_f32_16x16x32_bf16 a[16:19], a[164:167], v[116:119], a[16:19]
  ds_read_b64_tr_b16 a[220:221], v6 offset:16640
  v_mov_b32 v249, v244
  s_nop 1
  v_permlane16_swap_b32 v244, v249
  v_add_f32 v244, v244, v249
  v_subrev_u32 v244, 0x2b800000, v244
  v_mfma_f32_16x16x32_bf16 a[244:247], a[240:243], v[124:127], a[244:247]
  ds_read_b64_tr_b16 a[222:223], v6 offset:20736
  s_mov_b32 s100, 0x20000
  s_add_u32 m0, s75, 0x10000
  v_mfma_f32_16x16x32_bf16 a[244:247], a[240:243], v[132:135], a[244:247]
  buffer_load_dwordx4 v7, s[24:27], s100 offen lds
  v_mfma_f32_16x16x32_bf16 a[248:251], a[240:243], v[156:159], a[248:251]
  v_mfma_f32_16x16x32_bf16 a[248:251], a[240:243], v[164:167], a[248:251]
  buffer_load_dwordx4 v8, s[24:27], s100 offen offset:1024 lds
  v_mfma_f32_16x16x32_bf16 a[20:23], a[168:171], v[108:111], a[20:23]
  v_mfma_f32_16x16x32_bf16 a[20:23], a[172:175], v[116:119], a[20:23]
  buffer_load_dwordx4 v254, s[24:27], s100 offen offset:2048 lds
  v_mfma_f32_16x16x32_bf16 a[24:27], a[176:179], v[108:111], a[24:27]
  v_mfma_f32_16x16x32_bf16 a[24:27], a[180:183], v[116:119], a[24:27]
  buffer_load_dwordx4 v255, s[24:27], s100 offen offset:3072 lds
  s_cmp_ge_u32 s3, 2
  s_cbranch_scc1 L_cx1
  ds_write_b128 v250, a[144:147]
  ds_write_b128 v250, a[148:151] offset:1024
  ds_write_b128 v250, a[152:155] offset:2048
  ds_write_b128 v250, a[156:159] offset:3072
L_cx1r:
  ds_write_b32 v252, v13
  v_xor_b32 v252, 0x200, v252
  v_mfma_f32_16x16x32_bf16 a[28:31], a[184:187], v[108:111], a[28:31]
  s_mov_b32 s100, 0x28000
  s_add_u32 m0, s75, 0x14000
  v_mfma_f32_16x16x32_bf16 a[28:31], a[188:191], v[116:119], a[28:31]
  buffer_load_dwordx4 v7, s[24:27], s100 offen lds
  s_waitcnt lgkmcnt(5)
  v_accvgpr_read_b32 v10, a244
  v_subrev_u32 v241, 0x2b800000, v10
  v_rcp_f32 v10, v10
  v_mfma_f32_16x16x32_bf16 a[0:3], a[192:195], v[108:111], a[0:3]
  v_accvgpr_read_b32 v12, a248
  v_subrev_u32 v243, 0x2b800000, v12
  v_rcp_f32 v12, v12
  v_mfma_f32_16x16x32_bf16 a[0:3], a[196:199], v[116:119], a[0:3]
  buffer_load_dwordx4 v8, s[24:27], s100 offen offset:1024 lds
  v_max3_u32 v244, v244, v240, v241
  v_max3_u32 v244, v244, v242, v243
  s_lshl_b32 s42, s3, 2
  s_add_u32 s42, s42, 0x24400
  v_lshl_add_u32 v245, v14, 4, s42
  v_and_b32 v246, -16, v245
  v_mfma_f32_16x16x32_bf16 a[4:7], a[200:203], v[108:111], a[4:7]
  ds_write_b32 v245, v244
  v_mfma_f32_16x16x32_bf16 a[4:7], a[204:207], v[116:119], a[4:7]
  buffer_load_dwordx4 v254, s[24:27], s100 offen offset:2048 lds
  v_mfma_f32_16x16x32_bf16 a[8:11], a[208:211], v[108:111], a[8:11]
  v_mfma_f32_16x16x32_bf16 a[8:11], a[212:215], v[116:119], a[8:11]
  buffer_load_dwordx4 v255, s[24:27], s100 offen offset:3072 lds
  v_mfma_f32_16x16x32_bf16 a[12:15], a[216:219], v[108:111], a[12:15]
  v_mfma_f32_16x16x32_bf16 a[12:15], a[220:223], v[116:119], a[12:15]
  v_mfma_f32_16x16x32_bf16 a[48:51], a[160:163], v[124:127], a[48:51]
  v_mfma_f32_16x16x32_bf16 a[48:51], a[164:167], v[132:135], a[48:51]
  v_mfma_f32_16x16x32_bf16 a[52:55], a[168:171], v[124:127], a[52:55]
  s_mov_b32 s43, 0
  v_accvgpr_read_b32 v192, a0
  v_accvgpr_read_b32 v193, a1
  v_accvgpr_read_b32 v194, a2
  v_accvgpr_read_b32 v195, a3
  v_mul_f32 v192, v9, v192
  v_mul_f32 v193, v9, v193
  v_mfma_f32_16x16x32_bf16 a[52:55], a[172:175], v[132:135], a[52:55]
  v_mul_f32 v194, v9, v194
  v_mul_f32 v195, v9, v195
  v_accvgpr_read_b32 v196, a4
  v_accvgpr_read_b32 v197, a5
  v_accvgpr_read_b32 v198, a6
  v_accvgpr_read_b32 v199, a7
  v_mfma_f32_16x16x32_bf16 a[56:59], a[176:179], v[124:127], a[56:59]
  v_mul_f32 v196, v9, v196
  v_mul_f32 v197, v9, v197
  v_mul_f32 v198, v9, v198
  v_mul_f32 v199, v9, v199
  v_cvt_pk_bf16_f32 v192, v192, v193
  v_cvt_pk_bf16_f32 v193, v194, v195
  v_mfma_f32_16x16x32_bf16 a[56:59], a[180:183], v[132:135], a[56:59]
  v_cvt_pk_bf16_f32 v194, v196, v197
  v_cvt_pk_bf16_f32 v195, v198, v199
  buffer_store_dwordx4 v[192:195], v1, s[20:23], s43 offen sc1
  v_accvgpr_read_b32 v200, a8
  v_accvgpr_read_b32 v201, a9
  v_accvgpr_read_b32 v202, a10
  v_mfma_f32_16x16x32_bf16 a[60:63], a[184:187], v[124:127], a[60:63]
  s_waitcnt lgkmcnt(0)
  s_barrier
  ds_read_b128 v[176:179], v251
  ds_read_b128 v[180:183], v251 offset:1024
  ds_read_b128 v[184:187], v251 offset:2048
  ds_read_b128 v[188:191], v251 offset:3072
  ds_read_b32 v253, v252
  ds_read_b128 v[240:243], v246
  v_accvgpr_read_b32 v203, a11
  v_mul_f32 v200, v9, v200
  v_mul_f32 v201, v9, v201
  v_mul_f32 v202, v9, v202
  v_mul_f32 v203, v9, v203
  v_accvgpr_read_b32 v204, a12
  v_mfma_f32_16x16x32_bf16 a[60:63], a[188:191], v[132:135], a[60:63]
  v_accvgpr_read_b32 v205, a13
  v_accvgpr_read_b32 v206, a14
  v_accvgpr_read_b32 v207, a15
  v_mul_f32 v204, v9, v204
  v_mul_f32 v205, v9, v205
  v_mul_f32 v206, v9, v206
  v_mfma_f32_16x16x32_bf16 a[32:35], a[192:195], v[124:127], a[32:35]
  v_mul_f32 v207, v9, v207
  v_cvt_pk_bf16_f32 v200, v200, v201
  v_cvt_pk_bf16_f32 v201, v202, v203
  v_cvt_pk_bf16_f32 v202, v204, v205
  v_cvt_pk_bf16_f32 v203, v206, v207
  buffer_store_dwordx4 v[200:203], v1, s[20:23], s43 offen offset:1024 sc1
  v_mfma_f32_16x16x32_bf16 a[32:35], a[196:199], v[132:135], a[32:35]
  v_accvgpr_read_b32 v192, a16
  v_accvgpr_read_b32 v193, a17
  v_accvgpr_read_b32 v194, a18
  v_accvgpr_read_b32 v195, a19
  v_mul_f32 v192, v9, v192
  v_mul_f32 v193, v9, v193
  v_mfma_f32_16x16x32_bf16 a[36:39], a[200:203], v[124:127], a[36:39]
  v_mul_f32 v194, v9, v194
  v_mul_f32 v195, v9, v195
  v_accvgpr_read_b32 v196, a20
  v_accvgpr_read_b32 v197, a21
  v_accvgpr_read_b32 v198, a22
  v_accvgpr_read_b32 v199, a23
  v_mfma_f32_16x16x32_bf16 a[36:39], a[204:207], v[132:135], a[36:39]
  v_mul_f32 v196, v9, v196
  v_mul_f32 v197, v9, v197
  v_mul_f32 v198, v9, v198
  v_mul_f32 v199, v9, v199
  v_cvt_pk_bf16_f32 v192, v192, v193
  v_cvt_pk_bf16_f32 v193, v194, v195
  v_mfma_f32_16x16x32_bf16 a[40:43], a[208:211], v[124:127], a[40:43]
  v_cvt_pk_bf16_f32 v194, v196, v197
  v_cvt_pk_bf16_f32 v195, v198, v199
  buffer_store_dwordx4 v[192:195], v1, s[20:23], s43 offen offset:2048 sc1
  v_accvgpr_read_b32 v200, a24
  v_accvgpr_read_b32 v201, a25
  v_accvgpr_read_b32 v202, a26
  v_mfma_f32_16x16x32_bf16 a[40:43], a[212:215], v[132:135], a[40:43]
  v_accvgpr_read_b32 v203, a27
  v_mul_f32 v200, v9, v200
  v_mul_f32 v201, v9, v201
  v_mul_f32 v202, v9, v202
  v_mul_f32 v203, v9, v203
  v_accvgpr_read_b32 v204, a28
  v_mfma_f32_16x16x32_bf16 a[44:47], a[216:219], v[124:127], a[44:47]
  v_accvgpr_read_b32 v205, a29
  v_accvgpr_read_b32 v206, a30
  v_accvgpr_read_b32 v207, a31
  v_mul_f32 v204, v9, v204
  v_mul_f32 v205, v9, v205
  v_mul_f32 v206, v9, v206
  v_mfma_f32_16x16x32_bf16 a[44:47], a[220:223], v[132:135], a[44:47]
  v_mul_f32 v207, v9, v207
  v_cvt_pk_bf16_f32 v200, v200, v201
  v_cvt_pk_bf16_f32 v201, v202, v203
  v_cvt_pk_bf16_f32 v202, v204, v205
  v_cvt_pk_bf16_f32 v203, v206, v207
  buffer_store_dwordx4 v[200:203], v1, s[20:23], s43 offen offset:3072 sc1
  v_mfma_f32_16x16x32_bf16 a[80:83], a[160:163], v[140:143], a[80:83]
  v_mfma_f32_16x16x32_bf16 a[80:83], a[164:167], v[148:151], a[80:83]
  v_mfma_f32_16x16x32_bf16 a[84:87], a[168:171], v[140:143], a[84:87]
  s_mov_b32 s43, 0x20000
  v_accvgpr_read_b32 v192, a32
  v_accvgpr_read_b32 v193, a33
  v_accvgpr_read_b32 v194, a34
  v_accvgpr_read_b32 v195, a35
  v_mul_f32 v192, v10, v192
  v_mul_f32 v193, v10, v193
  v_mfma_f32_16x16x32_bf16 a[84:87], a[172:175], v[148:151], a[84:87]
  v_mul_f32 v194, v10, v194
  v_mul_f32 v195, v10, v195
  v_accvgpr_read_b32 v196, a36
  v_accvgpr_read_b32 v197, a37
  v_accvgpr_read_b32 v198, a38
  v_accvgpr_read_b32 v199, a39
  v_mfma_f32_16x16x32_bf16 a[88:91], a[176:179], v[140:143], a[88:91]
  v_mul_f32 v196, v10, v196
  v_mul_f32 v197, v10, v197
  v_mul_f32 v198, v10, v198
  v_mul_f32 v199, v10, v199
  v_cvt_pk_bf16_f32 v192, v192, v193
  v_cvt_pk_bf16_f32 v193, v194, v195
  v_mfma_f32_16x16x32_bf16 a[88:91], a[180:183], v[148:151], a[88:91]
  v_cvt_pk_bf16_f32 v194, v196, v197
  v_cvt_pk_bf16_f32 v195, v198, v199
  buffer_store_dwordx4 v[192:195], v1, s[20:23], s43 offen sc1
  v_accvgpr_read_b32 v200, a40
  v_accvgpr_read_b32 v201, a41
  v_accvgpr_read_b32 v202, a42
  v_mfma_f32_16x16x32_bf16 a[92:95], a[184:187], v[140:143], a[92:95]
  v_accvgpr_read_b32 v203, a43
  v_mul_f32 v200, v10, v200
  v_mul_f32 v201, v10, v201
  v_mul_f32 v202, v10, v202
  v_mul_f32 v203, v10, v203
  v_accvgpr_read_b32 v204, a44
  v_mfma_f32_16x16x32_bf16 a[92:95], a[188:191], v[148:151], a[92:95]
  v_accvgpr_read_b32 v205, a45
  v_accvgpr_read_b32 v206, a46
  v_accvgpr_read_b32 v207, a47
  v_mul_f32 v204, v10, v204
  v_mul_f32 v205, v10, v205
  v_mul_f32 v206, v10, v206
  v_mfma_f32_16x16x32_bf16 a[64:67], a[192:195], v[140:143], a[64:67]
  v_mul_f32 v207, v10, v207
  v_cvt_pk_bf16_f32 v200, v200, v201
  v_cvt_pk_bf16_f32 v201, v202, v203
  v_cvt_pk_bf16_f32 v202, v204, v205
  v_cvt_pk_bf16_f32 v203, v206, v207
  buffer_store_dwordx4 v[200:203], v1, s[20:23], s43 offen offset:1024 sc1
  v_mfma_f32_16x16x32_bf16 a[64:67], a[196:199], v[148:151], a[64:67]
  v_accvgpr_read_b32 v192, a48
  v_accvgpr_read_b32 v193, a49
  v_accvgpr_read_b32 v194, a50
  v_accvgpr_read_b32 v195, a51
  v_mul_f32 v192, v10, v192
  v_mul_f32 v193, v10, v193
  v_mfma_f32_16x16x32_bf16 a[68:71], a[200:203], v[140:143], a[68:71]
  v_mul_f32 v194, v10, v194
  v_mul_f32 v195, v10, v195
  v_accvgpr_read_b32 v196, a52
  v_accvgpr_read_b32 v197, a53
  v_accvgpr_read_b32 v198, a54
  v_accvgpr_read_b32 v199, a55
  v_mfma_f32_16x16x32_bf16 a[68:71], a[204:207], v[148:151], a[68:71]
  v_mul_f32 v196, v10, v196
  v_mul_f32 v197, v10, v197
  v_mul_f32 v198, v10, v198
  v_mul_f32 v199, v10, v199
  v_cvt_pk_bf16_f32 v192, v192, v193
  v_cvt_pk_bf16_f32 v193, v194, v195
  v_mfma_f32_16x16x32_bf16 a[72:75], a[208:211], v[140:143], a[72:75]
  v_cvt_pk_bf16_f32 v194, v196, v197
  v_cvt_pk_bf16_f32 v195, v198, v199
  buffer_store_dwordx4 v[192:195], v1, s[20:23], s43 offen offset:2048 sc1
  v_accvgpr_read_b32 v200, a56
  v_accvgpr_read_b32 v201, a57
  v_accvgpr_read_b32 v202, a58
  v_mfma_f32_16x16x32_bf16 a[72:75], a[212:215], v[148:151], a[72:75]
  v_accvgpr_read_b32 v203, a59
  v_mul_f32 v200, v10, v200
  v_mul_f32 v201, v10, v201
  v_mul_f32 v202, v10, v202
  v_mul_f32 v203, v10, v203
  v_accvgpr_read_b32 v204, a60
  v_mfma_f32_16x16x32_bf16 a[76:79], a[216:219], v[140:143], a[76:79]
  v_accvgpr_read_b32 v205, a61
  v_accvgpr_read_b32 v206, a62
  v_accvgpr_read_b32 v207, a63
  v_mul_f32 v204, v10, v204
  v_mul_f32 v205, v10, v205
  v_mul_f32 v206, v10, v206
  v_mfma_f32_16x16x32_bf16 a[76:79], a[220:223], v[148:151], a[76:79]
  v_mul_f32 v207, v10, v207
  v_cvt_pk_bf16_f32 v200, v200, v201
  v_cvt_pk_bf16_f32 v201, v202, v203
  v_cvt_pk_bf16_f32 v202, v204, v205
  v_cvt_pk_bf16_f32 v203, v206, v207
  buffer_store_dwordx4 v[200:203], v1, s[20:23], s43 offen offset:3072 sc1
  v_mfma_f32_16x16x32_bf16 a[112:115], a[160:163], v[156:159], a[112:115]
  v_mfma_f32_16x16x32_bf16 a[112:115], a[164:167], v[164:167], a[112:115]
  v_mfma_f32_16x16x32_bf16 a[116:119], a[168:171], v[156:159], a[116:119]
  s_mov_b32 s43, 0x40000
  v_accvgpr_read_b32 v192, a64
  v_accvgpr_read_b32 v193, a65
  v_accvgpr_read_b32 v194, a66
  v_accvgpr_read_b32 v195, a67
  v_mul_f32 v192, v11, v192
  v_mul_f32 v193, v11, v193
  v_mfma_f32_16x16x32_bf16 a[116:119], a[172:175], v[164:167], a[116:119]
  v_mul_f32 v194, v11, v194
  v_mul_f32 v195, v11, v195
  v_accvgpr_read_b32 v196, a68
  v_accvgpr_read_b32 v197, a69
  v_accvgpr_read_b32 v198, a70
  v_accvgpr_read_b32 v199, a71
  v_mfma_f32_16x16x32_bf16 a[120:123], a[176:179], v[156:159], a[120:123]
  v_mul_f32 v196, v11, v196
  v_mul_f32 v197, v11, v197
  v_mul_f32 v198, v11, v198
  v_mul_f32 v199, v11, v199
  v_cvt_pk_bf16_f32 v192, v192, v193
  v_cvt_pk_bf16_f32 v193, v194, v195
  v_mfma_f32_16x16x32_bf16 a[120:123], a[180:183], v[164:167], a[120:123]
  v_cvt_pk_bf16_f32 v194, v196, v197
  v_cvt_pk_bf16_f32 v195, v198, v199
  buffer_store_dwordx4 v[192:195], v1, s[20:23], s43 offen sc1
  v_accvgpr_read_b32 v200, a72
  v_accvgpr_read_b32 v201, a73
  v_accvgpr_read_b32 v202, a74
  v_mfma_f32_16x16x32_bf16 a[124:127], a[184:187], v[156:159], a[124:127]
  v_accvgpr_read_b32 v203, a75
  v_mul_f32 v200, v11, v200
  v_mul_f32 v201, v11, v201
  v_mul_f32 v202, v11, v202
  v_mul_f32 v203, v11, v203
  v_accvgpr_read_b32 v204, a76
  v_mfma_f32_16x16x32_bf16 a[124:127], a[188:191], v[164:167], a[124:127]
  v_accvgpr_read_b32 v205, a77
  v_accvgpr_read_b32 v206, a78
  v_accvgpr_read_b32 v207, a79
  v_mul_f32 v204, v11, v204
  v_mul_f32 v205, v11, v205
  v_mul_f32 v206, v11, v206
  v_mfma_f32_16x16x32_bf16 a[96:99], a[192:195], v[156:159], a[96:99]
  v_mul_f32 v207, v11, v207
  v_cvt_pk_bf16_f32 v200, v200, v201
  v_cvt_pk_bf16_f32 v201, v202, v203
  v_cvt_pk_bf16_f32 v202, v204, v205
  v_cvt_pk_bf16_f32 v203, v206, v207
  buffer_store_dwordx4 v[200:203], v1, s[20:23], s43 offen offset:1024 sc1
  v_mfma_f32_16x16x32_bf16 a[96:99], a[196:199], v[164:167], a[96:99]
  v_accvgpr_read_b32 v192, a80
  v_accvgpr_read_b32 v193, a81
  v_accvgpr_read_b32 v194, a82
  v_accvgpr_read_b32 v195, a83
  v_mul_f32 v192, v11, v192
  v_mul_f32 v193, v11, v193
  v_mfma_f32_16x16x32_bf16 a[100:103], a[200:203], v[156:159], a[100:103]
  v_mul_f32 v194, v11, v194
  v_mul_f32 v195, v11, v195
  v_accvgpr_read_b32 v196, a84
  v_accvgpr_read_b32 v197, a85
  v_accvgpr_read_b32 v198, a86
  v_accvgpr_read_b32 v199, a87
  v_mfma_f32_16x16x32_bf16 a[100:103], a[204:207], v[164:167], a[100:103]
  v_mul_f32 v196, v11, v196
  v_mul_f32 v197, v11, v197
  v_mul_f32 v198, v11, v198
  v_mul_f32 v199, v11, v199
  v_cvt_pk_bf16_f32 v192, v192, v193
  v_cvt_pk_bf16_f32 v193, v194, v195
  v_mfma_f32_16x16x32_bf16 a[104:107], a[208:211], v[156:159], a[104:107]
  v_cvt_pk_bf16_f32 v194, v196, v197
  v_cvt_pk_bf16_f32 v195, v198, v199
  buffer_store_dwordx4 v[192:195], v1, s[20:23], s43 offen offset:2048 sc1
  v_accvgpr_read_b32 v200, a88
  v_accvgpr_read_b32 v201, a89
  v_accvgpr_read_b32 v202, a90
  v_mfma_f32_16x16x32_bf16 a[104:107], a[212:215], v[164:167], a[104:107]
  v_accvgpr_read_b32 v203, a91
  v_mul_f32 v200, v11, v200
  v_mul_f32 v201, v11, v201
  v_mul_f32 v202, v11, v202
  v_mul_f32 v203, v11, v203
  v_accvgpr_read_b32 v204, a92
  v_mfma_f32_16x16x32_bf16 a[108:111], a[216:219], v[156:159], a[108:111]
  v_accvgpr_read_b32 v205, a93
  v_accvgpr_read_b32 v206, a94
  v_accvgpr_read_b32 v207, a95
  v_mul_f32 v204, v11, v204
  v_mul_f32 v205, v11, v205
  v_mul_f32 v206, v11, v206
  v_mfma_f32_16x16x32_bf16 a[108:111], a[220:223], v[164:167], a[108:111]
  v_mul_f32 v207, v11, v207
  v_cvt_pk_bf16_f32 v200, v200, v201
  v_cvt_pk_bf16_f32 v201, v202, v203
  v_cvt_pk_bf16_f32 v202, v204, v205
  v_cvt_pk_bf16_f32 v203, v206, v207
  buffer_store_dwordx4 v[200:203], v1, s[20:23], s43 offen offset:3072 sc1
  s_waitcnt lgkmcnt(0)
  v_max3_u32 v244, v240, v241, v242
  v_max_u32 v244, v244, v243
  v_cmp_lt_u32 vcc, 0x28000000, v244
  v_add_f32 v13, v253, v13
  s_cmp_lg_u64 vcc, 0
  s_cbranch_scc1 L_fail
  s_mov_b32 s43, 0x60000
  v_accvgpr_read_b32 v192, a96
  v_accvgpr_read_b32 v193, a97
  v_accvgpr_read_b32 v194, a98
  v_accvgpr_read_b32 v195, a99
  v_pk_mul_f32 v[192:193], v[192:193], v[12:13] op_sel:[0,0] op_sel_hi:[1,0]
  v_pk_mul_f32 v[194:195], v[194:195], v[12:13] op_sel:[0,0] op_sel_hi:[1,0]
  v_accvgpr_read_b32 v196, a100
  v_accvgpr_read_b32 v197, a101
  v_accvgpr_read_b32 v198, a102
  v_accvgpr_read_b32 v199, a103
  v_pk_mul_f32 v[196:197], v[196:197], v[12:13] op_sel:[0,0] op_sel_hi:[1,0]
  v_pk_mul_f32 v[198:199], v[198:199], v[12:13] op_sel:[0,0] op_sel_hi:[1,0]
  v_cvt_pk_bf16_f32 v192, v192, v193
  v_cvt_pk_bf16_f32 v193, v194, v195
  v_cvt_pk_bf16_f32 v194, v196, v197
  v_cvt_pk_bf16_f32 v195, v198, v199
  buffer_store_dwordx4 v[192:195], v1, s[20:23], s43 offen sc1
  v_accvgpr_read_b32 v200, a104
  v_accvgpr_read_b32 v201, a105
  v_accvgpr_read_b32 v202, a106
  v_accvgpr_read_b32 v203, a107
  v_pk_mul_f32 v[200:201], v[200:201], v[12:13] op_sel:[0,0] op_sel_hi:[1,0]
  v_pk_mul_f32 v[202:203], v[202:203], v[12:13] op_sel:[0,0] op_sel_hi:[1,0]
  v_accvgpr_read_b32 v204, a108
  v_accvgpr_read_b32 v205, a109
  v_accvgpr_read_b32 v206, a110
  v_accvgpr_read_b32 v207, a111
  v_pk_mul_f32 v[204:205], v[204:205], v[12:13] op_sel:[0,0] op_sel_hi:[1,0]
  v_pk_mul_f32 v[206:207], v[206:207], v[12:13] op_sel:[0,0] op_sel_hi:[1,0]
  v_cvt_pk_bf16_f32 v200, v200, v201
  v_cvt_pk_bf16_f32 v201, v202, v203
  v_cvt_pk_bf16_f32 v202, v204, v205
  v_cvt_pk_bf16_f32 v203, v206, v207
  buffer_store_dwordx4 v[200:203], v1, s[20:23], s43 offen offset:1024 sc1
  v_accvgpr_read_b32 v192, a112
  v_accvgpr_read_b32 v193, a113
  v_accvgpr_read_b32 v194, a114
  v_accvgpr_read_b32 v195, a115
  v_pk_mul_f32 v[192:193], v[192:193], v[12:13] op_sel:[0,0] op_sel_hi:[1,0]
  v_pk_mul_f32 v[194:195], v[194:195], v[12:13] op_sel:[0,0] op_sel_hi:[1,0]
  v_accvgpr_read_b32 v196, a116
  v_accvgpr_read_b32 v197, a117
  v_accvgpr_read_b32 v198, a118
  v_accvgpr_read_b32 v199, a119
  v_pk_mul_f32 v[196:197], v[196:197], v[12:13] op_sel:[0,0] op_sel_hi:[1,0]
  v_pk_mul_f32 v[198:199], v[198:199], v[12:13] op_sel:[0,0] op_sel_hi:[1,0]
  v_cvt_pk_bf16_f32 v192, v192, v193
  v_cvt_pk_bf16_f32 v193, v194, v195
  v_cvt_pk_bf16_f32 v194, v196, v197
  v_cvt_pk_bf16_f32 v195, v198, v199
  buffer_store_dwordx4 v[192:195], v1, s[20:23], s43 offen offset:2048 sc1
  v_accvgpr_read_b32 v200, a120
  v_accvgpr_read_b32 v201, a121
  v_accvgpr_read_b32 v202, a122
  v_accvgpr_read_b32 v203, a123
  v_pk_mul_f32 v[200:201], v[200:201], v[12:13] op_sel:[0,0] op_sel_hi:[1,0]
  v_pk_mul_f32 v[202:203], v[202:203], v[12:13] op_sel:[0,0] op_sel_hi:[1,0]
  v_accvgpr_read_b32 v204, a124
  v_accvgpr_read_b32 v205, a125
  v_accvgpr_read_b32 v206, a126
  v_accvgpr_read_b32 v207, a127
  v_pk_mul_f32 v[204:205], v[204:205], v[12:13] op_sel:[0,0] op_sel_hi:[1,0]
  v_pk_mul_f32 v[206:207], v[206:207], v[12:13] op_sel:[0,0] op_sel_hi:[1,0]
  v_cvt_pk_bf16_f32 v200, v200, v201
  v_cvt_pk_bf16_f32 v201, v202, v203
  v_cvt_pk_bf16_f32 v202, v204, v205
  v_cvt_pk_bf16_f32 v203, v206, v207
  buffer_store_dwordx4 v[200:203], v1, s[20:23], s43 offen offset:3072 sc1
  v_mov_b32 v249, v13
  s_nop 1
  v_permlane32_swap_b32 v13, v249
  v_add_f32 v13, v13, v249
  v_mov_b32 v249, v13
  s_nop 1
  v_permlane16_swap_b32 v13, v249
  v_add_f32 v13, v13, v249
  v_rcp_f32 v13, v13
  s_mov_b32 s43, 0
  v_accvgpr_read_b32 v192, a128
  v_accvgpr_read_b32 v193, a129
  v_accvgpr_read_b32 v194, a130
  v_accvgpr_read_b32 v195, a131
  v_pk_add_f32 v[192:193], v[192:193], v[176:177]
  v_pk_add_f32 v[194:195], v[194:195], v[178:179]
  v_pk_mul_f32 v[192:193], v[192:193], v[12:13] op_sel:[0,1] op_sel_hi:[1,1]
  v_pk_mul_f32 v[194:195], v[194:195], v[12:13] op_sel:[0,1] op_sel_hi:[1,1]
  v_accvgpr_read_b32 v196, a132
  v_accvgpr_read_b32 v197, a133
  v_accvgpr_read_b32 v198, a134
  v_accvgpr_read_b32 v199, a135
  v_pk_add_f32 v[196:197], v[196:197], v[180:181]
  v_pk_add_f32 v[198:199], v[198:199], v[182:183]
  v_pk_mul_f32 v[196:197], v[196:197], v[12:13] op_sel:[0,1] op_sel_hi:[1,1]
  v_pk_mul_f32 v[198:199], v[198:199], v[12:13] op_sel:[0,1] op_sel_hi:[1,1]
  v_cvt_pk_bf16_f32 v192, v192, v193
  v_cvt_pk_bf16_f32 v193, v194, v195
  v_cvt_pk_bf16_f32 v194, v196, v197
  v_cvt_pk_bf16_f32 v195, v198, v199
  buffer_store_dwordx4 v[192:195], v2, s[20:23], s43 offen sc1
  v_accvgpr_read_b32 v200, a136
  v_accvgpr_read_b32 v201, a137
  v_accvgpr_read_b32 v202, a138
  v_accvgpr_read_b32 v203, a139
  v_pk_add_f32 v[200:201], v[200:201], v[184:185]
  v_pk_add_f32 v[202:203], v[202:203], v[186:187]
  v_pk_mul_f32 v[200:201], v[200:201], v[12:13] op_sel:[0,1] op_sel_hi:[1,1]
  v_pk_mul_f32 v[202:203], v[202:203], v[12:13] op_sel:[0,1] op_sel_hi:[1,1]
  v_accvgpr_read_b32 v204, a140
  v_accvgpr_read_b32 v205, a141
  v_accvgpr_read_b32 v206, a142
  v_accvgpr_read_b32 v207, a143
  v_pk_add_f32 v[204:205], v[204:205], v[188:189]
  v_pk_add_f32 v[206:207], v[206:207], v[190:191]
  v_pk_mul_f32 v[204:205], v[204:205], v[12:13] op_sel:[0,1] op_sel_hi:[1,1]
  v_pk_mul_f32 v[206:207], v[206:207], v[12:13] op_sel:[0,1] op_sel_hi:[1,1]
  v_cvt_pk_bf16_f32 v200, v200, v201
  v_cvt_pk_bf16_f32 v201, v202, v203
  v_cvt_pk_bf16_f32 v202, v204, v205
  v_cvt_pk_bf16_f32 v203, v206, v207
  buffer_store_dwordx4 v[200:203], v2, s[20:23], s43 offen offset:1024 sc1
L_join:
  v_lshrrev_b32 v249, 2, v14
  v_lshlrev_b32 v249, 7, v249
  v_bfe_u32 v250, v14, 3, 2
  v_lshl_add_u32 v249, v250, 5, v249
  v_and_b32 v250, 3, v14
  v_lshl_add_u32 v249, v250, 3, v249
  v_add_u32 v3, s75, v249
  v_xor_b32 v4, 32, v3
  v_xor_b32 v5, 64, v3
  v_xor_b32 v6, 0x60, v3
  s_waitcnt vmcnt(18)
  ds_read_b64_tr_b16 a[224:225], v3
  ds_read_b64_tr_b16 a[226:227], v3 offset:2048
  ds_read_b64_tr_b16 a[228:229], v4
  ds_read_b64_tr_b16 a[230:231], v4 offset:2048
  ds_read_b64_tr_b16 a[232:233], v5
  ds_read_b64_tr_b16 a[234:235], v5 offset:2048
  ds_read_b64_tr_b16 a[236:237], v6
  ds_read_b64_tr_b16 a[238:239], v6 offset:2048
  ds_read_b64_tr_b16 v[16:17], v3 offset:16384
  ds_read_b64_tr_b16 v[18:19], v3 offset:18432
  ds_read_b64_tr_b16 v[24:25], v4 offset:16384
  ds_read_b64_tr_b16 v[26:27], v4 offset:18432
  ds_read_b64_tr_b16 v[32:33], v5 offset:16384
  ds_read_b64_tr_b16 v[34:35], v5 offset:18432
  ds_read_b64_tr_b16 v[40:41], v6 offset:16384
  ds_read_b64_tr_b16 v[42:43], v6 offset:18432
  ds_read_b64_tr_b16 v[48:49], v3 offset:32768
  ds_read_b64_tr_b16 v[50:51], v3 offset:34816
  ds_read_b64_tr_b16 v[56:57], v4 offset:32768
  ds_read_b64_tr_b16 v[58:59], v4 offset:34816
  ds_read_b64_tr_b16 v[64:65], v5 offset:32768
  ds_read_b64_tr_b16 v[66:67], v5 offset:34816
  ds_read_b64_tr_b16 v[72:73], v6 offset:32768
  ds_read_b64_tr_b16 v[74:75], v6 offset:34816
  ds_read_b64_tr_b16 v[80:81], v3 offset:49152
  ds_read_b64_tr_b16 v[82:83], v3 offset:51200
  ds_read_b64_tr_b16 v[88:89], v4 offset:49152
  ds_read_b64_tr_b16 v[90:91], v4 offset:51200
  ds_read_b64_tr_b16 v[96:97], v5 offset:49152
  ds_read_b64_tr_b16 v[98:99], v5 offset:51200
  ds_read_b64_tr_b16 v[104:105], v6 offset:49152
  ds_read_b64_tr_b16 v[106:107], v6 offset:51200
  v_xor_b32 v3, 0x10000, v3
  v_xor_b32 v4, 0x10000, v4
  v_xor_b32 v5, 0x10000, v5
  v_xor_b32 v6, 0x10000, v6
  ds_read_b64_tr_b16 v[112:113], v3
  ds_read_b64_tr_b16 v[114:115], v3 offset:2048
  ds_read_b64_tr_b16 v[120:121], v4
  ds_read_b64_tr_b16 v[122:123], v4 offset:2048
  ds_read_b64_tr_b16 v[128:129], v5
  ds_read_b64_tr_b16 v[130:131], v5 offset:2048
  ds_read_b64_tr_b16 v[136:137], v6
  ds_read_b64_tr_b16 v[138:139], v6 offset:2048
  ds_read_b64_tr_b16 v[144:145], v3 offset:16384
  ds_read_b64_tr_b16 v[146:147], v3 offset:18432
  ds_read_b64_tr_b16 v[152:153], v4 offset:16384
  ds_read_b64_tr_b16 v[154:155], v4 offset:18432
  ds_read_b64_tr_b16 v[160:161], v5 offset:16384
  ds_read_b64_tr_b16 v[162:163], v5 offset:18432
  ds_read_b64_tr_b16 v[168:169], v6 offset:16384
  ds_read_b64_tr_b16 v[170:171], v6 offset:18432
  v_lshlrev_b32 v249, 4, v14
  s_lshl_b32 s42, s3, 14
  v_add_u32 v2, s42, v249
  s_lshl_b32 s43, s66, 1
  s_xor_b32 s44, s68, 1
  s_add_u32 s43, s43, s44
  s_lshl_b32 s43, s43, 2
  s_mul_i32 s42, s67, 0
  s_add_u32 s42, s42, s3
  s_and_b32 s38, s42, 3
  s_add_u32 s42, s38, 0
  s_and_b32 s42, s42, 3
  s_add_u32 s42, s42, s43
  s_lshl_b32 s96, s42, 17
  s_add_u32 s42, s38, 1
  s_and_b32 s42, s42, 3
  s_add_u32 s42, s42, s43
  s_lshl_b32 s97, s42, 17
  s_add_u32 s42, s38, 2
  s_and_b32 s42, s42, 3
  s_add_u32 s42, s42, s43
  s_lshl_b32 s98, s42, 17
  s_add_u32 s42, s38, 3
  s_and_b32 s42, s42, 3
  s_add_u32 s42, s42, s43
  s_lshl_b32 s99, s42, 17
  s_add_u32 s42, s66, 16
  s_lshl_b32 s101, s42, 17
  s_mul_i32 s42, s70, 0x240000
  s_lshl_b32 s43, s68, 16
  s_add_u32 s42, s42, s43
  s_sub_u32 s43, 0x1200000, s42
  s_add_u32 s42, s42, 0
  s_add_u32 s8, s62, s42
  s_addc_u32 s9, s63, 0
  s_mov_b32 s10, s43
  s_mov_b32 s11, 0x20000
  s_lshl_b32 s42, s40, 5
  s_add_u32 s42, s42, s41
  s_lshl_b32 s42, s42, 7
  s_add_u32 s42, s42, 0x1900000
  s_add_u32 s4, s62, s42
  s_addc_u32 s5, s63, 0
  s_mov_b32 s6, 4
  s_mov_b32 s7, 0x20000
  s_mov_b32 s100, 0x30000
  s_add_u32 m0, s75, 0x18000
  s_nop 0
  buffer_load_dwordx4 v7, s[24:27], s100 offen lds
  buffer_load_dwordx4 v8, s[24:27], s100 offen offset:1024 lds
  buffer_load_dwordx4 v254, s[24:27], s100 offen offset:2048 lds
  buffer_load_dwordx4 v255, s[24:27], s100 offen offset:3072 lds
  s_mov_b32 s100, 0x38000
  s_add_u32 m0, s75, 0x1c000
  s_nop 0
  buffer_load_dwordx4 v7, s[24:27], s100 offen lds
  buffer_load_dwordx4 v8, s[24:27], s100 offen offset:1024 lds
  buffer_load_dwordx4 v254, s[24:27], s100 offen offset:2048 lds
  buffer_load_dwordx4 v255, s[24:27], s100 offen offset:3072 lds
  s_waitcnt vmcnt(8) lgkmcnt(0)
  s_barrier
  s_cmp_lg_u32 s3, 0
  s_cbranch_scc1 L_nf1
  buffer_store_dword v248, v0, s[4:7], 0 offen sc1
L_nf1:
  s_mov_b32 s100, 0x40000
  s_add_u32 m0, s75, 0
  s_nop 0
  buffer_load_dwordx4 v7, s[24:27], s100 offen lds
  buffer_load_dwordx4 v8, s[24:27], s100 offen offset:1024 lds
  buffer_load_dwordx4 v254, s[24:27], s100 offen offset:2048 lds
  buffer_load_dwordx4 v255, s[24:27], s100 offen offset:3072 lds
  s_waitcnt vmcnt(8)
  ds_read_b64_tr_b16 v[208:209], v3 offset:32768
  ds_read_b64_tr_b16 v[210:211], v3 offset:34816
  ds_read_b64_tr_b16 v[212:213], v4 offset:32768
  ds_read_b64_tr_b16 v[214:215], v4 offset:34816
  ds_read_b64_tr_b16 v[216:217], v5 offset:32768
  ds_read_b64_tr_b16 v[218:219], v5 offset:34816
  ds_read_b64_tr_b16 v[220:221], v6 offset:32768
  ds_read_b64_tr_b16 v[222:223], v6 offset:34816
  s_mov_b32 s100, 0x48000
  s_add_u32 m0, s75, 0x4000
  s_nop 0
  buffer_load_dwordx4 v7, s[24:27], s100 offen lds
  buffer_load_dwordx4 v8, s[24:27], s100 offen offset:1024 lds
  buffer_load_dwordx4 v254, s[24:27], s100 offen offset:2048 lds
  buffer_load_dwordx4 v255, s[24:27], s100 offen offset:3072 lds
  s_waitcnt vmcnt(8)
  ds_read_b64_tr_b16 v[224:225], v3 offset:49152
  ds_read_b64_tr_b16 v[226:227], v3 offset:51200
  ds_read_b64_tr_b16 v[228:229], v4 offset:49152
  ds_read_b64_tr_b16 v[230:231], v4 offset:51200
  ds_read_b64_tr_b16 v[232:233], v5 offset:49152
  ds_read_b64_tr_b16 v[234:235], v5 offset:51200
  ds_read_b64_tr_b16 v[236:237], v6 offset:49152
  ds_read_b64_tr_b16 v[238:239], v6 offset:51200
  s_mov_b32 s100, 0x50000
  s_add_u32 m0, s75, 0x8000
  s_nop 0
  buffer_load_dwordx4 v7, s[24:27], s100 offen lds
  buffer_load_dwordx4 v8, s[24:27], s100 offen offset:1024 lds
  buffer_load_dwordx4 v254, s[24:27], s100 offen offset:2048 lds
  buffer_load_dwordx4 v255, s[24:27], s100 offen offset:3072 lds
  s_waitcnt vmcnt(8)
  v_xor_b32 v3, 0x10000, v3
  v_xor_b32 v4, 0x10000, v4
  v_xor_b32 v5, 0x10000, v5
  v_xor_b32 v6, 0x10000, v6
  ds_read_b64_tr_b16 v[20:21], v3
  ds_read_b64_tr_b16 v[22:23], v3 offset:2048
  ds_read_b64_tr_b16 v[28:29], v4
  ds_read_b64_tr_b16 v[30:31], v4 offset:2048
  ds_read_b64_tr_b16 v[36:37], v5
  ds_read_b64_tr_b16 v[38:39], v5 offset:2048
  ds_read_b64_tr_b16 v[44:45], v6
  ds_read_b64_tr_b16 v[46:47], v6 offset:2048
  s_mov_b32 s100, 0x58000
  s_add_u32 m0, s75, 0xc000
  s_nop 0
  buffer_load_dwordx4 v7, s[24:27], s100 offen lds
  buffer_load_dwordx4 v8, s[24:27], s100 offen offset:1024 lds
  buffer_load_dwordx4 v254, s[24:27], s100 offen offset:2048 lds
  buffer_load_dwordx4 v255, s[24:27], s100 offen offset:3072 lds
  s_waitcnt vmcnt(8)
  ds_read_b64_tr_b16 v[52:53], v3 offset:16384
  ds_read_b64_tr_b16 v[54:55], v3 offset:18432
  ds_read_b64_tr_b16 v[60:61], v4 offset:16384
  ds_read_b64_tr_b16 v[62:63], v4 offset:18432
  ds_read_b64_tr_b16 v[68:69], v5 offset:16384
  ds_read_b64_tr_b16 v[70:71], v5 offset:18432
  ds_read_b64_tr_b16 v[76:77], v6 offset:16384
  ds_read_b64_tr_b16 v[78:79], v6 offset:18432
  s_mov_b32 s100, 0x60000
  s_add_u32 m0, s75, 0x10000
  s_nop 0
  buffer_load_dwordx4 v7, s[24:27], s100 offen lds
  buffer_load_dwordx4 v8, s[24:27], s100 offen offset:1024 lds
  buffer_load_dwordx4 v254, s[24:27], s100 offen offset:2048 lds
  buffer_load_dwordx4 v255, s[24:27], s100 offen offset:3072 lds
  s_lshl_b32 s42, s70, 1
  s_add_u32 s42, s42, s68
  s_lshl_b32 s42, s42, 2
  s_add_u32 s42, s42, s3
  s_lshl_b32 s42, s42, 2
  s_lshl_b32 s42, s42, 7
  s_add_u32 s42, s42, 0x1900000
  s_add_u32 s4, s62, s42
  s_addc_u32 s5, s63, 0
  s_mov_b32 s6, 0x200
  s_mov_b32 s7, 0x20000
  buffer_load_dword v15, v0, s[4:7], 0 offen sc1
  s_waitcnt vmcnt(9)
  ds_read_b64_tr_b16 v[84:85], v3 offset:32768
  ds_read_b64_tr_b16 v[86:87], v3 offset:34816
  ds_read_b64_tr_b16 v[92:93], v4 offset:32768
  ds_read_b64_tr_b16 v[94:95], v4 offset:34816
  ds_read_b64_tr_b16 v[100:101], v5 offset:32768
  ds_read_b64_tr_b16 v[102:103], v5 offset:34816
  ds_read_b64_tr_b16 a[0:1], v6 offset:32768
  ds_read_b64_tr_b16 a[2:3], v6 offset:34816
  s_mov_b32 s100, 0x68000
  s_add_u32 m0, s75, 0x14000
  s_nop 0
  buffer_load_dwordx4 v7, s[24:27], s100 offen lds
  buffer_load_dwordx4 v8, s[24:27], s100 offen offset:1024 lds
  buffer_load_dwordx4 v254, s[24:27], s100 offen offset:2048 lds
  buffer_load_dwordx4 v255, s[24:27], s100 offen offset:3072 lds
  s_waitcnt vmcnt(9)
  ds_read_b64_tr_b16 a[4:5], v3 offset:49152
  ds_read_b64_tr_b16 a[6:7], v3 offset:51200
  ds_read_b64_tr_b16 a[8:9], v4 offset:49152
  ds_read_b64_tr_b16 a[10:11], v4 offset:51200
  ds_read_b64_tr_b16 a[12:13], v5 offset:49152
  ds_read_b64_tr_b16 a[14:15], v5 offset:51200
  ds_read_b64_tr_b16 a[16:17], v6 offset:49152
  ds_read_b64_tr_b16 a[18:19], v6 offset:51200
  s_waitcnt lgkmcnt(15)
  s_mov_b32 s100, 0x70000
  s_add_u32 m0, s75, 0x18000
  s_nop 0
  buffer_load_dwordx4 v7, s[24:27], s100 offen lds
  buffer_load_dwordx4 v8, s[24:27], s100 offen offset:1024 lds
  buffer_load_dwordx4 v254, s[24:27], s100 offen offset:2048 lds
  buffer_load_dwordx4 v255, s[24:27], s100 offen offset:3072 lds
  s_waitcnt vmcnt(9)
  v_xor_b32 v3, 0x10000, v3
  v_xor_b32 v4, 0x10000, v4
  v_xor_b32 v5, 0x10000, v5
  v_xor_b32 v6, 0x10000, v6
  ds_read_b64_tr_b16 a[20:21], v3
  ds_read_b64_tr_b16 a[22:23], v3 offset:2048
  ds_read_b64_tr_b16 a[24:25], v4
  ds_read_b64_tr_b16 a[26:27], v4 offset:2048
  ds_read_b64_tr_b16 a[28:29], v5
  ds_read_b64_tr_b16 a[30:31], v5 offset:2048
  ds_read_b64_tr_b16 a[32:33], v6
  ds_read_b64_tr_b16 a[34:35], v6 offset:2048
  s_waitcnt lgkmcnt(15)
  s_mov_b32 s100, 0x78000
  s_add_u32 m0, s75, 0x1c000
  s_nop 0
  buffer_load_dwordx4 v7, s[24:27], s100 offen lds
  buffer_load_dwordx4 v8, s[24:27], s100 offen offset:1024 lds
  buffer_load_dwordx4 v254, s[24:27], s100 offen offset:2048 lds
  buffer_load_dwordx4 v255, s[24:27], s100 offen offset:3072 lds
  s_waitcnt vmcnt(8)
  ds_read_b64_tr_b16 a[36:37], v3 offset:16384
  ds_read_b64_tr_b16 a[38:39], v3 offset:18432
  ds_read_b64_tr_b16 a[40:41], v4 offset:16384
  ds_read_b64_tr_b16 a[42:43], v4 offset:18432
  ds_read_b64_tr_b16 a[44:45], v5 offset:16384
  ds_read_b64_tr_b16 a[46:47], v5 offset:18432
  ds_read_b64_tr_b16 a[48:49], v6 offset:16384
  ds_read_b64_tr_b16 a[50:51], v6 offset:18432
  s_waitcnt vmcnt(4)
  ds_read_b64_tr_b16 a[52:53], v3 offset:32768
  ds_read_b64_tr_b16 a[54:55], v3 offset:34816
  ds_read_b64_tr_b16 a[56:57], v4 offset:32768
  ds_read_b64_tr_b16 a[58:59], v4 offset:34816
  ds_read_b64_tr_b16 a[60:61], v5 offset:32768
  ds_read_b64_tr_b16 a[62:63], v5 offset:34816
  ds_read_b64_tr_b16 a[64:65], v6 offset:32768
  ds_read_b64_tr_b16 a[66:67], v6 offset:34816
  s_waitcnt vmcnt(0)
  ds_read_b64_tr_b16 a[68:69], v3 offset:49152
  ds_read_b64_tr_b16 a[70:71], v3 offset:51200
  ds_read_b64_tr_b16 a[72:73], v4 offset:49152
  ds_read_b64_tr_b16 a[74:75], v4 offset:51200
  ds_read_b64_tr_b16 a[76:77], v5 offset:49152
  ds_read_b64_tr_b16 a[78:79], v5 offset:51200
  ds_read_b64_tr_b16 a[80:81], v6 offset:49152
  ds_read_b64_tr_b16 a[82:83], v6 offset:51200
  s_waitcnt vmcnt(63)
  v_cmp_ne_u32 vcc, 0, v15
  s_nop 0
  s_cmp_eq_u32 vcc_lo, 15
  s_cbranch_scc1 L_ot_ok
L_ot_spin:
  s_sleep 2
  buffer_load_dword v15, v0, s[4:7], 0 offen sc1
  s_waitcnt vmcnt(0)
  v_cmp_ne_u32 vcc, 0, v15
  s_nop 0
  s_cmp_eq_u32 vcc_lo, 15
  s_cbranch_scc0 L_ot_spin
L_ot_ok:
  s_add_u32 s46, s96, 0
  buffer_load_dwordx4 a[148:151], v2, s[8:11], s46 offen sc1
  buffer_load_dwordx4 a[152:155], v2, s[8:11], s46 offen offset:1024 sc1
  s_add_u32 s47, s97, 0
  buffer_load_dwordx4 a[156:159], v2, s[8:11], s47 offen sc1
  buffer_load_dwordx4 a[160:163], v2, s[8:11], s47 offen offset:1024 sc1
  s_add_u32 s46, s98, 0
  buffer_load_dwordx4 a[164:167], v2, s[8:11], s46 offen sc1
  buffer_load_dwordx4 a[168:171], v2, s[8:11], s46 offen offset:1024 sc1
  s_add_u32 s47, s99, 0
  buffer_load_dwordx4 a[172:175], v2, s[8:11], s47 offen sc1
  buffer_load_dwordx4 a[176:179], v2, s[8:11], s47 offen offset:1024 sc1
  s_add_u32 s46, s101, 0
  buffer_load_dwordx4 a[180:183], v2, s[8:11], s46 offen sc1
  buffer_load_dwordx4 a[184:187], v2, s[8:11], s46 offen offset:1024 sc1
  s_add_u32 s47, s96, 0x800
  buffer_load_dwordx4 a[188:191], v2, s[8:11], s47 offen sc1
  buffer_load_dwordx4 a[192:195], v2, s[8:11], s47 offen offset:1024 sc1
  s_add_u32 s46, s97, 0x800
  buffer_load_dwordx4 a[196:199], v2, s[8:11], s46 offen sc1
  buffer_load_dwordx4 a[200:203], v2, s[8:11], s46 offen offset:1024 sc1
  s_add_u32 s47, s98, 0x800
  buffer_load_dwordx4 a[204:207], v2, s[8:11], s47 offen sc1
  buffer_load_dwordx4 a[208:211], v2, s[8:11], s47 offen offset:1024 sc1
  s_add_u32 s46, s99, 0x800
  buffer_load_dwordx4 a[212:215], v2, s[8:11], s46 offen sc1
  buffer_load_dwordx4 a[216:219], v2, s[8:11], s46 offen offset:1024 sc1
  s_add_u32 s47, s101, 0x800
  buffer_load_dwordx4 a[220:223], v2, s[8:11], s47 offen sc1
  buffer_load_dwordx4 a[240:243], v2, s[8:11], s47 offen offset:1024 sc1
  s_add_u32 s46, s96, 0x1000
  buffer_load_dwordx4 a[244:247], v2, s[8:11], s46 offen sc1
  buffer_load_dwordx4 a[248:251], v2, s[8:11], s46 offen offset:1024 sc1
  s_waitcnt lgkmcnt(0)
  s_barrier
  s_waitcnt vmcnt(20)
  v_mfma_f32_16x16x32_bf16 v[108:111], a[224:227], a[148:151], 0
  s_add_u32 s47, s97, 0x1000
  v_mfma_f32_16x16x32_bf16 v[108:111], v[16:19], a[152:155], v[108:111]
  buffer_load_dwordx4 a[252:255], v2, s[8:11], s47 offen sc1
  v_mfma_f32_16x16x32_bf16 v[116:119], a[228:231], a[148:151], 0
  v_mfma_f32_16x16x32_bf16 v[116:119], v[24:27], a[152:155], v[116:119]
  v_mfma_f32_16x16x32_bf16 v[124:127], a[232:235], a[148:151], 0
  v_mfma_f32_16x16x32_bf16 v[124:127], v[32:35], a[152:155], v[124:127]
  buffer_load_dwordx4 v[244:247], v2, s[8:11], s47 offen offset:1024 sc1
  v_mfma_f32_16x16x32_bf16 v[132:135], a[236:239], a[148:151], 0
  v_mfma_f32_16x16x32_bf16 v[132:135], v[40:43], a[152:155], v[132:135]
  s_waitcnt vmcnt(20)
  v_mfma_f32_16x16x32_bf16 a[84:87], a[224:227], a[156:159], 0
  s_add_u32 s46, s98, 0x1000
  v_mfma_f32_16x16x32_bf16 a[84:87], v[16:19], a[160:163], a[84:87]
  buffer_load_dwordx4 a[148:151], v2, s[8:11], s46 offen sc1
  v_mfma_f32_16x16x32_bf16 a[88:91], a[228:231], a[156:159], 0
  v_mfma_f32_16x16x32_bf16 a[88:91], v[24:27], a[160:163], a[88:91]
  v_mfma_f32_16x16x32_bf16 a[92:95], a[232:235], a[156:159], 0
  v_mfma_f32_16x16x32_bf16 a[92:95], v[32:35], a[160:163], a[92:95]
  buffer_load_dwordx4 a[152:155], v2, s[8:11], s46 offen offset:1024 sc1
  v_mfma_f32_16x16x32_bf16 a[96:99], a[236:239], a[156:159], 0
  v_mfma_f32_16x16x32_bf16 a[96:99], v[40:43], a[160:163], a[96:99]
  s_waitcnt vmcnt(20)
  v_mfma_f32_16x16x32_bf16 a[100:103], a[224:227], a[164:167], 0
  s_add_u32 s47, s99, 0x1000
  v_mfma_f32_16x16x32_bf16 a[100:103], v[16:19], a[168:171], a[100:103]
  buffer_load_dwordx4 a[156:159], v2, s[8:11], s47 offen sc1
  v_mfma_f32_16x16x32_bf16 a[104:107], a[228:231], a[164:167], 0
  v_mfma_f32_16x16x32_bf16 a[104:107], v[24:27], a[168:171], a[104:107]
  v_mfma_f32_16x16x32_bf16 a[108:111], a[232:235], a[164:167], 0
  v_mfma_f32_16x16x32_bf16 a[108:111], v[32:35], a[168:171], a[108:111]
  buffer_load_dwordx4 a[160:163], v2, s[8:11], s47 offen offset:1024 sc1
  v_mfma_f32_16x16x32_bf16 a[112:115], a[236:239], a[164:167], 0
  v_mfma_f32_16x16x32_bf16 a[112:115], v[40:43], a[168:171], a[112:115]
  s_waitcnt vmcnt(20)
  v_mfma_f32_16x16x32_bf16 a[116:119], a[224:227], a[172:175], 0
  s_add_u32 s46, s101, 0x1000
  v_mfma_f32_16x16x32_bf16 a[116:119], v[16:19], a[176:179], a[116:119]
  buffer_load_dwordx4 a[164:167], v2, s[8:11], s46 offen sc1
  v_mfma_f32_16x16x32_bf16 a[120:123], a[228:231], a[172:175], 0
  v_mfma_f32_16x16x32_bf16 a[120:123], v[24:27], a[176:179], a[120:123]
  v_mfma_f32_16x16x32_bf16 a[124:127], a[232:235], a[172:175], 0
  v_mfma_f32_16x16x32_bf16 a[124:127], v[32:35], a[176:179], a[124:127]
  buffer_load_dwordx4 a[168:171], v2, s[8:11], s46 offen offset:1024 sc1
  v_mfma_f32_16x16x32_bf16 a[128:131], a[236:239], a[172:175], 0
  v_mfma_f32_16x16x32_bf16 a[128:131], v[40:43], a[176:179], a[128:131]
  s_waitcnt vmcnt(20)
  v_mfma_f32_16x16x32_bf16 a[132:135], a[224:227], a[180:183], 0
  s_add_u32 s47, s96, 0x1800
  v_mfma_f32_16x16x32_bf16 a[132:135], v[16:19], a[184:187], a[132:135]
  buffer_load_dwordx4 a[172:175], v2, s[8:11], s47 offen sc1
  v_mfma_f32_16x16x32_bf16 a[136:139], a[228:231], a[180:183], 0
  v_mfma_f32_16x16x32_bf16 a[136:139], v[24:27], a[184:187], a[136:139]
  v_mfma_f32_16x16x32_bf16 a[140:143], a[232:235], a[180:183], 0
  v_mfma_f32_16x16x32_bf16 a[140:143], v[32:35], a[184:187], a[140:143]
  buffer_load_dwordx4 a[176:179], v2, s[8:11], s47 offen offset:1024 sc1
  v_mfma_f32_16x16x32_bf16 a[144:147], a[236:239], a[180:183], 0
  v_mfma_f32_16x16x32_bf16 a[144:147], v[40:43], a[184:187], a[144:147]
  s_waitcnt vmcnt(20)
  v_mfma_f32_16x16x32_bf16 v[108:111], v[48:51], a[188:191], v[108:111]
  s_add_u32 s46, s97, 0x1800
  v_mfma_f32_16x16x32_bf16 v[108:111], v[80:83], a[192:195], v[108:111]
  buffer_load_dwordx4 a[180:183], v2, s[8:11], s46 offen sc1
  v_mfma_f32_16x16x32_bf16 v[116:119], v[56:59], a[188:191], v[116:119]
  v_mfma_f32_16x16x32_bf16 v[116:119], v[88:91], a[192:195], v[116:119]
  v_mfma_f32_16x16x32_bf16 v[124:127], v[64:67], a[188:191], v[124:127]
  v_mfma_f32_16x16x32_bf16 v[124:127], v[96:99], a[192:195], v[124:127]
  buffer_load_dwordx4 a[184:187], v2, s[8:11], s46 offen offset:1024 sc1
  v_mfma_f32_16x16x32_bf16 v[132:135], v[72:75], a[188:191], v[132:135]
  v_mfma_f32_16x16x32_bf16 v[132:135], v[104:107], a[192:195], v[132:135]
  s_waitcnt vmcnt(20)
  v_mfma_f32_16x16x32_bf16 a[84:87], v[48:51], a[196:199], a[84:87]
  s_add_u32 s47, s98, 0x1800
  v_mfma_f32_16x16x32_bf16 a[84:87], v[80:83], a[200:203], a[84:87]
  buffer_load_dwordx4 a[188:191], v2, s[8:11], s47 offen sc1
  v_mfma_f32_16x16x32_bf16 a[88:91], v[56:59], a[196:199], a[88:91]
  v_mfma_f32_16x16x32_bf16 a[88:91], v[88:91], a[200:203], a[88:91]
  v_mfma_f32_16x16x32_bf16 a[92:95], v[64:67], a[196:199], a[92:95]
  v_mfma_f32_16x16x32_bf16 a[92:95], v[96:99], a[200:203], a[92:95]
  buffer_load_dwordx4 a[192:195], v2, s[8:11], s47 offen offset:1024 sc1
  v_mfma_f32_16x16x32_bf16 a[96:99], v[72:75], a[196:199], a[96:99]
  v_mfma_f32_16x16x32_bf16 a[96:99], v[104:107], a[200:203], a[96:99]
  s_waitcnt vmcnt(20)
  v_mfma_f32_16x16x32_bf16 a[100:103], v[48:51], a[204:207], a[100:103]
  s_add_u32 s46, s99, 0x1800
  v_mfma_f32_16x16x32_bf16 a[100:103], v[80:83], a[208:211], a[100:103]
  buffer_load_dwordx4 a[196:199], v2, s[8:11], s46 offen sc1
  v_mfma_f32_16x16x32_bf16 a[104:107], v[56:59], a[204:207], a[104:107]
  v_mfma_f32_16x16x32_bf16 a[104:107], v[88:91], a[208:211], a[104:107]
  v_mfma_f32_16x16x32_bf16 a[108:111], v[64:67], a[204:207], a[108:111]
  v_mfma_f32_16x16x32_bf16 a[108:111], v[96:99], a[208:211], a[108:111]
  buffer_load_dwordx4 a[200:203], v2, s[8:11], s46 offen offset:1024 sc1
  v_mfma_f32_16x16x32_bf16 a[112:115], v[72:75], a[204:207], a[112:115]
  v_mfma_f32_16x16x32_bf16 a[112:115], v[104:107], a[208:211], a[112:115]
  s_waitcnt vmcnt(20)
  v_mfma_f32_16x16x32_bf16 a[116:119], v[48:51], a[212:215], a[116:119]
  s_add_u32 s47, s101, 0x1800
  v_mfma_f32_16x16x32_bf16 a[116:119], v[80:83], a[216:219], a[116:119]
  buffer_load_dwordx4 a[204:207], v2, s[8:11], s47 offen sc1
  v_mfma_f32_16x16x32_bf16 a[120:123], v[56:59], a[212:215], a[120:123]
  v_mfma_f32_16x16x32_bf16 a[120:123], v[88:91], a[216:219], a[120:123]
  v_mfma_f32_16x16x32_bf16 a[124:127], v[64:67], a[212:215], a[124:127]
  v_mfma_f32_16x16x32_bf16 a[124:127], v[96:99], a[216:219], a[124:127]
  buffer_load_dwordx4 a[208:211], v2, s[8:11], s47 offen offset:1024 sc1
  v_mfma_f32_16x16x32_bf16 a[128:131], v[72:75], a[212:215], a[128:131]
  v_mfma_f32_16x16x32_bf16 a[128:131], v[104:107], a[216:219], a[128:131]
  s_waitcnt vmcnt(20)
  v_mfma_f32_16x16x32_bf16 a[132:135], v[48:51], a[220:223], a[132:135]
  s_add_u32 s46, s96, 0x2000
  v_mfma_f32_16x16x32_bf16 a[132:135], v[80:83], a[240:243], a[132:135]
  buffer_load_dwordx4 a[212:215], v2, s[8:11], s46 offen sc1
  v_mfma_f32_16x16x32_bf16 a[136:139], v[56:59], a[220:223], a[136:139]
  v_mfma_f32_16x16x32_bf16 a[136:139], v[88:91], a[240:243], a[136:139]
  v_mfma_f32_16x16x32_bf16 a[140:143], v[64:67], a[220:223], a[140:143]
  v_mfma_f32_16x16x32_bf16 a[140:143], v[96:99], a[240:243], a[140:143]
  buffer_load_dwordx4 a[216:219], v2, s[8:11], s46 offen offset:1024 sc1
  v_mfma_f32_16x16x32_bf16 a[144:147], v[72:75], a[220:223], a[144:147]
  v_mfma_f32_16x16x32_bf16 a[144:147], v[104:107], a[240:243], a[144:147]
  s_waitcnt vmcnt(20)
  v_mfma_f32_16x16x32_bf16 v[108:111], v[112:115], a[244:247], v[108:111]
  s_add_u32 s47, s97, 0x2000
  v_mfma_f32_16x16x32_bf16 v[108:111], v[144:147], a[248:251], v[108:111]
  buffer_load_dwordx4 a[220:223], v2, s[8:11], s47 offen sc1
  v_mfma_f32_16x16x32_bf16 v[116:119], v[120:123], a[244:247], v[116:119]
  v_mfma_f32_16x16x32_bf16 v[116:119], v[152:155], a[248:251], v[116:119]
  v_mfma_f32_16x16x32_bf16 v[124:127], v[128:131], a[244:247], v[124:127]
  v_mfma_f32_16x16x32_bf16 v[124:127], v[160:163], a[248:251], v[124:127]
  buffer_load_dwordx4 a[240:243], v2, s[8:11], s47 offen offset:1024 sc1
  v_mfma_f32_16x16x32_bf16 v[132:135], v[136:139], a[244:247], v[132:135]
  v_mfma_f32_16x16x32_bf16 v[132:135], v[168:171], a[248:251], v[132:135]
  s_waitcnt vmcnt(20)
  v_mfma_f32_16x16x32_bf16 a[84:87], v[112:115], a[252:255], a[84:87]
  s_add_u32 s46, s98, 0x2000
  v_mfma_f32_16x16x32_bf16 a[84:87], v[144:147], v[244:247], a[84:87]
  buffer_load_dwordx4 a[244:247], v2, s[8:11], s46 offen sc1
  v_mfma_f32_16x16x32_bf16 a[88:91], v[120:123], a[252:255], a[88:91]
  v_mfma_f32_16x16x32_bf16 a[88:91], v[152:155], v[244:247], a[88:91]
  v_mfma_f32_16x16x32_bf16 a[92:95], v[128:131], a[252:255], a[92:95]
  v_mfma_f32_16x16x32_bf16 a[92:95], v[160:163], v[244:247], a[92:95]
  buffer_load_dwordx4 a[248:251], v2, s[8:11], s46 offen offset:1024 sc1
  v_mfma_f32_16x16x32_bf16 a[96:99], v[136:139], a[252:255], a[96:99]
  v_mfma_f32_16x16x32_bf16 a[96:99], v[168:171], v[244:247], a[96:99]
  s_waitcnt vmcnt(20)
  v_mfma_f32_16x16x32_bf16 a[100:103], v[112:115], a[148:151], a[100:103]
  s_add_u32 s47, s99, 0x2000
  v_mfma_f32_16x16x32_bf16 a[100:103], v[144:147], a[152:155], a[100:103]
  buffer_load_dwordx4 a[252:255], v2, s[8:11], s47 offen sc1
  v_mfma_f32_16x16x32_bf16 a[104:107], v[120:123], a[148:151], a[104:107]
  v_mfma_f32_16x16x32_bf16 a[104:107], v[152:155], a[152:155], a[104:107]
  v_mfma_f32_16x16x32_bf16 a[108:111], v[128:131], a[148:151], a[108:111]
  v_mfma_f32_16x16x32_bf16 a[108:111], v[160:163], a[152:155], a[108:111]
  buffer_load_dwordx4 v[244:247], v2, s[8:11], s47 offen offset:1024 sc1
  v_mfma_f32_16x16x32_bf16 a[112:115], v[136:139], a[148:151], a[112:115]
  v_mfma_f32_16x16x32_bf16 a[112:115], v[168:171], a[152:155], a[112:115]
  s_waitcnt vmcnt(20)
  v_mfma_f32_16x16x32_bf16 a[116:119], v[112:115], a[156:159], a[116:119]
  s_add_u32 s46, s101, 0x2000
  v_mfma_f32_16x16x32_bf16 a[116:119], v[144:147], a[160:163], a[116:119]
  buffer_load_dwordx4 a[148:151], v2, s[8:11], s46 offen sc1
  v_mfma_f32_16x16x32_bf16 a[120:123], v[120:123], a[156:159], a[120:123]
  v_mfma_f32_16x16x32_bf16 a[120:123], v[152:155], a[160:163], a[120:123]
  v_mfma_f32_16x16x32_bf16 a[124:127], v[128:131], a[156:159], a[124:127]
  v_mfma_f32_16x16x32_bf16 a[124:127], v[160:163], a[160:163], a[124:127]
  buffer_load_dwordx4 a[152:155], v2, s[8:11], s46 offen offset:1024 sc1
  v_mfma_f32_16x16x32_bf16 a[128:131], v[136:139], a[156:159], a[128:131]
  v_mfma_f32_16x16x32_bf16 a[128:131], v[168:171], a[160:163], a[128:131]
  s_waitcnt vmcnt(20)
  v_mfma_f32_16x16x32_bf16 a[132:135], v[112:115], a[164:167], a[132:135]
  s_add_u32 s47, s96, 0x2800
  v_mfma_f32_16x16x32_bf16 a[132:135], v[144:147], a[168:171], a[132:135]
  buffer_load_dwordx4 a[156:159], v2, s[8:11], s47 offen sc1
  v_mfma_f32_16x16x32_bf16 a[136:139], v[120:123], a[164:167], a[136:139]
  v_lshlrev_b32 v249, 4, v14
  v_mfma_f32_16x16x32_bf16 a[136:139], v[152:155], a[168:171], a[136:139]
  s_add_u32 s44, s38, 1
  v_mfma_f32_16x16x32_bf16 a[140:143], v[128:131], a[164:167], a[140:143]
  s_and_b32 s44, s44, 3
  v_mfma_f32_16x16x32_bf16 a[140:143], v[160:163], a[168:171], a[140:143]
  buffer_load_dwordx4 a[160:163], v2, s[8:11], s47 offen offset:1024 sc1
  v_mfma_f32_16x16x32_bf16 a[144:147], v[136:139], a[164:167], a[144:147]
  s_mul_i32 s44, s44, 0x3000
  v_mfma_f32_16x16x32_bf16 a[144:147], v[168:171], a[168:171], a[144:147]
  s_waitcnt vmcnt(20)
  v_mfma_f32_16x16x32_bf16 v[108:111], v[208:211], a[172:175], v[108:111]
  s_add_u32 s46, s97, 0x2800
  v_mfma_f32_16x16x32_bf16 v[108:111], v[224:227], a[176:179], v[108:111]
  buffer_load_dwordx4 a[164:167], v2, s[8:11], s46 offen sc1
  v_mfma_f32_16x16x32_bf16 v[116:119], v[212:215], a[172:175], v[116:119]
  s_add_u32 s44, s44, 0
  v_mfma_f32_16x16x32_bf16 v[116:119], v[228:231], a[176:179], v[116:119]
  v_add_u32 v4, s44, v249
  v_mfma_f32_16x16x32_bf16 v[124:127], v[216:219], a[172:175], v[124:127]
  s_add_u32 s44, s38, 2
  v_mfma_f32_16x16x32_bf16 v[124:127], v[232:235], a[176:179], v[124:127]
  buffer_load_dwordx4 a[168:171], v2, s[8:11], s46 offen offset:1024 sc1
  v_mfma_f32_16x16x32_bf16 v[132:135], v[220:223], a[172:175], v[132:135]
  s_and_b32 s44, s44, 3
  v_mfma_f32_16x16x32_bf16 v[132:135], v[236:239], a[176:179], v[132:135]
  s_waitcnt vmcnt(20)
  v_mfma_f32_16x16x32_bf16 a[84:87], v[208:211], a[180:183], a[84:87]
  s_add_u32 s47, s98, 0x2800
  v_mfma_f32_16x16x32_bf16 a[84:87], v[224:227], a[184:187], a[84:87]
  buffer_load_dwordx4 a[172:175], v2, s[8:11], s47 offen sc1
  v_mfma_f32_16x16x32_bf16 a[88:91], v[212:215], a[180:183], a[88:91]
  s_mul_i32 s44, s44, 0x3000
  v_mfma_f32_16x16x32_bf16 a[88:91], v[228:231], a[184:187], a[88:91]
  s_add_u32 s44, s44, 0x1000
  v_mfma_f32_16x16x32_bf16 a[92:95], v[216:219], a[180:183], a[92:95]
  v_add_u32 v5, s44, v249
  v_mfma_f32_16x16x32_bf16 a[92:95], v[232:235], a[184:187], a[92:95]
  buffer_load_dwordx4 a[176:179], v2, s[8:11], s47 offen offset:1024 sc1
  v_mfma_f32_16x16x32_bf16 a[96:99], v[220:223], a[180:183], a[96:99]
  s_add_u32 s44, s38, 3
  v_mfma_f32_16x16x32_bf16 a[96:99], v[236:239], a[184:187], a[96:99]
  s_waitcnt vmcnt(20)
  v_mfma_f32_16x16x32_bf16 a[100:103], v[208:211], a[188:191], a[100:103]
  s_add_u32 s46, s99, 0x2800
  v_mfma_f32_16x16x32_bf16 a[100:103], v[224:227], a[192:195], a[100:103]
  buffer_load_dwordx4 a[180:183], v2, s[8:11], s46 offen sc1
  v_mfma_f32_16x16x32_bf16 a[104:107], v[212:215], a[188:191], a[104:107]
  s_and_b32 s44, s44, 3
  v_mfma_f32_16x16x32_bf16 a[104:107], v[228:231], a[192:195], a[104:107]
  s_mul_i32 s44, s44, 0x3000
  v_mfma_f32_16x16x32_bf16 a[108:111], v[216:219], a[188:191], a[108:111]
  s_add_u32 s44, s44, 0x2000
  v_mfma_f32_16x16x32_bf16 a[108:111], v[232:235], a[192:195], a[108:111]
  buffer_load_dwordx4 a[184:187], v2, s[8:11], s46 offen offset:1024 sc1
  v_mfma_f32_16x16x32_bf16 a[112:115], v[220:223], a[188:191], a[112:115]
  v_add_u32 v6, s44, v249
  v_mfma_f32_16x16x32_bf16 a[112:115], v[236:239], a[192:195], a[112:115]
  s_waitcnt vmcnt(20)
  v_mfma_f32_16x16x32_bf16 a[116:119], v[208:211], a[196:199], a[116:119]
  s_add_u32 s47, s101, 0x2800
  v_mfma_f32_16x16x32_bf16 a[116:119], v[224:227], a[200:203], a[116:119]
  buffer_load_dwordx4 a[188:191], v2, s[8:11], s47 offen sc1
  v_mfma_f32_16x16x32_bf16 a[120:123], v[212:215], a[196:199], a[120:123]
  s_add_u32 s44, s75, 0xc000
  v_mfma_f32_16x16x32_bf16 a[120:123], v[228:231], a[200:203], a[120:123]
  v_add_u32 v7, s44, v249
  v_mfma_f32_16x16x32_bf16 a[124:127], v[216:219], a[196:199], a[124:127]
  s_mul_i32 s44, s38, 0x3000
  v_mfma_f32_16x16x32_bf16 a[124:127], v[232:235], a[200:203], a[124:127]
  buffer_load_dwordx4 a[192:195], v2, s[8:11], s47 offen offset:1024 sc1
  v_mfma_f32_16x16x32_bf16 a[128:131], v[220:223], a[196:199], a[128:131]
  v_add_u32 v8, s44, v249
  v_mfma_f32_16x16x32_bf16 a[128:131], v[236:239], a[200:203], a[128:131]
  s_waitcnt vmcnt(20)
  v_mfma_f32_16x16x32_bf16 a[132:135], v[208:211], a[204:207], a[132:135]
  s_add_u32 s46, s96, 0x3000
  v_mfma_f32_16x16x32_bf16 a[132:135], v[224:227], a[208:211], a[132:135]
  buffer_load_dwordx4 a[196:199], v2, s[8:11], s46 offen sc1
  v_mfma_f32_16x16x32_bf16 a[136:139], v[212:215], a[204:207], a[136:139]
  s_lshl_b32 s44, s3, 10
  v_mfma_f32_16x16x32_bf16 a[136:139], v[228:231], a[208:211], a[136:139]
  s_add_u32 s44, s44, 0xc000
  v_mfma_f32_16x16x32_bf16 a[140:143], v[216:219], a[204:207], a[140:143]
  v_add_u32 v9, s44, v249
  v_mfma_f32_16x16x32_bf16 a[140:143], v[232:235], a[208:211], a[140:143]
  buffer_load_dwordx4 a[200:203], v2, s[8:11], s46 offen offset:1024 sc1
  v_mfma_f32_16x16x32_bf16 a[144:147], v[220:223], a[204:207], a[144:147]
  s_mul_i32 s44, s3, 0x1400
  v_mfma_f32_16x16x32_bf16 a[144:147], v[236:239], a[208:211], a[144:147]
  s_waitcnt vmcnt(20)
  v_mfma_f32_16x16x32_bf16 v[108:111], v[20:23], a[212:215], v[108:111]
  s_add_u32 s47, s97, 0x3000
  v_mfma_f32_16x16x32_bf16 v[108:111], v[52:55], a[216:219], v[108:111]
  buffer_load_dwordx4 a[204:207], v2, s[8:11], s47 offen sc1
  v_mfma_f32_16x16x32_bf16 v[116:119], v[28:31], a[212:215], v[116:119]
  v_add_u32 v12, s44, v249
  v_mfma_f32_16x16x32_bf16 v[116:119], v[60:63], a[216:219], v[116:119]
  v_and_b32 v250, 15, v14
  v_mfma_f32_16x16x32_bf16 v[124:127], v[36:39], a[212:215], v[124:127]
  v_lshrrev_b32 v251, 4, v14
  v_mfma_f32_16x16x32_bf16 v[124:127], v[68:71], a[216:219], v[124:127]
  buffer_load_dwordx4 a[208:211], v2, s[8:11], s47 offen offset:1024 sc1
  v_mfma_f32_16x16x32_bf16 v[132:135], v[44:47], a[212:215], v[132:135]
  v_lshlrev_b32 v251, 3, v251
  v_mfma_f32_16x16x32_bf16 v[132:135], v[76:79], a[216:219], v[132:135]
  s_waitcnt vmcnt(20)
  v_mfma_f32_16x16x32_bf16 a[84:87], v[20:23], a[220:223], a[84:87]
  s_add_u32 s46, s98, 0x3000
  v_mfma_f32_16x16x32_bf16 a[84:87], v[52:55], a[240:243], a[84:87]
  buffer_load_dwordx4 a[212:215], v2, s[8:11], s46 offen sc1
  v_mfma_f32_16x16x32_bf16 a[88:91], v[28:31], a[220:223], a[88:91]
  v_lshl_add_u32 v251, v250, 10, v251
  v_mfma_f32_16x16x32_bf16 a[88:91], v[60:63], a[240:243], a[88:91]
  s_lshl_b32 s44, s66, 1
  v_mfma_f32_16x16x32_bf16 a[92:95], v[36:39], a[220:223], a[92:95]
  s_add_u32 s44, s44, s68
  v_mfma_f32_16x16x32_bf16 a[92:95], v[68:71], a[240:243], a[92:95]
  buffer_load_dwordx4 a[216:219], v2, s[8:11], s46 offen offset:1024 sc1
  v_mfma_f32_16x16x32_bf16 a[96:99], v[44:47], a[220:223], a[96:99]
  s_lshl_b32 s44, s44, 2
  v_mfma_f32_16x16x32_bf16 a[96:99], v[76:79], a[240:243], a[96:99]
  s_waitcnt vmcnt(20)
  v_mfma_f32_16x16x32_bf16 a[100:103], v[20:23], a[244:247], a[100:103]
  s_add_u32 s47, s99, 0x3000
  v_mfma_f32_16x16x32_bf16 a[100:103], v[52:55], a[248:251], a[100:103]
  buffer_load_dwordx4 a[220:223], v2, s[8:11], s47 offen sc1
  v_mfma_f32_16x16x32_bf16 a[104:107], v[28:31], a[244:247], a[104:107]
  s_add_u32 s44, s44, s38
  v_mfma_f32_16x16x32_bf16 a[104:107], v[60:63], a[248:251], a[104:107]
  s_lshl_b32 s44, s44, 14
  v_mfma_f32_16x16x32_bf16 a[108:111], v[36:39], a[244:247], a[108:111]
  v_add_u32 v10, s44, v251
  v_mfma_f32_16x16x32_bf16 a[108:111], v[68:71], a[248:251], a[108:111]
  buffer_load_dwordx4 a[240:243], v2, s[8:11], s47 offen offset:1024 sc1
  v_mfma_f32_16x16x32_bf16 a[112:115], v[44:47], a[244:247], a[112:115]
  s_add_u32 s44, s66, 16
  v_mfma_f32_16x16x32_bf16 a[112:115], v[76:79], a[248:251], a[112:115]
  s_waitcnt vmcnt(20)
  v_mfma_f32_16x16x32_bf16 a[116:119], v[20:23], a[252:255], a[116:119]
  s_add_u32 s46, s101, 0x3000
  v_mfma_f32_16x16x32_bf16 a[116:119], v[52:55], v[244:247], a[116:119]
  buffer_load_dwordx4 a[244:247], v2, s[8:11], s46 offen sc1
  v_mfma_f32_16x16x32_bf16 a[120:123], v[28:31], a[252:255], a[120:123]
  s_lshl_b32 s44, s44, 14
  v_mfma_f32_16x16x32_bf16 a[120:123], v[60:63], v[244:247], a[120:123]
  s_lshl_b32 s45, s3, 5
  v_mfma_f32_16x16x32_bf16 a[124:127], v[36:39], a[252:255], a[124:127]
  s_add_u32 s44, s44, s45
  v_mfma_f32_16x16x32_bf16 a[124:127], v[68:71], v[244:247], a[124:127]
  buffer_load_dwordx4 a[248:251], v2, s[8:11], s46 offen offset:1024 sc1
  v_mfma_f32_16x16x32_bf16 a[128:131], v[44:47], a[252:255], a[128:131]
  s_lshr_b32 s45, s3, 1
  v_mfma_f32_16x16x32_bf16 a[128:131], v[76:79], v[244:247], a[128:131]
  s_waitcnt vmcnt(20)
  v_mfma_f32_16x16x32_bf16 a[132:135], v[20:23], a[148:151], a[132:135]
  s_add_u32 s47, s101, 0x3800
  v_mfma_f32_16x16x32_bf16 a[132:135], v[52:55], a[152:155], a[132:135]
  buffer_load_dwordx4 a[252:255], v2, s[8:11], s47 offen sc1
  v_mfma_f32_16x16x32_bf16 a[136:139], v[28:31], a[148:151], a[136:139]
  s_cmp_eq_u32 s45, s68
  s_cselect_b32 s44, s44, 0x7ff00000
  v_mfma_f32_16x16x32_bf16 a[136:139], v[60:63], a[152:155], a[136:139]
  v_add_u32 v11, s44, v251
  v_mfma_f32_16x16x32_bf16 a[140:143], v[36:39], a[148:151], a[140:143]
  s_mul_i32 s44, s70, 0x48000
  v_mfma_f32_16x16x32_bf16 a[140:143], v[68:71], a[152:155], a[140:143]
  buffer_load_dwordx4 v[244:247], v2, s[8:11], s47 offen offset:1024 sc1
  v_mfma_f32_16x16x32_bf16 a[144:147], v[44:47], a[148:151], a[144:147]
  s_lshl_b32 s45, s67, 7
  v_mfma_f32_16x16x32_bf16 a[144:147], v[76:79], a[152:155], a[144:147]
  s_waitcnt vmcnt(20)
  v_mfma_f32_16x16x32_bf16 v[108:111], v[84:87], a[156:159], v[108:111]
  s_add_u32 s46, s97, 0x3800
  v_mfma_f32_16x16x32_bf16 v[108:111], a[4:7], a[160:163], v[108:111]
  buffer_load_dwordx4 a[148:151], v2, s[8:11], s46 offen sc1
  v_mfma_f32_16x16x32_bf16 v[116:119], v[92:95], a[156:159], v[116:119]
  s_add_u32 s44, s44, s45
  v_mfma_f32_16x16x32_bf16 v[116:119], a[8:11], a[160:163], v[116:119]
  s_sub_u32 s45, 0x240000, s44
  v_mfma_f32_16x16x32_bf16 v[124:127], v[100:103], a[156:159], v[124:127]
  s_add_u32 s32, s58, s44
  s_addc_u32 s33, s59, 0
  v_mfma_f32_16x16x32_bf16 v[124:127], a[12:15], a[160:163], v[124:127]
  buffer_load_dwordx4 a[152:155], v2, s[8:11], s46 offen offset:1024 sc1
  v_mfma_f32_16x16x32_bf16 v[132:135], a[0:3], a[156:159], v[132:135]
  s_mov_b32 s34, s45
  v_mfma_f32_16x16x32_bf16 v[132:135], a[16:19], a[160:163], v[132:135]
  s_waitcnt vmcnt(20)
  v_mfma_f32_16x16x32_bf16 a[84:87], v[84:87], a[164:167], a[84:87]
  s_add_u32 s47, s98, 0x3800
  v_mfma_f32_16x16x32_bf16 a[84:87], a[4:7], a[168:171], a[84:87]
  buffer_load_dwordx4 a[156:159], v2, s[8:11], s47 offen sc1
  v_mfma_f32_16x16x32_bf16 a[88:91], v[92:95], a[164:167], a[88:91]
  s_mov_b32 s35, 0x20000
  v_mfma_f32_16x16x32_bf16 a[88:91], a[8:11], a[168:171], a[88:91]
  s_mul_i32 s44, s69, 0x5000
  v_mfma_f32_16x16x32_bf16 a[92:95], v[100:103], a[164:167], a[92:95]
  s_add_u32 s44, s44, 0x1a00000
  v_mfma_f32_16x16x32_bf16 a[92:95], a[12:15], a[168:171], a[92:95]
  buffer_load_dwordx4 a[160:163], v2, s[8:11], s47 offen offset:1024 sc1
  v_mfma_f32_16x16x32_bf16 a[96:99], a[0:3], a[164:167], a[96:99]
  s_add_u32 s12, s62, s44
  s_addc_u32 s13, s63, 0
  v_mfma_f32_16x16x32_bf16 a[96:99], a[16:19], a[168:171], a[96:99]
  s_waitcnt vmcnt(20)
  v_mfma_f32_16x16x32_bf16 a[100:103], v[84:87], a[172:175], a[100:103]
  s_add_u32 s46, s99, 0x3800
  v_mfma_f32_16x16x32_bf16 a[100:103], a[4:7], a[176:179], a[100:103]
  buffer_load_dwordx4 a[164:167], v2, s[8:11], s46 offen sc1
  v_mfma_f32_16x16x32_bf16 a[104:107], v[92:95], a[172:175], a[104:107]
  s_mov_b32 s14, 0x5000
  v_mfma_f32_16x16x32_bf16 a[104:107], a[8:11], a[176:179], a[104:107]
  s_mov_b32 s15, 0x20000
  v_mfma_f32_16x16x32_bf16 a[108:111], v[100:103], a[172:175], a[108:111]
  s_xor_b32 s44, s69, 1
  v_mfma_f32_16x16x32_bf16 a[108:111], a[12:15], a[176:179], a[108:111]
  buffer_load_dwordx4 a[168:171], v2, s[8:11], s46 offen offset:1024 sc1
  v_mfma_f32_16x16x32_bf16 a[112:115], a[0:3], a[172:175], a[112:115]
  s_mul_i32 s44, s44, 0x5000
  v_mfma_f32_16x16x32_bf16 a[112:115], a[16:19], a[176:179], a[112:115]
  s_waitcnt vmcnt(20)
  v_mfma_f32_16x16x32_bf16 a[116:119], v[84:87], a[180:183], a[116:119]
  s_add_u32 s47, s96, 0x3800
  v_mfma_f32_16x16x32_bf16 a[116:119], a[4:7], a[184:187], a[116:119]
  buffer_load_dwordx4 a[172:175], v2, s[8:11], s47 offen sc1
  v_mfma_f32_16x16x32_bf16 a[120:123], v[92:95], a[180:183], a[120:123]
  s_add_u32 s44, s44, 0x1a00000
  v_mfma_f32_16x16x32_bf16 a[120:123], a[8:11], a[184:187], a[120:123]
  s_add_u32 s16, s62, s44
  s_addc_u32 s17, s63, 0
  v_mfma_f32_16x16x32_bf16 a[124:127], v[100:103], a[180:183], a[124:127]
  s_mov_b32 s18, 0x5000
  v_mfma_f32_16x16x32_bf16 a[124:127], a[12:15], a[184:187], a[124:127]
  buffer_load_dwordx4 a[176:179], v2, s[8:11], s47 offen offset:1024 sc1
  v_mfma_f32_16x16x32_bf16 a[128:131], a[0:3], a[180:183], a[128:131]
  s_mov_b32 s19, 0x20000
  v_mfma_f32_16x16x32_bf16 a[128:131], a[16:19], a[184:187], a[128:131]
  s_waitcnt vmcnt(20)
  v_mfma_f32_16x16x32_bf16 a[132:135], v[84:87], a[188:191], a[132:135]
  s_xor_b32 s96, s96, 0x80000
  s_xor_b32 s97, s97, 0x80000
  s_xor_b32 s98, s98, 0x80000
  s_xor_b32 s99, s99, 0x80000
  s_add_u32 s46, s96, 0
  v_mfma_f32_16x16x32_bf16 a[132:135], a[4:7], a[192:195], a[132:135]
  buffer_load_dwordx4 a[180:183], v2, s[8:11], s46 offen sc1
  v_mfma_f32_16x16x32_bf16 a[136:139], v[92:95], a[188:191], a[136:139]
  v_mfma_f32_16x16x32_bf16 a[136:139], a[8:11], a[192:195], a[136:139]
  v_mfma_f32_16x16x32_bf16 a[140:143], v[100:103], a[188:191], a[140:143]
  v_mfma_f32_16x16x32_bf16 a[140:143], a[12:15], a[192:195], a[140:143]
  buffer_load_dwordx4 a[184:187], v2, s[8:11], s46 offen offset:1024 sc1
  v_mfma_f32_16x16x32_bf16 a[144:147], a[0:3], a[188:191], a[144:147]
  v_mfma_f32_16x16x32_bf16 a[144:147], a[16:19], a[192:195], a[144:147]
  s_waitcnt vmcnt(20)
  v_mfma_f32_16x16x32_bf16 v[108:111], a[20:23], a[196:199], v[108:111]
  s_add_u32 s47, s97, 0
  v_mfma_f32_16x16x32_bf16 v[108:111], a[36:39], a[200:203], v[108:111]
  buffer_load_dwordx4 a[188:191], v2, s[8:11], s47 offen sc1
  v_mfma_f32_16x16x32_bf16 v[116:119], a[24:27], a[196:199], v[116:119]
  v_mfma_f32_16x16x32_bf16 v[116:119], a[40:43], a[200:203], v[116:119]
  v_mfma_f32_16x16x32_bf16 v[124:127], a[28:31], a[196:199], v[124:127]
  v_mfma_f32_16x16x32_bf16 v[124:127], a[44:47], a[200:203], v[124:127]
  buffer_load_dwordx4 a[192:195], v2, s[8:11], s47 offen offset:1024 sc1
  v_mfma_f32_16x16x32_bf16 v[132:135], a[32:35], a[196:199], v[132:135]
  v_mfma_f32_16x16x32_bf16 v[132:135], a[48:51], a[200:203], v[132:135]
  s_waitcnt vmcnt(20)
  v_mfma_f32_16x16x32_bf16 a[84:87], a[20:23], a[204:207], a[84:87]
  s_add_u32 s46, s98, 0
  v_mfma_f32_16x16x32_bf16 a[84:87], a[36:39], a[208:211], a[84:87]
  buffer_load_dwordx4 a[196:199], v2, s[8:11], s46 offen sc1
  v_mfma_f32_16x16x32_bf16 a[88:91], a[24:27], a[204:207], a[88:91]
  v_mfma_f32_16x16x32_bf16 a[88:91], a[40:43], a[208:211], a[88:91]
  v_mfma_f32_16x16x32_bf16 a[92:95], a[28:31], a[204:207], a[92:95]
  v_mfma_f32_16x16x32_bf16 a[92:95], a[44:47], a[208:211], a[92:95]
  buffer_load_dwordx4 a[200:203], v2, s[8:11], s46 offen offset:1024 sc1
  v_mfma_f32_16x16x32_bf16 a[96:99], a[32:35], a[204:207], a[96:99]
  v_mfma_f32_16x16x32_bf16 a[96:99], a[48:51], a[208:211], a[96:99]
  s_waitcnt vmcnt(20)
  v_mfma_f32_16x16x32_bf16 a[100:103], a[20:23], a[212:215], a[100:103]
  s_add_u32 s47, s99, 0
  v_mfma_f32_16x16x32_bf16 a[100:103], a[36:39], a[216:219], a[100:103]
  buffer_load_dwordx4 a[204:207], v2, s[8:11], s47 offen sc1
  v_mfma_f32_16x16x32_bf16 a[104:107], a[24:27], a[212:215], a[104:107]
  v_mfma_f32_16x16x32_bf16 a[104:107], a[40:43], a[216:219], a[104:107]
  v_mfma_f32_16x16x32_bf16 a[108:111], a[28:31], a[212:215], a[108:111]
  v_mfma_f32_16x16x32_bf16 a[108:111], a[44:47], a[216:219], a[108:111]
  buffer_load_dwordx4 a[208:211], v2, s[8:11], s47 offen offset:1024 sc1
  v_mfma_f32_16x16x32_bf16 a[112:115], a[32:35], a[212:215], a[112:115]
  v_mfma_f32_16x16x32_bf16 a[112:115], a[48:51], a[216:219], a[112:115]
  s_waitcnt vmcnt(20)
  v_mfma_f32_16x16x32_bf16 a[116:119], a[20:23], a[220:223], a[116:119]
  s_add_u32 s46, s96, 0x800
  v_mfma_f32_16x16x32_bf16 a[116:119], a[36:39], a[240:243], a[116:119]
  buffer_load_dwordx4 a[212:215], v2, s[8:11], s46 offen sc1
  v_mfma_f32_16x16x32_bf16 a[120:123], a[24:27], a[220:223], a[120:123]
  v_mfma_f32_16x16x32_bf16 a[120:123], a[40:43], a[240:243], a[120:123]
  v_mfma_f32_16x16x32_bf16 a[124:127], a[28:31], a[220:223], a[124:127]
  v_mfma_f32_16x16x32_bf16 a[124:127], a[44:47], a[240:243], a[124:127]
  buffer_load_dwordx4 a[216:219], v2, s[8:11], s46 offen offset:1024 sc1
  v_mfma_f32_16x16x32_bf16 a[128:131], a[32:35], a[220:223], a[128:131]
  v_mfma_f32_16x16x32_bf16 a[128:131], a[48:51], a[240:243], a[128:131]
  s_waitcnt vmcnt(20)
  v_mfma_f32_16x16x32_bf16 a[132:135], a[20:23], a[244:247], a[132:135]
  s_add_u32 s47, s97, 0x800
  v_mfma_f32_16x16x32_bf16 a[132:135], a[36:39], a[248:251], a[132:135]
  buffer_load_dwordx4 a[220:223], v2, s[8:11], s47 offen sc1
  v_mfma_f32_16x16x32_bf16 a[136:139], a[24:27], a[244:247], a[136:139]
  v_mfma_f32_16x16x32_bf16 a[136:139], a[40:43], a[248:251], a[136:139]
  v_mfma_f32_16x16x32_bf16 a[140:143], a[28:31], a[244:247], a[140:143]
  v_mfma_f32_16x16x32_bf16 a[140:143], a[44:47], a[248:251], a[140:143]
  buffer_load_dwordx4 a[240:243], v2, s[8:11], s47 offen offset:1024 sc1
  v_mfma_f32_16x16x32_bf16 a[144:147], a[32:35], a[244:247], a[144:147]
  v_mfma_f32_16x16x32_bf16 a[144:147], a[48:51], a[248:251], a[144:147]
  s_waitcnt vmcnt(20)
  v_mfma_f32_16x16x32_bf16 a[132:135], a[52:55], a[252:255], a[132:135]
  s_add_u32 s46, s98, 0x800
  v_mfma_f32_16x16x32_bf16 a[132:135], a[68:71], v[244:247], a[132:135]
  buffer_load_dwordx4 a[244:247], v2, s[8:11], s46 offen sc1
  v_mfma_f32_16x16x32_bf16 a[136:139], a[56:59], a[252:255], a[136:139]
  v_mfma_f32_16x16x32_bf16 a[136:139], a[72:75], v[244:247], a[136:139]
  v_mfma_f32_16x16x32_bf16 a[140:143], a[60:63], a[252:255], a[140:143]
  v_mfma_f32_16x16x32_bf16 a[140:143], a[76:79], v[244:247], a[140:143]
  buffer_load_dwordx4 a[248:251], v2, s[8:11], s46 offen offset:1024 sc1
  v_mfma_f32_16x16x32_bf16 a[144:147], a[64:67], a[252:255], a[144:147]
  v_mfma_f32_16x16x32_bf16 a[144:147], a[80:83], v[244:247], a[144:147]
  s_waitcnt vmcnt(20)
  v_mfma_f32_16x16x32_bf16 a[84:87], a[52:55], a[148:151], a[84:87]
  s_add_u32 s47, s99, 0x800
  v_mfma_f32_16x16x32_bf16 a[84:87], a[68:71], a[152:155], a[84:87]
  buffer_load_dwordx4 a[252:255], v2, s[8:11], s47 offen sc1
  v_mfma_f32_16x16x32_bf16 a[88:91], a[56:59], a[148:151], a[88:91]
  ds_write_b128 v7, a[132:135]
  v_mfma_f32_16x16x32_bf16 a[88:91], a[72:75], a[152:155], a[88:91]
  ds_write_b128 v7, a[136:139] offset:1024
  v_mfma_f32_16x16x32_bf16 a[92:95], a[60:63], a[148:151], a[92:95]
  v_mfma_f32_16x16x32_bf16 a[92:95], a[76:79], a[152:155], a[92:95]
  buffer_load_dwordx4 v[244:247], v2, s[8:11], s47 offen offset:1024 sc1
  v_mfma_f32_16x16x32_bf16 a[96:99], a[64:67], a[148:151], a[96:99]
  ds_write_b128 v7, a[140:143] offset:2048
  v_mfma_f32_16x16x32_bf16 a[96:99], a[80:83], a[152:155], a[96:99]
  ds_write_b128 v7, a[144:147] offset:3072
  s_waitcnt vmcnt(20)
  v_mfma_f32_16x16x32_bf16 a[100:103], a[52:55], a[156:159], a[100:103]
  s_add_u32 s46, s96, 0x1000
  v_mfma_f32_16x16x32_bf16 a[100:103], a[68:71], a[160:163], a[100:103]
  buffer_load_dwordx4 a[148:151], v2, s[8:11], s46 offen sc1
  v_mfma_f32_16x16x32_bf16 a[104:107], a[56:59], a[156:159], a[104:107]
  ds_write_b128 v4, a[84:87]
  v_mfma_f32_16x16x32_bf16 a[104:107], a[72:75], a[160:163], a[104:107]
  ds_write_b128 v4, a[88:91] offset:1024
  v_mfma_f32_16x16x32_bf16 a[108:111], a[60:63], a[156:159], a[108:111]
  v_mfma_f32_16x16x32_bf16 a[108:111], a[76:79], a[160:163], a[108:111]
  buffer_load_dwordx4 a[152:155], v2, s[8:11], s46 offen offset:1024 sc1
  v_mfma_f32_16x16x32_bf16 a[112:115], a[64:67], a[156:159], a[112:115]
  ds_write_b128 v4, a[92:95] offset:2048
  v_mfma_f32_16x16x32_bf16 a[112:115], a[80:83], a[160:163], a[112:115]
  ds_write_b128 v4, a[96:99] offset:3072
  s_waitcnt vmcnt(20)
  v_mfma_f32_16x16x32_bf16 a[116:119], a[52:55], a[164:167], a[116:119]
  s_add_u32 s47, s97, 0x1000
  v_mfma_f32_16x16x32_bf16 a[116:119], a[68:71], a[168:171], a[116:119]
  buffer_load_dwordx4 a[156:159], v2, s[8:11], s47 offen sc1
  v_mfma_f32_16x16x32_bf16 a[120:123], a[56:59], a[164:167], a[120:123]
  ds_write_b128 v5, a[100:103]
  v_mfma_f32_16x16x32_bf16 a[120:123], a[72:75], a[168:171], a[120:123]
  ds_write_b128 v5, a[104:107] offset:1024
  v_mfma_f32_16x16x32_bf16 a[124:127], a[60:63], a[164:167], a[124:127]
  v_mfma_f32_16x16x32_bf16 a[124:127], a[76:79], a[168:171], a[124:127]
  buffer_load_dwordx4 a[160:163], v2, s[8:11], s47 offen offset:1024 sc1
  v_mfma_f32_16x16x32_bf16 a[128:131], a[64:67], a[164:167], a[128:131]
  ds_write_b128 v5, a[108:111] offset:2048
  v_mfma_f32_16x16x32_bf16 a[128:131], a[80:83], a[168:171], a[128:131]
  ds_write_b128 v5, a[112:115] offset:3072
  s_waitcnt vmcnt(20)
  v_mfma_f32_16x16x32_bf16 v[108:111], a[52:55], a[172:175], v[108:111]
  s_add_u32 s46, s98, 0x1000
  v_mfma_f32_16x16x32_bf16 v[108:111], a[68:71], a[176:179], v[108:111]
  buffer_load_dwordx4 a[164:167], v2, s[8:11], s46 offen sc1
  v_mfma_f32_16x16x32_bf16 v[116:119], a[56:59], a[172:175], v[116:119]
  ds_write_b128 v6, a[116:119]
  v_mfma_f32_16x16x32_bf16 v[116:119], a[72:75], a[176:179], v[116:119]
  ds_write_b128 v6, a[120:123] offset:1024
  v_mfma_f32_16x16x32_bf16 v[124:127], a[60:63], a[172:175], v[124:127]
  v_mfma_f32_16x16x32_bf16 v[124:127], a[76:79], a[176:179], v[124:127]
  buffer_load_dwordx4 a[168:171], v2, s[8:11], s46 offen offset:1024 sc1
  v_mfma_f32_16x16x32_bf16 v[132:135], a[64:67], a[172:175], v[132:135]
  ds_write_b128 v6, a[124:127] offset:2048
  v_mfma_f32_16x16x32_bf16 v[132:135], a[80:83], a[176:179], v[132:135]
  ds_write_b128 v6, a[128:131] offset:3072
  s_waitcnt vmcnt(20)
  v_mfma_f32_16x16x32_bf16 v[140:143], a[224:227], a[180:183], 0
  s_add_u32 s47, s99, 0x1000
  v_mfma_f32_16x16x32_bf16 v[140:143], v[16:19], a[184:187], v[140:143]
  buffer_load_dwordx4 a[172:175], v2, s[8:11], s47 offen sc1
  v_mfma_f32_16x16x32_bf16 v[148:151], a[228:231], a[180:183], 0
  v_mfma_f32_16x16x32_bf16 v[148:151], v[24:27], a[184:187], v[148:151]
  v_mfma_f32_16x16x32_bf16 v[156:159], a[232:235], a[180:183], 0
  v_mfma_f32_16x16x32_bf16 v[156:159], v[32:35], a[184:187], v[156:159]
  buffer_load_dwordx4 a[176:179], v2, s[8:11], s47 offen offset:1024 sc1
  v_mfma_f32_16x16x32_bf16 v[164:167], a[236:239], a[180:183], 0
  v_mfma_f32_16x16x32_bf16 v[164:167], v[40:43], a[184:187], v[164:167]
  s_waitcnt vmcnt(20)
  s_waitcnt lgkmcnt(0)
  s_barrier
  v_mfma_f32_16x16x32_bf16 a[84:87], a[224:227], a[188:191], 0
  ds_read_b128 v[172:175], v8
  s_add_u32 s46, s96, 0x1800
  s_mov_b32 s44, 0x1000
  v_mfma_f32_16x16x32_bf16 a[84:87], v[16:19], a[192:195], a[84:87]
  buffer_load_dwordx4 a[180:183], v2, s[8:11], s46 offen sc1
  v_mfma_f32_16x16x32_bf16 a[88:91], a[228:231], a[188:191], 0
  ds_read_b128 v[176:179], v8 offset:1024
  v_mfma_f32_16x16x32_bf16 a[88:91], v[24:27], a[192:195], a[88:91]
  ds_read_b128 v[180:183], v8 offset:2048
  v_mfma_f32_16x16x32_bf16 a[92:95], a[232:235], a[188:191], 0
  ds_read_b128 v[184:187], v8 offset:3072
  v_mfma_f32_16x16x32_bf16 a[92:95], v[32:35], a[192:195], a[92:95]
  buffer_load_dwordx4 a[184:187], v2, s[8:11], s46 offen offset:1024 sc1
  v_mfma_f32_16x16x32_bf16 a[96:99], a[236:239], a[188:191], 0
  ds_read_b128 v[188:191], v8 offset:4096
  v_mfma_f32_16x16x32_bf16 a[96:99], v[40:43], a[192:195], a[96:99]
  ds_read_b128 v[192:195], v8 offset:5120
  s_waitcnt vmcnt(20)
  v_mfma_f32_16x16x32_bf16 a[100:103], a[224:227], a[196:199], 0
  ds_read_b128 v[196:199], v8 offset:6144
  s_add_u32 s47, s97, 0x1800
  v_mfma_f32_16x16x32_bf16 a[100:103], v[16:19], a[200:203], a[100:103]
  buffer_load_dwordx4 a[188:191], v2, s[8:11], s47 offen sc1
  v_mfma_f32_16x16x32_bf16 a[104:107], a[228:231], a[196:199], 0
  ds_read_b128 v[200:203], v8 offset:7168
  v_mfma_f32_16x16x32_bf16 a[104:107], v[24:27], a[200:203], a[104:107]
  v_mfma_f32_16x16x32_bf16 a[108:111], a[232:235], a[196:199], 0
  v_mfma_f32_16x16x32_bf16 a[108:111], v[32:35], a[200:203], a[108:111]
  buffer_load_dwordx4 a[192:195], v2, s[8:11], s47 offen offset:1024 sc1
  v_mfma_f32_16x16x32_bf16 a[112:115], a[236:239], a[196:199], 0
  s_waitcnt lgkmcnt(4)
  v_mfma_f32_16x16x32_bf16 a[112:115], v[40:43], a[200:203], a[112:115]
  s_waitcnt vmcnt(20)
  v_add_f32 v108, v108, v172
  v_add_f32 v109, v109, v173
  v_add_f32 v110, v110, v174
  v_add_f32 v111, v111, v175
  v_mfma_f32_16x16x32_bf16 a[116:119], a[224:227], a[204:207], 0
  s_add_u32 s46, s98, 0x1800
  v_add_f32 v116, v116, v176
  v_add_f32 v117, v117, v177
  v_add_f32 v118, v118, v178
  v_add_f32 v119, v119, v179
  v_mfma_f32_16x16x32_bf16 a[116:119], v[16:19], a[208:211], a[116:119]
  buffer_load_dwordx4 a[196:199], v2, s[8:11], s46 offen sc1
  v_mfma_f32_16x16x32_bf16 a[120:123], a[228:231], a[204:207], 0
  v_add_f32 v124, v124, v180
  v_add_f32 v125, v125, v181
  v_add_f32 v126, v126, v182
  v_add_f32 v127, v127, v183
  v_mfma_f32_16x16x32_bf16 a[120:123], v[24:27], a[208:211], a[120:123]
  v_add_f32 v132, v132, v184
  v_add_f32 v133, v133, v185
  v_add_f32 v134, v134, v186
  v_add_f32 v135, v135, v187
  s_waitcnt lgkmcnt(0)
  v_mfma_f32_16x16x32_bf16 a[124:127], a[232:235], a[204:207], 0
  ds_read_b128 v[172:175], v8 offset:8192
  v_add_f32 v108, v108, v188
  v_add_f32 v109, v109, v189
  v_add_f32 v110, v110, v190
  v_add_f32 v111, v111, v191
  v_mfma_f32_16x16x32_bf16 a[124:127], v[32:35], a[208:211], a[124:127]
  buffer_load_dwordx4 a[200:203], v2, s[8:11], s46 offen offset:1024 sc1
  v_mfma_f32_16x16x32_bf16 a[128:131], a[236:239], a[204:207], 0
  ds_read_b128 v[176:179], v8 offset:9216
  v_add_f32 v116, v116, v192
  v_add_f32 v117, v117, v193
  v_add_f32 v118, v118, v194
  v_add_f32 v119, v119, v195
  v_mfma_f32_16x16x32_bf16 a[128:131], v[40:43], a[208:211], a[128:131]
  ds_read_b128 v[180:183], v8 offset:10240
  s_waitcnt vmcnt(20)
  v_add_f32 v124, v124, v196
  v_add_f32 v125, v125, v197
  v_add_f32 v126, v126, v198
  v_add_f32 v127, v127, v199
  v_mfma_f32_16x16x32_bf16 v[140:143], v[48:51], a[212:215], v[140:143]
  ds_read_b128 v[184:187], v8 offset:11264
  s_add_u32 s47, s99, 0x1800
  v_add_f32 v132, v132, v200
  v_add_f32 v133, v133, v201
  v_add_f32 v134, v134, v202
  v_add_f32 v135, v135, v203
  v_mfma_f32_16x16x32_bf16 v[140:143], v[80:83], a[216:219], v[140:143]
  buffer_load_dwordx4 a[204:207], v2, s[8:11], s47 offen sc1
  v_mfma_f32_16x16x32_bf16 v[148:151], v[56:59], a[212:215], v[148:151]
  ds_read_b128 v[204:207], v9
  v_mfma_f32_16x16x32_bf16 v[148:151], v[88:91], a[216:219], v[148:151]
  ds_read_b128 v[192:195], v9 offset:4096
  v_mfma_f32_16x16x32_bf16 v[156:159], v[64:67], a[212:215], v[156:159]
  ds_read_b128 v[196:199], v9 offset:8192
  v_mfma_f32_16x16x32_bf16 v[156:159], v[96:99], a[216:219], v[156:159]
  buffer_load_dwordx4 a[208:211], v2, s[8:11], s47 offen offset:1024 sc1
  v_mfma_f32_16x16x32_bf16 v[164:167], v[72:75], a[212:215], v[164:167]
  ds_read_b128 v[200:203], v9 offset:12288
  v_mfma_f32_16x16x32_bf16 v[164:167], v[104:107], a[216:219], v[164:167]
  s_waitcnt vmcnt(20)
  v_mfma_f32_16x16x32_bf16 a[84:87], v[48:51], a[220:223], a[84:87]
  s_add_u32 s46, s96, 0x2000
  v_mfma_f32_16x16x32_bf16 a[84:87], v[80:83], a[240:243], a[84:87]
  buffer_load_dwordx4 a[212:215], v2, s[8:11], s46 offen sc1
  v_mfma_f32_16x16x32_bf16 a[88:91], v[56:59], a[220:223], a[88:91]
  s_waitcnt lgkmcnt(4)
  v_mfma_f32_16x16x32_bf16 a[88:91], v[88:91], a[240:243], a[88:91]
  v_add_f32 v108, v108, v172
  v_add_f32 v109, v109, v173
  v_add_f32 v110, v110, v174
  v_add_f32 v111, v111, v175
  v_mfma_f32_16x16x32_bf16 a[92:95], v[64:67], a[220:223], a[92:95]
  v_add_f32 v116, v116, v176
  v_add_f32 v117, v117, v177
  v_add_f32 v118, v118, v178
  v_add_f32 v119, v119, v179
  v_mfma_f32_16x16x32_bf16 a[92:95], v[96:99], a[240:243], a[92:95]
  buffer_load_dwordx4 a[216:219], v2, s[8:11], s46 offen offset:1024 sc1
  v_mfma_f32_16x16x32_bf16 a[96:99], v[72:75], a[220:223], a[96:99]
  v_add_f32 v124, v124, v180
  v_add_f32 v125, v125, v181
  v_add_f32 v126, v126, v182
  v_add_f32 v127, v127, v183
  v_mfma_f32_16x16x32_bf16 a[96:99], v[104:107], a[240:243], a[96:99]
  s_waitcnt vmcnt(20)
  v_add_f32 v132, v132, v184
  v_add_f32 v133, v133, v185
  v_add_f32 v134, v134, v186
  v_add_f32 v135, v135, v187
  s_waitcnt lgkmcnt(0)
  v_mfma_f32_16x16x32_bf16 a[100:103], v[48:51], a[244:247], a[100:103]
  s_add_u32 s47, s97, 0x2000
  v_add_f32 v204, v204, v192
  v_add_f32 v205, v205, v193
  v_add_f32 v206, v206, v194
  v_add_f32 v207, v207, v195
  v_mfma_f32_16x16x32_bf16 a[100:103], v[80:83], a[248:251], a[100:103]
  buffer_load_dwordx4 a[220:223], v2, s[8:11], s47 offen sc1
  v_mfma_f32_16x16x32_bf16 a[104:107], v[56:59], a[244:247], a[104:107]
  v_add_f32 v204, v204, v196
  v_add_f32 v205, v205, v197
  v_add_f32 v206, v206, v198
  v_add_f32 v207, v207, v199
  v_mfma_f32_16x16x32_bf16 a[104:107], v[88:91], a[248:251], a[104:107]
  v_add_f32 v204, v204, v200
  v_add_f32 v205, v205, v201
  v_add_f32 v206, v206, v202
  v_add_f32 v207, v207, v203
  v_mfma_f32_16x16x32_bf16 a[108:111], v[64:67], a[244:247], a[108:111]
  v_mfma_f32_16x16x32_bf16 a[108:111], v[96:99], a[248:251], a[108:111]
  buffer_load_dwordx4 a[240:243], v2, s[8:11], s47 offen offset:1024 sc1
  v_mfma_f32_16x16x32_bf16 a[112:115], v[72:75], a[244:247], a[112:115]
  buffer_store_dwordx4 v[108:111], v12, s[12:15], 0 offen sc1
  v_mfma_f32_16x16x32_bf16 a[112:115], v[104:107], a[248:251], a[112:115]
  s_waitcnt vmcnt(21)
  v_mfma_f32_16x16x32_bf16 a[116:119], v[48:51], a[252:255], a[116:119]
  s_add_u32 s46, s98, 0x2000
  v_mfma_f32_16x16x32_bf16 a[116:119], v[80:83], v[244:247], a[116:119]
  buffer_load_dwordx4 a[244:247], v2, s[8:11], s46 offen sc1
  v_mfma_f32_16x16x32_bf16 a[120:123], v[56:59], a[252:255], a[120:123]
  buffer_store_dwordx4 v[116:119], v12, s[12:15], 0 offen offset:1024 sc1
  v_mfma_f32_16x16x32_bf16 a[120:123], v[88:91], v[244:247], a[120:123]
  v_mfma_f32_16x16x32_bf16 a[124:127], v[64:67], a[252:255], a[124:127]
  v_mfma_f32_16x16x32_bf16 a[124:127], v[96:99], v[244:247], a[124:127]
  buffer_load_dwordx4 a[248:251], v2, s[8:11], s46 offen offset:1024 sc1
  v_mfma_f32_16x16x32_bf16 a[128:131], v[72:75], a[252:255], a[128:131]
  buffer_store_dwordx4 v[124:127], v12, s[12:15], 0 offen offset:2048 sc1
  v_mfma_f32_16x16x32_bf16 a[128:131], v[104:107], v[244:247], a[128:131]
  s_waitcnt vmcnt(23)
  v_mfma_f32_16x16x32_bf16 v[140:143], v[112:115], a[148:151], v[140:143]
  s_add_u32 s47, s99, 0x2000
  v_mfma_f32_16x16x32_bf16 v[140:143], v[144:147], a[152:155], v[140:143]
  buffer_load_dwordx4 a[252:255], v2, s[8:11], s47 offen sc1
  v_mfma_f32_16x16x32_bf16 v[148:151], v[120:123], a[148:151], v[148:151]
  buffer_store_dwordx4 v[132:135], v12, s[12:15], 0 offen offset:3072 sc1
  v_mfma_f32_16x16x32_bf16 v[148:151], v[152:155], a[152:155], v[148:151]
  v_mfma_f32_16x16x32_bf16 v[156:159], v[128:131], a[148:151], v[156:159]
  v_mfma_f32_16x16x32_bf16 v[156:159], v[160:163], a[152:155], v[156:159]
  buffer_load_dwordx4 v[244:247], v2, s[8:11], s47 offen offset:1024 sc1
  v_mfma_f32_16x16x32_bf16 v[164:167], v[136:139], a[148:151], v[164:167]
  buffer_store_dwordx4 v[204:207], v12, s[12:15], s44 offen sc1
  v_mfma_f32_16x16x32_bf16 v[164:167], v[168:171], a[152:155], v[164:167]
  s_waitcnt vmcnt(25)
  v_mfma_f32_16x16x32_bf16 a[84:87], v[112:115], a[156:159], a[84:87]
  s_add_u32 s46, s96, 0x2800
  v_mfma_f32_16x16x32_bf16 a[84:87], v[144:147], a[160:163], a[84:87]
  buffer_load_dwordx4 a[148:151], v2, s[8:11], s46 offen sc1
  v_mfma_f32_16x16x32_bf16 a[88:91], v[120:123], a[156:159], a[88:91]
  v_mfma_f32_16x16x32_bf16 a[88:91], v[152:155], a[160:163], a[88:91]
  v_mfma_f32_16x16x32_bf16 a[92:95], v[128:131], a[156:159], a[92:95]
  v_mfma_f32_16x16x32_bf16 a[92:95], v[160:163], a[160:163], a[92:95]
  buffer_load_dwordx4 a[152:155], v2, s[8:11], s46 offen offset:1024 sc1
  v_mfma_f32_16x16x32_bf16 a[96:99], v[136:139], a[156:159], a[96:99]
  v_mfma_f32_16x16x32_bf16 a[96:99], v[168:171], a[160:163], a[96:99]
  s_waitcnt vmcnt(25)
  v_mfma_f32_16x16x32_bf16 a[100:103], v[112:115], a[164:167], a[100:103]
  s_add_u32 s47, s97, 0x2800
  v_mfma_f32_16x16x32_bf16 a[100:103], v[144:147], a[168:171], a[100:103]
  buffer_load_dwordx4 a[156:159], v2, s[8:11], s47 offen sc1
  v_mfma_f32_16x16x32_bf16 a[104:107], v[120:123], a[164:167], a[104:107]
  v_mfma_f32_16x16x32_bf16 a[104:107], v[152:155], a[168:171], a[104:107]
  v_mfma_f32_16x16x32_bf16 a[108:111], v[128:131], a[164:167], a[108:111]
  v_mfma_f32_16x16x32_bf16 a[108:111], v[160:163], a[168:171], a[108:111]
  buffer_load_dwordx4 a[160:163], v2, s[8:11], s47 offen offset:1024 sc1
  v_mfma_f32_16x16x32_bf16 a[112:115], v[136:139], a[164:167], a[112:115]
  v_mfma_f32_16x16x32_bf16 a[112:115], v[168:171], a[168:171], a[112:115]
  s_waitcnt vmcnt(25)
  v_mfma_f32_16x16x32_bf16 a[116:119], v[112:115], a[172:175], a[116:119]
  s_add_u32 s46, s98, 0x2800
  v_mfma_f32_16x16x32_bf16 a[116:119], v[144:147], a[176:179], a[116:119]
  buffer_load_dwordx4 a[164:167], v2, s[8:11], s46 offen sc1
  v_mfma_f32_16x16x32_bf16 a[120:123], v[120:123], a[172:175], a[120:123]
  v_mfma_f32_16x16x32_bf16 a[120:123], v[152:155], a[176:179], a[120:123]
  v_mfma_f32_16x16x32_bf16 a[124:127], v[128:131], a[172:175], a[124:127]
  v_mfma_f32_16x16x32_bf16 a[124:127], v[160:163], a[176:179], a[124:127]
  buffer_load_dwordx4 a[168:171], v2, s[8:11], s46 offen offset:1024 sc1
  v_mfma_f32_16x16x32_bf16 a[128:131], v[136:139], a[172:175], a[128:131]
  v_mfma_f32_16x16x32_bf16 a[128:131], v[168:171], a[176:179], a[128:131]
  s_waitcnt vmcnt(25)
  v_mfma_f32_16x16x32_bf16 v[140:143], v[208:211], a[180:183], v[140:143]
  s_add_u32 s47, s99, 0x2800
  v_mfma_f32_16x16x32_bf16 v[140:143], v[224:227], a[184:187], v[140:143]
  buffer_load_dwordx4 a[172:175], v2, s[8:11], s47 offen sc1
  v_mfma_f32_16x16x32_bf16 v[148:151], v[212:215], a[180:183], v[148:151]
  v_mfma_f32_16x16x32_bf16 v[148:151], v[228:231], a[184:187], v[148:151]
  v_mfma_f32_16x16x32_bf16 v[156:159], v[216:219], a[180:183], v[156:159]
  v_mfma_f32_16x16x32_bf16 v[156:159], v[232:235], a[184:187], v[156:159]
  buffer_load_dwordx4 a[176:179], v2, s[8:11], s47 offen offset:1024 sc1
  v_mfma_f32_16x16x32_bf16 v[164:167], v[220:223], a[180:183], v[164:167]
  v_mfma_f32_16x16x32_bf16 v[164:167], v[236:239], a[184:187], v[164:167]
  s_waitcnt vmcnt(25)
  v_mfma_f32_16x16x32_bf16 a[84:87], v[208:211], a[188:191], a[84:87]
  s_add_u32 s46, s96, 0x3000
  v_mfma_f32_16x16x32_bf16 a[84:87], v[224:227], a[192:195], a[84:87]
  buffer_load_dwordx4 a[180:183], v2, s[8:11], s46 offen sc1
  v_mfma_f32_16x16x32_bf16 a[88:91], v[212:215], a[188:191], a[88:91]
  v_mfma_f32_16x16x32_bf16 a[88:91], v[228:231], a[192:195], a[88:91]
  v_mfma_f32_16x16x32_bf16 a[92:95], v[216:219], a[188:191], a[92:95]
  v_mfma_f32_16x16x32_bf16 a[92:95], v[232:235], a[192:195], a[92:95]
  buffer_load_dwordx4 a[184:187], v2, s[8:11], s46 offen offset:1024 sc1
  v_mfma_f32_16x16x32_bf16 a[96:99], v[220:223], a[188:191], a[96:99]
  v_mfma_f32_16x16x32_bf16 a[96:99], v[236:239], a[192:195], a[96:99]
  s_waitcnt vmcnt(25)
  v_mfma_f32_16x16x32_bf16 a[100:103], v[208:211], a[196:199], a[100:103]
  s_add_u32 s47, s97, 0x3000
  v_mfma_f32_16x16x32_bf16 a[100:103], v[224:227], a[200:203], a[100:103]
  buffer_load_dwordx4 a[188:191], v2, s[8:11], s47 offen sc1
  v_mfma_f32_16x16x32_bf16 a[104:107], v[212:215], a[196:199], a[104:107]
  v_mfma_f32_16x16x32_bf16 a[104:107], v[228:231], a[200:203], a[104:107]
  v_mfma_f32_16x16x32_bf16 a[108:111], v[216:219], a[196:199], a[108:111]
  v_mfma_f32_16x16x32_bf16 a[108:111], v[232:235], a[200:203], a[108:111]
  buffer_load_dwordx4 a[192:195], v2, s[8:11], s47 offen offset:1024 sc1
  v_mfma_f32_16x16x32_bf16 a[112:115], v[220:223], a[196:199], a[112:115]
  v_mfma_f32_16x16x32_bf16 a[112:115], v[236:239], a[200:203], a[112:115]
  s_waitcnt vmcnt(25)
  v_mfma_f32_16x16x32_bf16 a[116:119], v[208:211], a[204:207], a[116:119]
  s_add_u32 s46, s98, 0x3000
  v_mfma_f32_16x16x32_bf16 a[116:119], v[224:227], a[208:211], a[116:119]
  buffer_load_dwordx4 a[196:199], v2, s[8:11], s46 offen sc1
  v_mfma_f32_16x16x32_bf16 a[120:123], v[212:215], a[204:207], a[120:123]
  v_mfma_f32_16x16x32_bf16 a[120:123], v[228:231], a[208:211], a[120:123]
  v_mfma_f32_16x16x32_bf16 a[124:127], v[216:219], a[204:207], a[124:127]
  v_mfma_f32_16x16x32_bf16 a[124:127], v[232:235], a[208:211], a[124:127]
  buffer_load_dwordx4 a[200:203], v2, s[8:11], s46 offen offset:1024 sc1
  v_mfma_f32_16x16x32_bf16 a[128:131], v[220:223], a[204:207], a[128:131]
  v_mfma_f32_16x16x32_bf16 a[128:131], v[236:239], a[208:211], a[128:131]
  s_waitcnt vmcnt(25)
  v_mfma_f32_16x16x32_bf16 v[140:143], v[20:23], a[212:215], v[140:143]
  s_add_u32 s47, s99, 0x3000
  v_mfma_f32_16x16x32_bf16 v[140:143], v[52:55], a[216:219], v[140:143]
  buffer_load_dwordx4 a[204:207], v2, s[8:11], s47 offen sc1
  v_mfma_f32_16x16x32_bf16 v[148:151], v[28:31], a[212:215], v[148:151]
  v_mfma_f32_16x16x32_bf16 v[148:151], v[60:63], a[216:219], v[148:151]
  v_mfma_f32_16x16x32_bf16 v[156:159], v[36:39], a[212:215], v[156:159]
  v_mfma_f32_16x16x32_bf16 v[156:159], v[68:71], a[216:219], v[156:159]
  buffer_load_dwordx4 a[208:211], v2, s[8:11], s47 offen offset:1024 sc1
  v_mfma_f32_16x16x32_bf16 v[164:167], v[44:47], a[212:215], v[164:167]
  v_mfma_f32_16x16x32_bf16 v[164:167], v[76:79], a[216:219], v[164:167]
  s_waitcnt vmcnt(25)
  s_add_u32 s42, s69, 0x100
  s_lshl_b32 s42, s42, 7
  s_add_u32 s42, s42, 0x1900000
  s_add_u32 s4, s62, s42
  s_addc_u32 s5, s63, 0
  s_mov_b32 s6, 4
  s_mov_b32 s7, 0x20000
  s_waitcnt vmcnt(16) lgkmcnt(0)
  s_barrier
  s_cmp_lg_u32 s3, 0
  s_cbranch_scc1 L_nf2
  buffer_store_dword v248, v0, s[4:7], 0 offen sc1
L_nf2:
  s_xor_b32 s42, s69, 1
  s_add_u32 s42, s42, 0x100
  s_lshl_b32 s42, s42, 7
  s_add_u32 s42, s42, 0x1900000
  s_add_u32 s4, s62, s42
  s_addc_u32 s5, s63, 0
  s_mov_b32 s6, 4
  s_mov_b32 s7, 0x20000
  buffer_load_dword v15, v0, s[4:7], 0 offen sc1
  v_mfma_f32_16x16x32_bf16 a[84:87], v[20:23], a[220:223], a[84:87]
  s_add_u32 s46, s97, 0x3800
  v_mfma_f32_16x16x32_bf16 a[84:87], v[52:55], a[240:243], a[84:87]
  buffer_load_dwordx4 a[212:215], v2, s[8:11], s46 offen sc1
  v_mfma_f32_16x16x32_bf16 a[88:91], v[28:31], a[220:223], a[88:91]
  v_mfma_f32_16x16x32_bf16 a[88:91], v[60:63], a[240:243], a[88:91]
  v_mfma_f32_16x16x32_bf16 a[92:95], v[36:39], a[220:223], a[92:95]
  v_mfma_f32_16x16x32_bf16 a[92:95], v[68:71], a[240:243], a[92:95]
  buffer_load_dwordx4 a[216:219], v2, s[8:11], s46 offen offset:1024 sc1
  v_mfma_f32_16x16x32_bf16 a[96:99], v[44:47], a[220:223], a[96:99]
  v_mfma_f32_16x16x32_bf16 a[96:99], v[76:79], a[240:243], a[96:99]
  s_waitcnt vmcnt(63)
  v_mfma_f32_16x16x32_bf16 a[100:103], v[20:23], a[244:247], a[100:103]
  s_add_u32 s47, s98, 0x3800
  v_mfma_f32_16x16x32_bf16 a[100:103], v[52:55], a[248:251], a[100:103]
  buffer_load_dwordx4 a[220:223], v2, s[8:11], s47 offen sc1
  v_mfma_f32_16x16x32_bf16 a[104:107], v[28:31], a[244:247], a[104:107]
  v_mfma_f32_16x16x32_bf16 a[104:107], v[60:63], a[248:251], a[104:107]
  v_mfma_f32_16x16x32_bf16 a[108:111], v[36:39], a[244:247], a[108:111]
  v_mfma_f32_16x16x32_bf16 a[108:111], v[68:71], a[248:251], a[108:111]
  buffer_load_dwordx4 a[240:243], v2, s[8:11], s47 offen offset:1024 sc1
  v_mfma_f32_16x16x32_bf16 a[112:115], v[44:47], a[244:247], a[112:115]
  v_mfma_f32_16x16x32_bf16 a[112:115], v[76:79], a[248:251], a[112:115]
  s_waitcnt vmcnt(63)
  v_mfma_f32_16x16x32_bf16 a[116:119], v[20:23], a[252:255], a[116:119]
  s_add_u32 s46, s99, 0x3800
  v_mfma_f32_16x16x32_bf16 a[116:119], v[52:55], v[244:247], a[116:119]
  buffer_load_dwordx4 a[244:247], v2, s[8:11], s46 offen sc1
  v_mfma_f32_16x16x32_bf16 a[120:123], v[28:31], a[252:255], a[120:123]
  v_mfma_f32_16x16x32_bf16 a[120:123], v[60:63], v[244:247], a[120:123]
  v_mfma_f32_16x16x32_bf16 a[124:127], v[36:39], a[252:255], a[124:127]
  v_mfma_f32_16x16x32_bf16 a[124:127], v[68:71], v[244:247], a[124:127]
  buffer_load_dwordx4 a[248:251], v2, s[8:11], s46 offen offset:1024 sc1
  v_mfma_f32_16x16x32_bf16 a[128:131], v[44:47], a[252:255], a[128:131]
  v_mfma_f32_16x16x32_bf16 a[128:131], v[76:79], v[244:247], a[128:131]
  s_waitcnt vmcnt(21)
  v_mfma_f32_16x16x32_bf16 v[140:143], v[84:87], a[148:151], v[140:143]
  s_add_u32 s47, s96, 0x3800
  v_mfma_f32_16x16x32_bf16 v[140:143], a[4:7], a[152:155], v[140:143]
  buffer_load_dwordx4 a[252:255], v2, s[8:11], s47 offen sc1
  v_mfma_f32_16x16x32_bf16 v[148:151], v[92:95], a[148:151], v[148:151]
  v_mfma_f32_16x16x32_bf16 v[148:151], a[8:11], a[152:155], v[148:151]
  v_mfma_f32_16x16x32_bf16 v[156:159], v[100:103], a[148:151], v[156:159]
  v_mfma_f32_16x16x32_bf16 v[156:159], a[12:15], a[152:155], v[156:159]
  buffer_load_dwordx4 v[244:247], v2, s[8:11], s47 offen offset:1024 sc1
  v_mfma_f32_16x16x32_bf16 v[164:167], a[0:3], a[148:151], v[164:167]
  v_mfma_f32_16x16x32_bf16 v[164:167], a[16:19], a[152:155], v[164:167]
  s_waitcnt vmcnt(21)
  v_mfma_f32_16x16x32_bf16 a[84:87], v[84:87], a[156:159], a[84:87]
  v_mfma_f32_16x16x32_bf16 a[84:87], a[4:7], a[160:163], a[84:87]
  v_mfma_f32_16x16x32_bf16 a[88:91], v[92:95], a[156:159], a[88:91]
  v_mfma_f32_16x16x32_bf16 a[88:91], a[8:11], a[160:163], a[88:91]
  v_mfma_f32_16x16x32_bf16 a[92:95], v[100:103], a[156:159], a[92:95]
  v_mfma_f32_16x16x32_bf16 a[92:95], a[12:15], a[160:163], a[92:95]
  v_mfma_f32_16x16x32_bf16 a[96:99], a[0:3], a[156:159], a[96:99]
  v_mfma_f32_16x16x32_bf16 a[96:99], a[16:19], a[160:163], a[96:99]
  s_waitcnt vmcnt(19)
  v_mfma_f32_16x16x32_bf16 a[100:103], v[84:87], a[164:167], a[100:103]
  v_add_u32 v4, 0x10000, v4
  v_add_u32 v5, 0x10000, v5
  v_add_u32 v6, 0x10000, v6
  v_add_u32 v8, 0x10000, v8
  v_mfma_f32_16x16x32_bf16 a[100:103], a[4:7], a[168:171], a[100:103]
  v_mfma_f32_16x16x32_bf16 a[104:107], v[92:95], a[164:167], a[104:107]
  v_mfma_f32_16x16x32_bf16 a[104:107], a[8:11], a[168:171], a[104:107]
  v_mfma_f32_16x16x32_bf16 a[108:111], v[100:103], a[164:167], a[108:111]
  v_mfma_f32_16x16x32_bf16 a[108:111], a[12:15], a[168:171], a[108:111]
  v_mfma_f32_16x16x32_bf16 a[112:115], a[0:3], a[164:167], a[112:115]
  v_mfma_f32_16x16x32_bf16 a[112:115], a[16:19], a[168:171], a[112:115]
  s_waitcnt vmcnt(17)
  v_mfma_f32_16x16x32_bf16 a[116:119], v[84:87], a[172:175], a[116:119]
  v_mfma_f32_16x16x32_bf16 a[116:119], a[4:7], a[176:179], a[116:119]
  v_mfma_f32_16x16x32_bf16 a[120:123], v[92:95], a[172:175], a[120:123]
  v_mfma_f32_16x16x32_bf16 a[120:123], a[8:11], a[176:179], a[120:123]
  v_mfma_f32_16x16x32_bf16 a[124:127], v[100:103], a[172:175], a[124:127]
  v_mfma_f32_16x16x32_bf16 a[124:127], a[12:15], a[176:179], a[124:127]
  v_mfma_f32_16x16x32_bf16 a[128:131], a[0:3], a[172:175], a[128:131]
  v_mfma_f32_16x16x32_bf16 a[128:131], a[16:19], a[176:179], a[128:131]
  s_waitcnt vmcnt(15)
  s_waitcnt vmcnt(8)
  v_cmp_ne_u32 vcc, 0, v15
  s_nop 0
  s_cmp_eq_u32 vcc_lo, 1
  s_cbranch_scc1 L_xt_ok
L_xt_spin:
  s_sleep 2
  buffer_load_dword v15, v0, s[4:7], 0 offen sc1
  s_waitcnt vmcnt(0)
  v_cmp_ne_u32 vcc, 0, v15
  s_nop 0
  s_cmp_eq_u32 vcc_lo, 1
  s_cbranch_scc0 L_xt_spin
L_xt_ok:
  buffer_load_dwordx4 v[108:111], v12, s[16:19], 0 offen sc1
  buffer_load_dwordx4 v[116:119], v12, s[16:19], 0 offen offset:1024 sc1
  buffer_load_dwordx4 v[124:127], v12, s[16:19], 0 offen offset:2048 sc1
  buffer_load_dwordx4 v[132:135], v12, s[16:19], 0 offen offset:3072 sc1
  buffer_load_dwordx4 v[240:243], v12, s[16:19], s44 offen sc1
  v_mfma_f32_16x16x32_bf16 v[140:143], a[20:23], a[180:183], v[140:143]
  v_mfma_f32_16x16x32_bf16 v[140:143], a[36:39], a[184:187], v[140:143]
  v_mfma_f32_16x16x32_bf16 v[148:151], a[24:27], a[180:183], v[148:151]
  v_mfma_f32_16x16x32_bf16 v[148:151], a[40:43], a[184:187], v[148:151]
  v_mfma_f32_16x16x32_bf16 v[156:159], a[28:31], a[180:183], v[156:159]
  v_mfma_f32_16x16x32_bf16 v[156:159], a[44:47], a[184:187], v[156:159]
  v_mfma_f32_16x16x32_bf16 v[164:167], a[32:35], a[180:183], v[164:167]
  v_mfma_f32_16x16x32_bf16 v[164:167], a[48:51], a[184:187], v[164:167]
  s_waitcnt vmcnt(63)
  v_mfma_f32_16x16x32_bf16 a[84:87], a[20:23], a[188:191], a[84:87]
  v_mfma_f32_16x16x32_bf16 a[84:87], a[36:39], a[192:195], a[84:87]
  v_mfma_f32_16x16x32_bf16 a[88:91], a[24:27], a[188:191], a[88:91]
  v_mfma_f32_16x16x32_bf16 a[88:91], a[40:43], a[192:195], a[88:91]
  v_mfma_f32_16x16x32_bf16 a[92:95], a[28:31], a[188:191], a[92:95]
  v_mfma_f32_16x16x32_bf16 a[92:95], a[44:47], a[192:195], a[92:95]
  v_mfma_f32_16x16x32_bf16 a[96:99], a[32:35], a[188:191], a[96:99]
  v_mfma_f32_16x16x32_bf16 a[96:99], a[48:51], a[192:195], a[96:99]
  s_waitcnt vmcnt(63)
  v_mfma_f32_16x16x32_bf16 a[100:103], a[20:23], a[196:199], a[100:103]
  v_mfma_f32_16x16x32_bf16 a[100:103], a[36:39], a[200:203], a[100:103]
  v_mfma_f32_16x16x32_bf16 a[104:107], a[24:27], a[196:199], a[104:107]
  v_mfma_f32_16x16x32_bf16 a[104:107], a[40:43], a[200:203], a[104:107]
  v_mfma_f32_16x16x32_bf16 a[108:111], a[28:31], a[196:199], a[108:111]
  v_mfma_f32_16x16x32_bf16 a[108:111], a[44:47], a[200:203], a[108:111]
  v_mfma_f32_16x16x32_bf16 a[112:115], a[32:35], a[196:199], a[112:115]
  v_mfma_f32_16x16x32_bf16 a[112:115], a[48:51], a[200:203], a[112:115]
  s_waitcnt vmcnt(63)
  v_mfma_f32_16x16x32_bf16 a[116:119], a[20:23], a[204:207], a[116:119]
  v_mfma_f32_16x16x32_bf16 a[116:119], a[36:39], a[208:211], a[116:119]
  v_mfma_f32_16x16x32_bf16 a[120:123], a[24:27], a[204:207], a[120:123]
  v_mfma_f32_16x16x32_bf16 a[120:123], a[40:43], a[208:211], a[120:123]
  v_mfma_f32_16x16x32_bf16 a[124:127], a[28:31], a[204:207], a[124:127]
  v_mfma_f32_16x16x32_bf16 a[124:127], a[44:47], a[208:211], a[124:127]
  v_mfma_f32_16x16x32_bf16 a[128:131], a[32:35], a[204:207], a[128:131]
  v_mfma_f32_16x16x32_bf16 a[128:131], a[48:51], a[208:211], a[128:131]
  s_waitcnt vmcnt(11)
  v_mfma_f32_16x16x32_bf16 a[84:87], a[52:55], a[212:215], a[84:87]
  v_mfma_f32_16x16x32_bf16 a[84:87], a[68:71], a[216:219], a[84:87]
  v_mfma_f32_16x16x32_bf16 a[88:91], a[56:59], a[212:215], a[88:91]
  v_mfma_f32_16x16x32_bf16 a[88:91], a[72:75], a[216:219], a[88:91]
  v_mfma_f32_16x16x32_bf16 a[92:95], a[60:63], a[212:215], a[92:95]
  v_mfma_f32_16x16x32_bf16 a[92:95], a[76:79], a[216:219], a[92:95]
  v_mfma_f32_16x16x32_bf16 a[96:99], a[64:67], a[212:215], a[96:99]
  v_mfma_f32_16x16x32_bf16 a[96:99], a[80:83], a[216:219], a[96:99]
  s_waitcnt vmcnt(9)
  v_mfma_f32_16x16x32_bf16 a[100:103], a[52:55], a[220:223], a[100:103]
  v_mfma_f32_16x16x32_bf16 a[100:103], a[68:71], a[240:243], a[100:103]
  ds_write_b128 v4, a[84:87]
  v_mfma_f32_16x16x32_bf16 a[104:107], a[56:59], a[220:223], a[104:107]
  v_mfma_f32_16x16x32_bf16 a[104:107], a[72:75], a[240:243], a[104:107]
  ds_write_b128 v4, a[88:91] offset:1024
  v_mfma_f32_16x16x32_bf16 a[108:111], a[60:63], a[220:223], a[108:111]
  v_mfma_f32_16x16x32_bf16 a[108:111], a[76:79], a[240:243], a[108:111]
  ds_write_b128 v4, a[92:95] offset:2048
  v_mfma_f32_16x16x32_bf16 a[112:115], a[64:67], a[220:223], a[112:115]
  v_mfma_f32_16x16x32_bf16 a[112:115], a[80:83], a[240:243], a[112:115]
  ds_write_b128 v4, a[96:99] offset:3072
  s_waitcnt vmcnt(7)
  v_mfma_f32_16x16x32_bf16 a[116:119], a[52:55], a[244:247], a[116:119]
  v_mfma_f32_16x16x32_bf16 a[116:119], a[68:71], a[248:251], a[116:119]
  ds_write_b128 v5, a[100:103]
  v_mfma_f32_16x16x32_bf16 a[120:123], a[56:59], a[244:247], a[120:123]
  v_mfma_f32_16x16x32_bf16 a[120:123], a[72:75], a[248:251], a[120:123]
  ds_write_b128 v5, a[104:107] offset:1024
  v_mfma_f32_16x16x32_bf16 a[124:127], a[60:63], a[244:247], a[124:127]
  v_mfma_f32_16x16x32_bf16 a[124:127], a[76:79], a[248:251], a[124:127]
  ds_write_b128 v5, a[108:111] offset:2048
  v_mfma_f32_16x16x32_bf16 a[128:131], a[64:67], a[244:247], a[128:131]
  v_mfma_f32_16x16x32_bf16 a[128:131], a[80:83], a[248:251], a[128:131]
  ds_write_b128 v5, a[112:115] offset:3072
  s_waitcnt vmcnt(5)
  v_mfma_f32_16x16x32_bf16 v[140:143], a[52:55], a[252:255], v[140:143]
  v_mfma_f32_16x16x32_bf16 v[140:143], a[68:71], v[244:247], v[140:143]
  ds_write_b128 v6, a[116:119]
  v_mfma_f32_16x16x32_bf16 v[148:151], a[56:59], a[252:255], v[148:151]
  v_mfma_f32_16x16x32_bf16 v[148:151], a[72:75], v[244:247], v[148:151]
  ds_write_b128 v6, a[120:123] offset:1024
  v_mfma_f32_16x16x32_bf16 v[156:159], a[60:63], a[252:255], v[156:159]
  v_mfma_f32_16x16x32_bf16 v[156:159], a[76:79], v[244:247], v[156:159]
  ds_write_b128 v6, a[124:127] offset:2048
  v_mfma_f32_16x16x32_bf16 v[164:167], a[64:67], a[252:255], v[164:167]
  v_mfma_f32_16x16x32_bf16 v[164:167], a[80:83], v[244:247], v[164:167]
  ds_write_b128 v6, a[128:131] offset:3072
  s_waitcnt lgkmcnt(0)
  s_barrier
  ds_read_b128 v[16:19], v8
  ds_read_b128 v[24:27], v8 offset:1024
  ds_read_b128 v[32:35], v8 offset:2048
  ds_read_b128 v[40:43], v8 offset:3072
  ds_read_b128 v[48:51], v8 offset:4096
  ds_read_b128 v[56:59], v8 offset:5120
  ds_read_b128 v[64:67], v8 offset:6144
  ds_read_b128 v[72:75], v8 offset:7168
  ds_read_b128 v[80:83], v8 offset:8192
  ds_read_b128 v[88:91], v8 offset:9216
  ds_read_b128 v[96:99], v8 offset:10240
  ds_read_b128 v[104:107], v8 offset:11264
  s_waitcnt lgkmcnt(11)
  v_pk_add_f32 v[140:141], v[140:141], v[16:17]
  v_pk_add_f32 v[142:143], v[142:143], v[18:19]
  s_waitcnt lgkmcnt(10)
  v_pk_add_f32 v[148:149], v[148:149], v[24:25]
  v_pk_add_f32 v[150:151], v[150:151], v[26:27]
  s_waitcnt lgkmcnt(9)
  v_pk_add_f32 v[156:157], v[156:157], v[32:33]
  v_pk_add_f32 v[158:159], v[158:159], v[34:35]
  s_waitcnt lgkmcnt(8)
  v_pk_add_f32 v[164:165], v[164:165], v[40:41]
  v_pk_add_f32 v[166:167], v[166:167], v[42:43]
  s_waitcnt lgkmcnt(7)
  v_pk_add_f32 v[140:141], v[140:141], v[48:49]
  v_pk_add_f32 v[142:143], v[142:143], v[50:51]
  s_waitcnt lgkmcnt(6)
  v_pk_add_f32 v[148:149], v[148:149], v[56:57]
  v_pk_add_f32 v[150:151], v[150:151], v[58:59]
  s_waitcnt lgkmcnt(5)
  v_pk_add_f32 v[156:157], v[156:157], v[64:65]
  v_pk_add_f32 v[158:159], v[158:159], v[66:67]
  s_waitcnt lgkmcnt(4)
  v_pk_add_f32 v[164:165], v[164:165], v[72:73]
  v_pk_add_f32 v[166:167], v[166:167], v[74:75]
  s_waitcnt lgkmcnt(3)
  v_pk_add_f32 v[140:141], v[140:141], v[80:81]
  v_pk_add_f32 v[142:143], v[142:143], v[82:83]
  s_waitcnt lgkmcnt(2)
  v_pk_add_f32 v[148:149], v[148:149], v[88:89]
  v_pk_add_f32 v[150:151], v[150:151], v[90:91]
  s_waitcnt lgkmcnt(1)
  v_pk_add_f32 v[156:157], v[156:157], v[96:97]
  v_pk_add_f32 v[158:159], v[158:159], v[98:99]
  s_waitcnt lgkmcnt(0)
  v_pk_add_f32 v[164:165], v[164:165], v[104:105]
  v_pk_add_f32 v[166:167], v[166:167], v[106:107]
  s_waitcnt vmcnt(0)
  v_pk_add_f32 v[140:141], v[140:141], v[108:109]
  v_pk_add_f32 v[142:143], v[142:143], v[110:111]
  v_pk_add_f32 v[148:149], v[148:149], v[116:117]
  v_pk_add_f32 v[150:151], v[150:151], v[118:119]
  v_pk_add_f32 v[156:157], v[156:157], v[124:125]
  v_pk_add_f32 v[158:159], v[158:159], v[126:127]
  v_pk_add_f32 v[164:165], v[164:165], v[132:133]
  v_pk_add_f32 v[166:167], v[166:167], v[134:135]
  v_cvt_pk_bf16_f32 v140, v140, v141
  v_cvt_pk_bf16_f32 v141, v142, v143
  buffer_store_dwordx2 v[140:141], v10, s[32:35], 0 offen
  v_cvt_pk_bf16_f32 v148, v148, v149
  v_cvt_pk_bf16_f32 v149, v150, v151
  buffer_store_dwordx2 v[148:149], v10, s[32:35], 0 offen offset:32
  v_cvt_pk_bf16_f32 v156, v156, v157
  v_cvt_pk_bf16_f32 v157, v158, v159
  buffer_store_dwordx2 v[156:157], v10, s[32:35], 0 offen offset:64
  v_cvt_pk_bf16_f32 v164, v164, v165
  v_cvt_pk_bf16_f32 v165, v166, v167
  buffer_store_dwordx2 v[164:165], v10, s[32:35], 0 offen offset:96
  v_pk_add_f32 v[204:205], v[204:205], v[240:241]
  v_pk_add_f32 v[206:207], v[206:207], v[242:243]
  v_cvt_pk_bf16_f32 v204, v204, v205
  v_cvt_pk_bf16_f32 v205, v206, v207
  buffer_store_dwordx2 v[204:205], v11, s[32:35], 0 offen
L_exit:
  s_endpgm
L_cx1:
  ds_write_b128 v250, a[128:131]
  ds_write_b128 v250, a[132:135] offset:1024
  ds_write_b128 v250, a[136:139] offset:2048
  ds_write_b128 v250, a[140:143] offset:3072
  v_accvgpr_mov_b32 a128, a144
  v_accvgpr_mov_b32 a129, a145
  v_accvgpr_mov_b32 a130, a146
  v_accvgpr_mov_b32 a131, a147
  v_accvgpr_mov_b32 a132, a148
  v_accvgpr_mov_b32 a133, a149
  v_accvgpr_mov_b32 a134, a150
  v_accvgpr_mov_b32 a135, a151
  v_accvgpr_mov_b32 a136, a152
  v_accvgpr_mov_b32 a137, a153
  v_accvgpr_mov_b32 a138, a154
  v_accvgpr_mov_b32 a139, a155
  v_accvgpr_mov_b32 a140, a156
  v_accvgpr_mov_b32 a141, a157
  v_accvgpr_mov_b32 a142, a158
  v_accvgpr_mov_b32 a143, a159
  s_branch L_cx1r
L_fail:
  s_waitcnt vmcnt(0) lgkmcnt(0)
  s_barrier
  s_mov_b32 s39, 1
  s_branch L_restart
L_safe:
  v_mov_b32 v242, 0xff800000
  v_mov_b32 v243, 0xff800000
  v_mov_b32 v244, 0xff800000
  v_mov_b32 v245, 0xff800000
  v_mov_b32 v246, 0xff800000
  s_mov_b32 s72, 0
  s_mov_b32 s71, 16
L_sf1:
  s_waitcnt vmcnt(0) lgkmcnt(0)
  s_barrier
  s_mov_b32 m0, s75
  s_nop 0
  buffer_load_dwordx4 v7, s[12:15], s72 offen nt lds
  buffer_load_dwordx4 v7, s[12:15], s72 offen offset:1024 nt lds
  buffer_load_dwordx4 v8, s[12:15], s72 offen offset:2048 nt lds
  buffer_load_dwordx4 v8, s[12:15], s72 offen offset:3072 nt lds
  s_add_u32 s72, s72, 0x4000
  s_waitcnt vmcnt(0)
  s_barrier
  ds_read_b128 a[160:163], v1
  ds_read_b128 a[164:167], v1 offset:256
  ds_read_b128 a[168:171], v240
  ds_read_b128 a[172:175], v240 offset:256
  s_waitcnt lgkmcnt(0)
  v_mfma_f32_16x16x32_bf16 v[176:179], a[160:163], v[16:19], 0
  v_mfma_f32_16x16x32_bf16 v[176:179], a[164:167], v[24:27], v[176:179]
  v_mfma_f32_16x16x32_bf16 v[176:179], a[168:171], v[32:35], v[176:179]
  v_mfma_f32_16x16x32_bf16 v[176:179], a[172:175], v[40:43], v[176:179]
  v_mfma_f32_16x16x32_bf16 v[180:183], a[160:163], v[48:51], 0
  v_mfma_f32_16x16x32_bf16 v[180:183], a[164:167], v[56:59], v[180:183]
  v_mfma_f32_16x16x32_bf16 v[180:183], a[168:171], v[64:67], v[180:183]
  v_mfma_f32_16x16x32_bf16 v[180:183], a[172:175], v[72:75], v[180:183]
  v_mfma_f32_16x16x32_bf16 v[184:187], a[160:163], v[80:83], 0
  v_mfma_f32_16x16x32_bf16 v[184:187], a[164:167], v[88:91], v[184:187]
  v_mfma_f32_16x16x32_bf16 v[184:187], a[168:171], v[96:99], v[184:187]
  v_mfma_f32_16x16x32_bf16 v[184:187], a[172:175], v[104:107], v[184:187]
  v_mfma_f32_16x16x32_bf16 v[188:191], a[160:163], v[112:115], 0
  v_mfma_f32_16x16x32_bf16 v[188:191], a[164:167], v[120:123], v[188:191]
  v_mfma_f32_16x16x32_bf16 v[188:191], a[168:171], v[128:131], v[188:191]
  v_mfma_f32_16x16x32_bf16 v[188:191], a[172:175], v[136:139], v[188:191]
  v_mfma_f32_16x16x32_bf16 v[192:195], a[160:163], v[144:147], 0
  v_mfma_f32_16x16x32_bf16 v[192:195], a[164:167], v[152:155], v[192:195]
  v_mfma_f32_16x16x32_bf16 v[192:195], a[168:171], v[160:163], v[192:195]
  v_mfma_f32_16x16x32_bf16 v[192:195], a[172:175], v[168:171], v[192:195]
  ds_read_b128 a[176:179], v1 offset:4096
  ds_read_b128 a[180:183], v1 offset:4352
  ds_read_b128 a[184:187], v240 offset:4096
  ds_read_b128 a[188:191], v240 offset:4352
  s_waitcnt lgkmcnt(0)
  v_mfma_f32_16x16x32_bf16 v[196:199], a[176:179], v[16:19], 0
  v_mfma_f32_16x16x32_bf16 v[196:199], a[180:183], v[24:27], v[196:199]
  v_mfma_f32_16x16x32_bf16 v[196:199], a[184:187], v[32:35], v[196:199]
  v_mfma_f32_16x16x32_bf16 v[196:199], a[188:191], v[40:43], v[196:199]
  v_mfma_f32_16x16x32_bf16 v[200:203], a[176:179], v[48:51], 0
  v_mfma_f32_16x16x32_bf16 v[200:203], a[180:183], v[56:59], v[200:203]
  v_mfma_f32_16x16x32_bf16 v[200:203], a[184:187], v[64:67], v[200:203]
  v_mfma_f32_16x16x32_bf16 v[200:203], a[188:191], v[72:75], v[200:203]
  v_mfma_f32_16x16x32_bf16 v[204:207], a[176:179], v[80:83], 0
  v_mfma_f32_16x16x32_bf16 v[204:207], a[180:183], v[88:91], v[204:207]
  v_mfma_f32_16x16x32_bf16 v[204:207], a[184:187], v[96:99], v[204:207]
  v_mfma_f32_16x16x32_bf16 v[204:207], a[188:191], v[104:107], v[204:207]
  v_mfma_f32_16x16x32_bf16 v[208:211], a[176:179], v[112:115], 0
  v_mfma_f32_16x16x32_bf16 v[208:211], a[180:183], v[120:123], v[208:211]
  v_mfma_f32_16x16x32_bf16 v[208:211], a[184:187], v[128:131], v[208:211]
  v_mfma_f32_16x16x32_bf16 v[208:211], a[188:191], v[136:139], v[208:211]
  v_mfma_f32_16x16x32_bf16 v[212:215], a[176:179], v[144:147], 0
  v_mfma_f32_16x16x32_bf16 v[212:215], a[180:183], v[152:155], v[212:215]
  v_mfma_f32_16x16x32_bf16 v[212:215], a[184:187], v[160:163], v[212:215]
  v_mfma_f32_16x16x32_bf16 v[212:215], a[188:191], v[168:171], v[212:215]
  ds_read_b128 a[160:163], v2
  ds_read_b128 a[164:167], v2 offset:256
  ds_read_b128 a[168:171], v241
  ds_read_b128 a[172:175], v241 offset:256
  s_waitcnt lgkmcnt(0)
  v_mfma_f32_16x16x32_bf16 v[216:219], a[160:163], v[16:19], 0
  v_mfma_f32_16x16x32_bf16 v[216:219], a[164:167], v[24:27], v[216:219]
  v_mfma_f32_16x16x32_bf16 v[216:219], a[168:171], v[32:35], v[216:219]
  v_mfma_f32_16x16x32_bf16 v[216:219], a[172:175], v[40:43], v[216:219]
  v_mfma_f32_16x16x32_bf16 v[220:223], a[160:163], v[48:51], 0
  v_mfma_f32_16x16x32_bf16 v[220:223], a[164:167], v[56:59], v[220:223]
  v_mfma_f32_16x16x32_bf16 v[220:223], a[168:171], v[64:67], v[220:223]
  v_mfma_f32_16x16x32_bf16 v[220:223], a[172:175], v[72:75], v[220:223]
  v_mfma_f32_16x16x32_bf16 v[224:227], a[160:163], v[80:83], 0
  v_mfma_f32_16x16x32_bf16 v[224:227], a[164:167], v[88:91], v[224:227]
  v_mfma_f32_16x16x32_bf16 v[224:227], a[168:171], v[96:99], v[224:227]
  v_mfma_f32_16x16x32_bf16 v[224:227], a[172:175], v[104:107], v[224:227]
  v_mfma_f32_16x16x32_bf16 v[228:231], a[160:163], v[112:115], 0
  v_mfma_f32_16x16x32_bf16 v[228:231], a[164:167], v[120:123], v[228:231]
  v_mfma_f32_16x16x32_bf16 v[228:231], a[168:171], v[128:131], v[228:231]
  v_mfma_f32_16x16x32_bf16 v[228:231], a[172:175], v[136:139], v[228:231]
  ds_read_b128 a[176:179], v2 offset:4096
  ds_read_b128 a[180:183], v2 offset:4352
  ds_read_b128 a[184:187], v241 offset:4096
  ds_read_b128 a[188:191], v241 offset:4352
  s_waitcnt lgkmcnt(0)
  v_mfma_f32_16x16x32_bf16 v[232:235], a[176:179], v[16:19], 0
  v_mfma_f32_16x16x32_bf16 v[232:235], a[180:183], v[24:27], v[232:235]
  v_mfma_f32_16x16x32_bf16 v[232:235], a[184:187], v[32:35], v[232:235]
  v_mfma_f32_16x16x32_bf16 v[232:235], a[188:191], v[40:43], v[232:235]
  v_mfma_f32_16x16x32_bf16 v[236:239], a[176:179], v[48:51], 0
  v_mfma_f32_16x16x32_bf16 v[236:239], a[180:183], v[56:59], v[236:239]
  v_mfma_f32_16x16x32_bf16 v[236:239], a[184:187], v[64:67], v[236:239]
  v_mfma_f32_16x16x32_bf16 v[236:239], a[188:191], v[72:75], v[236:239]
  v_mfma_f32_16x16x32_bf16 v[20:23], a[176:179], v[80:83], 0
  v_mfma_f32_16x16x32_bf16 v[20:23], a[180:183], v[88:91], v[20:23]
  v_mfma_f32_16x16x32_bf16 v[20:23], a[184:187], v[96:99], v[20:23]
  v_mfma_f32_16x16x32_bf16 v[20:23], a[188:191], v[104:107], v[20:23]
  v_mfma_f32_16x16x32_bf16 v[28:31], a[176:179], v[112:115], 0
  v_mfma_f32_16x16x32_bf16 v[28:31], a[180:183], v[120:123], v[28:31]
  v_mfma_f32_16x16x32_bf16 v[28:31], a[184:187], v[128:131], v[28:31]
  v_mfma_f32_16x16x32_bf16 v[28:31], a[188:191], v[136:139], v[28:31]
  s_nop 7
  v_max3_f32 v242, v242, v176, v177
  v_max3_f32 v242, v242, v178, v179
  v_max3_f32 v243, v243, v180, v181
  v_max3_f32 v243, v243, v182, v183
  v_max3_f32 v244, v244, v184, v185
  v_max3_f32 v244, v244, v186, v187
  v_max3_f32 v245, v245, v188, v189
  v_max3_f32 v245, v245, v190, v191
  v_max3_f32 v246, v246, v192, v193
  v_max3_f32 v246, v246, v194, v195
  v_max3_f32 v242, v242, v196, v197
  v_max3_f32 v242, v242, v198, v199
  v_max3_f32 v243, v243, v200, v201
  v_max3_f32 v243, v243, v202, v203
  v_max3_f32 v244, v244, v204, v205
  v_max3_f32 v244, v244, v206, v207
  v_max3_f32 v245, v245, v208, v209
  v_max3_f32 v245, v245, v210, v211
  v_max3_f32 v246, v246, v212, v213
  v_max3_f32 v246, v246, v214, v215
  v_max3_f32 v242, v242, v216, v217
  v_max3_f32 v242, v242, v218, v219
  v_max3_f32 v243, v243, v220, v221
  v_max3_f32 v243, v243, v222, v223
  v_max3_f32 v244, v244, v224, v225
  v_max3_f32 v244, v244, v226, v227
  v_max3_f32 v245, v245, v228, v229
  v_max3_f32 v245, v245, v230, v231
  v_max3_f32 v242, v242, v232, v233
  v_max3_f32 v242, v242, v234, v235
  v_max3_f32 v243, v243, v236, v237
  v_max3_f32 v243, v243, v238, v239
  v_max3_f32 v244, v244, v20, v21
  v_max3_f32 v244, v244, v22, v23
  v_max3_f32 v245, v245, v28, v29
  v_max3_f32 v245, v245, v30, v31
  s_sub_u32 s71, s71, 1
  s_cmp_lg_u32 s71, 0
  s_cbranch_scc1 L_sf1
  v_mov_b32 v249, v242
  s_nop 1
  v_permlane32_swap_b32 v242, v249
  v_max_f32 v242, v242, v249
  v_mov_b32 v249, v242
  s_nop 1
  v_permlane16_swap_b32 v242, v249
  v_max_f32 v242, v242, v249
  v_mov_b32 v249, v243
  s_nop 1
  v_permlane32_swap_b32 v243, v249
  v_max_f32 v243, v243, v249
  v_mov_b32 v249, v243
  s_nop 1
  v_permlane16_swap_b32 v243, v249
  v_max_f32 v243, v243, v249
  v_mov_b32 v249, v244
  s_nop 1
  v_permlane32_swap_b32 v244, v249
  v_max_f32 v244, v244, v249
  v_mov_b32 v249, v244
  s_nop 1
  v_permlane16_swap_b32 v244, v249
  v_max_f32 v244, v244, v249
  v_mov_b32 v249, v245
  s_nop 1
  v_permlane32_swap_b32 v245, v249
  v_max_f32 v245, v245, v249
  v_mov_b32 v249, v245
  s_nop 1
  v_permlane16_swap_b32 v245, v249
  v_max_f32 v245, v245, v249
  v_mov_b32 v249, v246
  s_nop 1
  v_permlane32_swap_b32 v246, v249
  v_max_f32 v246, v246, v249
  v_mov_b32 v249, v246
  s_nop 1
  v_permlane16_swap_b32 v246, v249
  v_max_f32 v246, v246, v249
  s_lshl_b32 s42, s3, 8
  s_add_u32 s42, s42, 0x20000
  v_lshl_add_u32 v250, v14, 2, s42
  ds_write_b32 v250, v246
  v_xor_b32 v250, 0x200, v250
  s_waitcnt lgkmcnt(0)
  s_barrier
  ds_read_b32 v251, v250
  s_waitcnt lgkmcnt(0)
  v_max_f32 v246, v246, v251
  s_mov_b32 s72, 0
  s_mov_b32 s71, 16
L_sf2:
  s_waitcnt vmcnt(0) lgkmcnt(0)
  s_barrier
  s_mov_b32 m0, s75
  s_nop 0
  buffer_load_dwordx4 v7, s[12:15], s72 offen nt lds
  buffer_load_dwordx4 v7, s[12:15], s72 offen offset:1024 nt lds
  buffer_load_dwordx4 v8, s[12:15], s72 offen offset:2048 nt lds
  buffer_load_dwordx4 v8, s[12:15], s72 offen offset:3072 nt lds
  s_add_u32 m0, s75, 0x10000
  s_nop 0
  buffer_load_dwordx4 v7, s[16:19], s72 offen nt lds
  buffer_load_dwordx4 v8, s[16:19], s72 offen offset:1024 nt lds
  buffer_load_dwordx4 v7, s[16:19], s72 offen offset:2048 nt lds
  buffer_load_dwordx4 v8, s[16:19], s72 offen offset:3072 nt lds
  s_add_u32 s72, s72, 0x4000
  s_waitcnt vmcnt(0)
  s_barrier
  ds_read_b128 a[160:163], v1
  ds_read_b128 a[164:167], v1 offset:256
  ds_read_b128 a[168:171], v240
  ds_read_b128 a[172:175], v240 offset:256
  s_waitcnt lgkmcnt(0)
  v_mfma_f32_16x16x32_bf16 v[176:179], a[160:163], v[16:19], 0
  v_mfma_f32_16x16x32_bf16 v[176:179], a[164:167], v[24:27], v[176:179]
  v_mfma_f32_16x16x32_bf16 v[176:179], a[168:171], v[32:35], v[176:179]
  v_mfma_f32_16x16x32_bf16 v[176:179], a[172:175], v[40:43], v[176:179]
  v_mfma_f32_16x16x32_bf16 v[180:183], a[160:163], v[48:51], 0
  v_mfma_f32_16x16x32_bf16 v[180:183], a[164:167], v[56:59], v[180:183]
  v_mfma_f32_16x16x32_bf16 v[180:183], a[168:171], v[64:67], v[180:183]
  v_mfma_f32_16x16x32_bf16 v[180:183], a[172:175], v[72:75], v[180:183]
  v_mfma_f32_16x16x32_bf16 v[184:187], a[160:163], v[80:83], 0
  v_mfma_f32_16x16x32_bf16 v[184:187], a[164:167], v[88:91], v[184:187]
  v_mfma_f32_16x16x32_bf16 v[184:187], a[168:171], v[96:99], v[184:187]
  v_mfma_f32_16x16x32_bf16 v[184:187], a[172:175], v[104:107], v[184:187]
  v_mfma_f32_16x16x32_bf16 v[188:191], a[160:163], v[112:115], 0
  v_mfma_f32_16x16x32_bf16 v[188:191], a[164:167], v[120:123], v[188:191]
  v_mfma_f32_16x16x32_bf16 v[188:191], a[168:171], v[128:131], v[188:191]
  v_mfma_f32_16x16x32_bf16 v[188:191], a[172:175], v[136:139], v[188:191]
  v_mfma_f32_16x16x32_bf16 v[192:195], a[160:163], v[144:147], 0
  v_mfma_f32_16x16x32_bf16 v[192:195], a[164:167], v[152:155], v[192:195]
  v_mfma_f32_16x16x32_bf16 v[192:195], a[168:171], v[160:163], v[192:195]
  v_mfma_f32_16x16x32_bf16 v[192:195], a[172:175], v[168:171], v[192:195]
  ds_read_b128 a[176:179], v1 offset:4096
  ds_read_b128 a[180:183], v1 offset:4352
  ds_read_b128 a[184:187], v240 offset:4096
  ds_read_b128 a[188:191], v240 offset:4352
  s_waitcnt lgkmcnt(0)
  v_mfma_f32_16x16x32_bf16 v[196:199], a[176:179], v[16:19], 0
  v_mfma_f32_16x16x32_bf16 v[196:199], a[180:183], v[24:27], v[196:199]
  v_mfma_f32_16x16x32_bf16 v[196:199], a[184:187], v[32:35], v[196:199]
  v_mfma_f32_16x16x32_bf16 v[196:199], a[188:191], v[40:43], v[196:199]
  v_mfma_f32_16x16x32_bf16 v[200:203], a[176:179], v[48:51], 0
  v_mfma_f32_16x16x32_bf16 v[200:203], a[180:183], v[56:59], v[200:203]
  v_mfma_f32_16x16x32_bf16 v[200:203], a[184:187], v[64:67], v[200:203]
  v_mfma_f32_16x16x32_bf16 v[200:203], a[188:191], v[72:75], v[200:203]
  v_mfma_f32_16x16x32_bf16 v[204:207], a[176:179], v[80:83], 0
  v_mfma_f32_16x16x32_bf16 v[204:207], a[180:183], v[88:91], v[204:207]
  v_mfma_f32_16x16x32_bf16 v[204:207], a[184:187], v[96:99], v[204:207]
  v_mfma_f32_16x16x32_bf16 v[204:207], a[188:191], v[104:107], v[204:207]
  v_mfma_f32_16x16x32_bf16 v[208:211], a[176:179], v[112:115], 0
  v_mfma_f32_16x16x32_bf16 v[208:211], a[180:183], v[120:123], v[208:211]
  v_mfma_f32_16x16x32_bf16 v[208:211], a[184:187], v[128:131], v[208:211]
  v_mfma_f32_16x16x32_bf16 v[208:211], a[188:191], v[136:139], v[208:211]
  v_mfma_f32_16x16x32_bf16 v[212:215], a[176:179], v[144:147], 0
  v_mfma_f32_16x16x32_bf16 v[212:215], a[180:183], v[152:155], v[212:215]
  v_mfma_f32_16x16x32_bf16 v[212:215], a[184:187], v[160:163], v[212:215]
  v_mfma_f32_16x16x32_bf16 v[212:215], a[188:191], v[168:171], v[212:215]
  ds_read_b128 a[160:163], v2
  ds_read_b128 a[164:167], v2 offset:256
  ds_read_b128 a[168:171], v241
  ds_read_b128 a[172:175], v241 offset:256
  s_waitcnt lgkmcnt(0)
  v_mfma_f32_16x16x32_bf16 v[216:219], a[160:163], v[16:19], 0
  v_mfma_f32_16x16x32_bf16 v[216:219], a[164:167], v[24:27], v[216:219]
  v_mfma_f32_16x16x32_bf16 v[216:219], a[168:171], v[32:35], v[216:219]
  v_mfma_f32_16x16x32_bf16 v[216:219], a[172:175], v[40:43], v[216:219]
  v_mfma_f32_16x16x32_bf16 v[220:223], a[160:163], v[48:51], 0
  v_mfma_f32_16x16x32_bf16 v[220:223], a[164:167], v[56:59], v[220:223]
  v_mfma_f32_16x16x32_bf16 v[220:223], a[168:171], v[64:67], v[220:223]
  v_mfma_f32_16x16x32_bf16 v[220:223], a[172:175], v[72:75], v[220:223]
  v_mfma_f32_16x16x32_bf16 v[224:227], a[160:163], v[80:83], 0
  v_mfma_f32_16x16x32_bf16 v[224:227], a[164:167], v[88:91], v[224:227]
  v_mfma_f32_16x16x32_bf16 v[224:227], a[168:171], v[96:99], v[224:227]
  v_mfma_f32_16x16x32_bf16 v[224:227], a[172:175], v[104:107], v[224:227]
  v_mfma_f32_16x16x32_bf16 v[228:231], a[160:163], v[112:115], 0
  v_mfma_f32_16x16x32_bf16 v[228:231], a[164:167], v[120:123], v[228:231]
  v_mfma_f32_16x16x32_bf16 v[228:231], a[168:171], v[128:131], v[228:231]
  v_mfma_f32_16x16x32_bf16 v[228:231], a[172:175], v[136:139], v[228:231]
  ds_read_b128 a[176:179], v2 offset:4096
  ds_read_b128 a[180:183], v2 offset:4352
  ds_read_b128 a[184:187], v241 offset:4096
  ds_read_b128 a[188:191], v241 offset:4352
  s_waitcnt lgkmcnt(0)
  v_mfma_f32_16x16x32_bf16 v[232:235], a[176:179], v[16:19], 0
  v_mfma_f32_16x16x32_bf16 v[232:235], a[180:183], v[24:27], v[232:235]
  v_mfma_f32_16x16x32_bf16 v[232:235], a[184:187], v[32:35], v[232:235]
  v_mfma_f32_16x16x32_bf16 v[232:235], a[188:191], v[40:43], v[232:235]
  v_mfma_f32_16x16x32_bf16 v[236:239], a[176:179], v[48:51], 0
  v_mfma_f32_16x16x32_bf16 v[236:239], a[180:183], v[56:59], v[236:239]
  v_mfma_f32_16x16x32_bf16 v[236:239], a[184:187], v[64:67], v[236:239]
  v_mfma_f32_16x16x32_bf16 v[236:239], a[188:191], v[72:75], v[236:239]
  v_mfma_f32_16x16x32_bf16 v[20:23], a[176:179], v[80:83], 0
  v_mfma_f32_16x16x32_bf16 v[20:23], a[180:183], v[88:91], v[20:23]
  v_mfma_f32_16x16x32_bf16 v[20:23], a[184:187], v[96:99], v[20:23]
  v_mfma_f32_16x16x32_bf16 v[20:23], a[188:191], v[104:107], v[20:23]
  v_mfma_f32_16x16x32_bf16 v[28:31], a[176:179], v[112:115], 0
  v_mfma_f32_16x16x32_bf16 v[28:31], a[180:183], v[120:123], v[28:31]
  v_mfma_f32_16x16x32_bf16 v[28:31], a[184:187], v[128:131], v[28:31]
  v_mfma_f32_16x16x32_bf16 v[28:31], a[188:191], v[136:139], v[28:31]
  s_nop 7
  v_sub_f32 v176, v176, v242
  v_sub_f32 v177, v177, v242
  v_sub_f32 v178, v178, v242
  v_sub_f32 v179, v179, v242
  v_exp_f32 v176, v176
  v_exp_f32 v177, v177
  v_exp_f32 v178, v178
  v_exp_f32 v179, v179
  v_add_f32 v9, v176, v9
  v_add_f32 v9, v177, v9
  v_add_f32 v9, v178, v9
  v_add_f32 v9, v179, v9
  v_cvt_pk_bf16_f32 v36, v176, v177
  v_cvt_pk_bf16_f32 v37, v178, v179
  v_sub_f32 v180, v180, v243
  v_sub_f32 v181, v181, v243
  v_sub_f32 v182, v182, v243
  v_sub_f32 v183, v183, v243
  v_exp_f32 v180, v180
  v_exp_f32 v181, v181
  v_exp_f32 v182, v182
  v_exp_f32 v183, v183
  v_add_f32 v10, v180, v10
  v_add_f32 v10, v181, v10
  v_add_f32 v10, v182, v10
  v_add_f32 v10, v183, v10
  v_cvt_pk_bf16_f32 v52, v180, v181
  v_cvt_pk_bf16_f32 v53, v182, v183
  v_sub_f32 v184, v184, v244
  v_sub_f32 v185, v185, v244
  v_sub_f32 v186, v186, v244
  v_sub_f32 v187, v187, v244
  v_exp_f32 v184, v184
  v_exp_f32 v185, v185
  v_exp_f32 v186, v186
  v_exp_f32 v187, v187
  v_add_f32 v11, v184, v11
  v_add_f32 v11, v185, v11
  v_add_f32 v11, v186, v11
  v_add_f32 v11, v187, v11
  v_cvt_pk_bf16_f32 v68, v184, v185
  v_cvt_pk_bf16_f32 v69, v186, v187
  v_sub_f32 v188, v188, v245
  v_sub_f32 v189, v189, v245
  v_sub_f32 v190, v190, v245
  v_sub_f32 v191, v191, v245
  v_exp_f32 v188, v188
  v_exp_f32 v189, v189
  v_exp_f32 v190, v190
  v_exp_f32 v191, v191
  v_add_f32 v12, v188, v12
  v_add_f32 v12, v189, v12
  v_add_f32 v12, v190, v12
  v_add_f32 v12, v191, v12
  v_cvt_pk_bf16_f32 v84, v188, v189
  v_cvt_pk_bf16_f32 v85, v190, v191
  v_sub_f32 v192, v192, v246
  v_sub_f32 v193, v193, v246
  v_sub_f32 v194, v194, v246
  v_sub_f32 v195, v195, v246
  v_exp_f32 v192, v192
  v_exp_f32 v193, v193
  v_exp_f32 v194, v194
  v_exp_f32 v195, v195
  v_add_f32 v13, v192, v13
  v_add_f32 v13, v193, v13
  v_add_f32 v13, v194, v13
  v_add_f32 v13, v195, v13
  v_cvt_pk_bf16_f32 v100, v192, v193
  v_cvt_pk_bf16_f32 v101, v194, v195
  v_sub_f32 v196, v196, v242
  v_sub_f32 v197, v197, v242
  v_sub_f32 v198, v198, v242
  v_sub_f32 v199, v199, v242
  v_exp_f32 v196, v196
  v_exp_f32 v197, v197
  v_exp_f32 v198, v198
  v_exp_f32 v199, v199
  v_add_f32 v9, v196, v9
  v_add_f32 v9, v197, v9
  v_add_f32 v9, v198, v9
  v_add_f32 v9, v199, v9
  v_cvt_pk_bf16_f32 v38, v196, v197
  v_cvt_pk_bf16_f32 v39, v198, v199
  v_sub_f32 v200, v200, v243
  v_sub_f32 v201, v201, v243
  v_sub_f32 v202, v202, v243
  v_sub_f32 v203, v203, v243
  v_exp_f32 v200, v200
  v_exp_f32 v201, v201
  v_exp_f32 v202, v202
  v_exp_f32 v203, v203
  v_add_f32 v10, v200, v10
  v_add_f32 v10, v201, v10
  v_add_f32 v10, v202, v10
  v_add_f32 v10, v203, v10
  v_cvt_pk_bf16_f32 v54, v200, v201
  v_cvt_pk_bf16_f32 v55, v202, v203
  v_sub_f32 v204, v204, v244
  v_sub_f32 v205, v205, v244
  v_sub_f32 v206, v206, v244
  v_sub_f32 v207, v207, v244
  v_exp_f32 v204, v204
  v_exp_f32 v205, v205
  v_exp_f32 v206, v206
  v_exp_f32 v207, v207
  v_add_f32 v11, v204, v11
  v_add_f32 v11, v205, v11
  v_add_f32 v11, v206, v11
  v_add_f32 v11, v207, v11
  v_cvt_pk_bf16_f32 v70, v204, v205
  v_cvt_pk_bf16_f32 v71, v206, v207
  v_sub_f32 v208, v208, v245
  v_sub_f32 v209, v209, v245
  v_sub_f32 v210, v210, v245
  v_sub_f32 v211, v211, v245
  v_exp_f32 v208, v208
  v_exp_f32 v209, v209
  v_exp_f32 v210, v210
  v_exp_f32 v211, v211
  v_add_f32 v12, v208, v12
  v_add_f32 v12, v209, v12
  v_add_f32 v12, v210, v12
  v_add_f32 v12, v211, v12
  v_cvt_pk_bf16_f32 v86, v208, v209
  v_cvt_pk_bf16_f32 v87, v210, v211
  v_sub_f32 v212, v212, v246
  v_sub_f32 v213, v213, v246
  v_sub_f32 v214, v214, v246
  v_sub_f32 v215, v215, v246
  v_exp_f32 v212, v212
  v_exp_f32 v213, v213
  v_exp_f32 v214, v214
  v_exp_f32 v215, v215
  v_add_f32 v13, v212, v13
  v_add_f32 v13, v213, v13
  v_add_f32 v13, v214, v13
  v_add_f32 v13, v215, v13
  v_cvt_pk_bf16_f32 v102, v212, v213
  v_cvt_pk_bf16_f32 v103, v214, v215
  v_sub_f32 v216, v216, v242
  v_sub_f32 v217, v217, v242
  v_sub_f32 v218, v218, v242
  v_sub_f32 v219, v219, v242
  v_exp_f32 v216, v216
  v_exp_f32 v217, v217
  v_exp_f32 v218, v218
  v_exp_f32 v219, v219
  v_add_f32 v9, v216, v9
  v_add_f32 v9, v217, v9
  v_add_f32 v9, v218, v9
  v_add_f32 v9, v219, v9
  v_cvt_pk_bf16_f32 v44, v216, v217
  v_cvt_pk_bf16_f32 v45, v218, v219
  v_sub_f32 v220, v220, v243
  v_sub_f32 v221, v221, v243
  v_sub_f32 v222, v222, v243
  v_sub_f32 v223, v223, v243
  v_exp_f32 v220, v220
  v_exp_f32 v221, v221
  v_exp_f32 v222, v222
  v_exp_f32 v223, v223
  v_add_f32 v10, v220, v10
  v_add_f32 v10, v221, v10
  v_add_f32 v10, v222, v10
  v_add_f32 v10, v223, v10
  v_cvt_pk_bf16_f32 v60, v220, v221
  v_cvt_pk_bf16_f32 v61, v222, v223
  v_sub_f32 v224, v224, v244
  v_sub_f32 v225, v225, v244
  v_sub_f32 v226, v226, v244
  v_sub_f32 v227, v227, v244
  v_exp_f32 v224, v224
  v_exp_f32 v225, v225
  v_exp_f32 v226, v226
  v_exp_f32 v227, v227
  v_add_f32 v11, v224, v11
  v_add_f32 v11, v225, v11
  v_add_f32 v11, v226, v11
  v_add_f32 v11, v227, v11
  v_cvt_pk_bf16_f32 v76, v224, v225
  v_cvt_pk_bf16_f32 v77, v226, v227
  v_sub_f32 v228, v228, v245
  v_sub_f32 v229, v229, v245
  v_sub_f32 v230, v230, v245
  v_sub_f32 v231, v231, v245
  v_exp_f32 v228, v228
  v_exp_f32 v229, v229
  v_exp_f32 v230, v230
  v_exp_f32 v231, v231
  v_add_f32 v12, v228, v12
  v_add_f32 v12, v229, v12
  v_add_f32 v12, v230, v12
  v_add_f32 v12, v231, v12
  v_cvt_pk_bf16_f32 v92, v228, v229
  v_cvt_pk_bf16_f32 v93, v230, v231
  v_sub_f32 v232, v232, v242
  v_sub_f32 v233, v233, v242
  v_sub_f32 v234, v234, v242
  v_sub_f32 v235, v235, v242
  v_exp_f32 v232, v232
  v_exp_f32 v233, v233
  v_exp_f32 v234, v234
  v_exp_f32 v235, v235
  v_add_f32 v9, v232, v9
  v_add_f32 v9, v233, v9
  v_add_f32 v9, v234, v9
  v_add_f32 v9, v235, v9
  v_cvt_pk_bf16_f32 v46, v232, v233
  v_cvt_pk_bf16_f32 v47, v234, v235
  v_sub_f32 v236, v236, v243
  v_sub_f32 v237, v237, v243
  v_sub_f32 v238, v238, v243
  v_sub_f32 v239, v239, v243
  v_exp_f32 v236, v236
  v_exp_f32 v237, v237
  v_exp_f32 v238, v238
  v_exp_f32 v239, v239
  v_add_f32 v10, v236, v10
  v_add_f32 v10, v237, v10
  v_add_f32 v10, v238, v10
  v_add_f32 v10, v239, v10
  v_cvt_pk_bf16_f32 v62, v236, v237
  v_cvt_pk_bf16_f32 v63, v238, v239
  v_sub_f32 v20, v20, v244
  v_sub_f32 v21, v21, v244
  v_sub_f32 v22, v22, v244
  v_sub_f32 v23, v23, v244
  v_exp_f32 v20, v20
  v_exp_f32 v21, v21
  v_exp_f32 v22, v22
  v_exp_f32 v23, v23
  v_add_f32 v11, v20, v11
  v_add_f32 v11, v21, v11
  v_add_f32 v11, v22, v11
  v_add_f32 v11, v23, v11
  v_cvt_pk_bf16_f32 v78, v20, v21
  v_cvt_pk_bf16_f32 v79, v22, v23
  v_sub_f32 v28, v28, v245
  v_sub_f32 v29, v29, v245
  v_sub_f32 v30, v30, v245
  v_sub_f32 v31, v31, v245
  v_exp_f32 v28, v28
  v_exp_f32 v29, v29
  v_exp_f32 v30, v30
  v_exp_f32 v31, v31
  v_add_f32 v12, v28, v12
  v_add_f32 v12, v29, v12
  v_add_f32 v12, v30, v12
  v_add_f32 v12, v31, v12
  v_cvt_pk_bf16_f32 v94, v28, v29
  v_cvt_pk_bf16_f32 v95, v30, v31
  ds_read_b64_tr_b16 a[192:193], v3
  ds_read_b64_tr_b16 a[194:195], v3 offset:4096
  ds_read_b64_tr_b16 a[196:197], v5
  ds_read_b64_tr_b16 a[198:199], v5 offset:4096
  s_waitcnt lgkmcnt(0)
  v_mfma_f32_16x16x32_bf16 a[0:3], a[192:195], v[36:39], a[0:3]
  v_mfma_f32_16x16x32_bf16 a[0:3], a[196:199], v[44:47], a[0:3]
  v_mfma_f32_16x16x32_bf16 a[32:35], a[192:195], v[52:55], a[32:35]
  v_mfma_f32_16x16x32_bf16 a[32:35], a[196:199], v[60:63], a[32:35]
  v_mfma_f32_16x16x32_bf16 a[64:67], a[192:195], v[68:71], a[64:67]
  v_mfma_f32_16x16x32_bf16 a[64:67], a[196:199], v[76:79], a[64:67]
  v_mfma_f32_16x16x32_bf16 a[96:99], a[192:195], v[84:87], a[96:99]
  v_mfma_f32_16x16x32_bf16 a[96:99], a[196:199], v[92:95], a[96:99]
  v_mfma_f32_16x16x32_bf16 a[128:131], a[192:195], v[100:103], a[128:131]
  ds_read_b64_tr_b16 a[200:201], v4
  ds_read_b64_tr_b16 a[202:203], v4 offset:4096
  ds_read_b64_tr_b16 a[204:205], v6
  ds_read_b64_tr_b16 a[206:207], v6 offset:4096
  s_waitcnt lgkmcnt(0)
  v_mfma_f32_16x16x32_bf16 a[4:7], a[200:203], v[36:39], a[4:7]
  v_mfma_f32_16x16x32_bf16 a[4:7], a[204:207], v[44:47], a[4:7]
  v_mfma_f32_16x16x32_bf16 a[36:39], a[200:203], v[52:55], a[36:39]
  v_mfma_f32_16x16x32_bf16 a[36:39], a[204:207], v[60:63], a[36:39]
  v_mfma_f32_16x16x32_bf16 a[68:71], a[200:203], v[68:71], a[68:71]
  v_mfma_f32_16x16x32_bf16 a[68:71], a[204:207], v[76:79], a[68:71]
  v_mfma_f32_16x16x32_bf16 a[100:103], a[200:203], v[84:87], a[100:103]
  v_mfma_f32_16x16x32_bf16 a[100:103], a[204:207], v[92:95], a[100:103]
  v_mfma_f32_16x16x32_bf16 a[132:135], a[200:203], v[100:103], a[132:135]
  ds_read_b64_tr_b16 a[208:209], v3 offset:256
  ds_read_b64_tr_b16 a[210:211], v3 offset:4352
  ds_read_b64_tr_b16 a[212:213], v5 offset:256
  ds_read_b64_tr_b16 a[214:215], v5 offset:4352
  s_waitcnt lgkmcnt(0)
  v_mfma_f32_16x16x32_bf16 a[8:11], a[208:211], v[36:39], a[8:11]
  v_mfma_f32_16x16x32_bf16 a[8:11], a[212:215], v[44:47], a[8:11]
  v_mfma_f32_16x16x32_bf16 a[40:43], a[208:211], v[52:55], a[40:43]
  v_mfma_f32_16x16x32_bf16 a[40:43], a[212:215], v[60:63], a[40:43]
  v_mfma_f32_16x16x32_bf16 a[72:75], a[208:211], v[68:71], a[72:75]
  v_mfma_f32_16x16x32_bf16 a[72:75], a[212:215], v[76:79], a[72:75]
  v_mfma_f32_16x16x32_bf16 a[104:107], a[208:211], v[84:87], a[104:107]
  v_mfma_f32_16x16x32_bf16 a[104:107], a[212:215], v[92:95], a[104:107]
  v_mfma_f32_16x16x32_bf16 a[136:139], a[208:211], v[100:103], a[136:139]
  ds_read_b64_tr_b16 a[216:217], v4 offset:256
  ds_read_b64_tr_b16 a[218:219], v4 offset:4352
  ds_read_b64_tr_b16 a[220:221], v6 offset:256
  ds_read_b64_tr_b16 a[222:223], v6 offset:4352
  s_waitcnt lgkmcnt(0)
  v_mfma_f32_16x16x32_bf16 a[12:15], a[216:219], v[36:39], a[12:15]
  v_mfma_f32_16x16x32_bf16 a[12:15], a[220:223], v[44:47], a[12:15]
  v_mfma_f32_16x16x32_bf16 a[44:47], a[216:219], v[52:55], a[44:47]
  v_mfma_f32_16x16x32_bf16 a[44:47], a[220:223], v[60:63], a[44:47]
  v_mfma_f32_16x16x32_bf16 a[76:79], a[216:219], v[68:71], a[76:79]
  v_mfma_f32_16x16x32_bf16 a[76:79], a[220:223], v[76:79], a[76:79]
  v_mfma_f32_16x16x32_bf16 a[108:111], a[216:219], v[84:87], a[108:111]
  v_mfma_f32_16x16x32_bf16 a[108:111], a[220:223], v[92:95], a[108:111]
  v_mfma_f32_16x16x32_bf16 a[140:143], a[216:219], v[100:103], a[140:143]
  ds_read_b64_tr_b16 a[192:193], v3 offset:512
  ds_read_b64_tr_b16 a[194:195], v3 offset:4608
  ds_read_b64_tr_b16 a[196:197], v5 offset:512
  ds_read_b64_tr_b16 a[198:199], v5 offset:4608
  s_waitcnt lgkmcnt(0)
  v_mfma_f32_16x16x32_bf16 a[16:19], a[192:195], v[36:39], a[16:19]
  v_mfma_f32_16x16x32_bf16 a[16:19], a[196:199], v[44:47], a[16:19]
  v_mfma_f32_16x16x32_bf16 a[48:51], a[192:195], v[52:55], a[48:51]
  v_mfma_f32_16x16x32_bf16 a[48:51], a[196:199], v[60:63], a[48:51]
  v_mfma_f32_16x16x32_bf16 a[80:83], a[192:195], v[68:71], a[80:83]
  v_mfma_f32_16x16x32_bf16 a[80:83], a[196:199], v[76:79], a[80:83]
  v_mfma_f32_16x16x32_bf16 a[112:115], a[192:195], v[84:87], a[112:115]
  v_mfma_f32_16x16x32_bf16 a[112:115], a[196:199], v[92:95], a[112:115]
  v_mfma_f32_16x16x32_bf16 a[144:147], a[192:195], v[100:103], a[144:147]
  ds_read_b64_tr_b16 a[200:201], v4 offset:512
  ds_read_b64_tr_b16 a[202:203], v4 offset:4608
  ds_read_b64_tr_b16 a[204:205], v6 offset:512
  ds_read_b64_tr_b16 a[206:207], v6 offset:4608
  s_waitcnt lgkmcnt(0)
  v_mfma_f32_16x16x32_bf16 a[20:23], a[200:203], v[36:39], a[20:23]
  v_mfma_f32_16x16x32_bf16 a[20:23], a[204:207], v[44:47], a[20:23]
  v_mfma_f32_16x16x32_bf16 a[52:55], a[200:203], v[52:55], a[52:55]
  v_mfma_f32_16x16x32_bf16 a[52:55], a[204:207], v[60:63], a[52:55]
  v_mfma_f32_16x16x32_bf16 a[84:87], a[200:203], v[68:71], a[84:87]
  v_mfma_f32_16x16x32_bf16 a[84:87], a[204:207], v[76:79], a[84:87]
  v_mfma_f32_16x16x32_bf16 a[116:119], a[200:203], v[84:87], a[116:119]
  v_mfma_f32_16x16x32_bf16 a[116:119], a[204:207], v[92:95], a[116:119]
  v_mfma_f32_16x16x32_bf16 a[148:151], a[200:203], v[100:103], a[148:151]
  ds_read_b64_tr_b16 a[208:209], v3 offset:768
  ds_read_b64_tr_b16 a[210:211], v3 offset:4864
  ds_read_b64_tr_b16 a[212:213], v5 offset:768
  ds_read_b64_tr_b16 a[214:215], v5 offset:4864
  s_waitcnt lgkmcnt(0)
  v_mfma_f32_16x16x32_bf16 a[24:27], a[208:211], v[36:39], a[24:27]
  v_mfma_f32_16x16x32_bf16 a[24:27], a[212:215], v[44:47], a[24:27]
  v_mfma_f32_16x16x32_bf16 a[56:59], a[208:211], v[52:55], a[56:59]
  v_mfma_f32_16x16x32_bf16 a[56:59], a[212:215], v[60:63], a[56:59]
  v_mfma_f32_16x16x32_bf16 a[88:91], a[208:211], v[68:71], a[88:91]
  v_mfma_f32_16x16x32_bf16 a[88:91], a[212:215], v[76:79], a[88:91]
  v_mfma_f32_16x16x32_bf16 a[120:123], a[208:211], v[84:87], a[120:123]
  v_mfma_f32_16x16x32_bf16 a[120:123], a[212:215], v[92:95], a[120:123]
  v_mfma_f32_16x16x32_bf16 a[152:155], a[208:211], v[100:103], a[152:155]
  ds_read_b64_tr_b16 a[216:217], v4 offset:768
  ds_read_b64_tr_b16 a[218:219], v4 offset:4864
  ds_read_b64_tr_b16 a[220:221], v6 offset:768
  ds_read_b64_tr_b16 a[222:223], v6 offset:4864
  s_waitcnt lgkmcnt(0)
  v_mfma_f32_16x16x32_bf16 a[28:31], a[216:219], v[36:39], a[28:31]
  v_mfma_f32_16x16x32_bf16 a[28:31], a[220:223], v[44:47], a[28:31]
  v_mfma_f32_16x16x32_bf16 a[60:63], a[216:219], v[52:55], a[60:63]
  v_mfma_f32_16x16x32_bf16 a[60:63], a[220:223], v[60:63], a[60:63]
  v_mfma_f32_16x16x32_bf16 a[92:95], a[216:219], v[68:71], a[92:95]
  v_mfma_f32_16x16x32_bf16 a[92:95], a[220:223], v[76:79], a[92:95]
  v_mfma_f32_16x16x32_bf16 a[124:127], a[216:219], v[84:87], a[124:127]
  v_mfma_f32_16x16x32_bf16 a[124:127], a[220:223], v[92:95], a[124:127]
  v_mfma_f32_16x16x32_bf16 a[156:159], a[216:219], v[100:103], a[156:159]
  s_sub_u32 s71, s71, 1
  s_cmp_lg_u32 s71, 0
  s_cbranch_scc1 L_sf2
  s_nop 7
  v_lshlrev_b32 v249, 4, v14
  s_add_u32 s42, s75, 0x20000
  v_add_u32 v250, s42, v249
  v_xor_b32 v251, 0x2000, v250
  s_lshl_b32 s42, s3, 8
  s_add_u32 s42, s42, 0x24000
  v_lshl_add_u32 v252, v14, 2, s42
  s_lshl_b32 s42, s3, 19
  v_add_u32 v1, s42, v249
  s_and_b32 s42, s3, 1
  s_add_u32 s42, s42, 16
  s_lshl_b32 s42, s42, 17
  s_lshr_b32 s43, s3, 1
  s_lshl_b32 s43, s43, 11
  s_add_u32 s42, s42, s43
  v_add_u32 v2, s42, v249
  s_cmp_ge_u32 s3, 2
  s_cbranch_scc1 L_cx2
  ds_write_b128 v250, a[144:147]
  ds_write_b128 v250, a[148:151] offset:1024
  ds_write_b128 v250, a[152:155] offset:2048
  ds_write_b128 v250, a[156:159] offset:3072
L_cx2r:
  ds_write_b32 v252, v13
  v_xor_b32 v252, 0x200, v252
  s_waitcnt lgkmcnt(0)
  s_barrier
  ds_read_b128 v[176:179], v251
  ds_read_b128 v[180:183], v251 offset:1024
  ds_read_b128 v[184:187], v251 offset:2048
  ds_read_b128 v[188:191], v251 offset:3072
  ds_read_b32 v253, v252
  s_waitcnt lgkmcnt(0)
  v_add_f32 v13, v253, v13
  v_mov_b32 v249, v9
  s_nop 1
  v_permlane32_swap_b32 v9, v249
  v_add_f32 v9, v9, v249
  v_mov_b32 v249, v9
  s_nop 1
  v_permlane16_swap_b32 v9, v249
  v_add_f32 v9, v9, v249
  v_rcp_f32 v9, v9
  s_mov_b32 s43, 0
  v_accvgpr_read_b32 v192, a0
  v_accvgpr_read_b32 v193, a1
  v_accvgpr_read_b32 v194, a2
  v_accvgpr_read_b32 v195, a3
  v_pk_mul_f32 v[192:193], v[192:193], v[8:9] op_sel:[0,1] op_sel_hi:[1,1]
  v_pk_mul_f32 v[194:195], v[194:195], v[8:9] op_sel:[0,1] op_sel_hi:[1,1]
  v_accvgpr_read_b32 v196, a4
  v_accvgpr_read_b32 v197, a5
  v_accvgpr_read_b32 v198, a6
  v_accvgpr_read_b32 v199, a7
  v_pk_mul_f32 v[196:197], v[196:197], v[8:9] op_sel:[0,1] op_sel_hi:[1,1]
  v_pk_mul_f32 v[198:199], v[198:199], v[8:9] op_sel:[0,1] op_sel_hi:[1,1]
  v_cvt_pk_bf16_f32 v192, v192, v193
  v_cvt_pk_bf16_f32 v193, v194, v195
  v_cvt_pk_bf16_f32 v194, v196, v197
  v_cvt_pk_bf16_f32 v195, v198, v199
  buffer_store_dwordx4 v[192:195], v1, s[20:23], s43 offen sc1
  v_accvgpr_read_b32 v200, a8
  v_accvgpr_read_b32 v201, a9
  v_accvgpr_read_b32 v202, a10
  v_accvgpr_read_b32 v203, a11
  v_pk_mul_f32 v[200:201], v[200:201], v[8:9] op_sel:[0,1] op_sel_hi:[1,1]
  v_pk_mul_f32 v[202:203], v[202:203], v[8:9] op_sel:[0,1] op_sel_hi:[1,1]
  v_accvgpr_read_b32 v204, a12
  v_accvgpr_read_b32 v205, a13
  v_accvgpr_read_b32 v206, a14
  v_accvgpr_read_b32 v207, a15
  v_pk_mul_f32 v[204:205], v[204:205], v[8:9] op_sel:[0,1] op_sel_hi:[1,1]
  v_pk_mul_f32 v[206:207], v[206:207], v[8:9] op_sel:[0,1] op_sel_hi:[1,1]
  v_cvt_pk_bf16_f32 v200, v200, v201
  v_cvt_pk_bf16_f32 v201, v202, v203
  v_cvt_pk_bf16_f32 v202, v204, v205
  v_cvt_pk_bf16_f32 v203, v206, v207
  buffer_store_dwordx4 v[200:203], v1, s[20:23], s43 offen offset:1024 sc1
  v_accvgpr_read_b32 v192, a16
  v_accvgpr_read_b32 v193, a17
  v_accvgpr_read_b32 v194, a18
  v_accvgpr_read_b32 v195, a19
  v_pk_mul_f32 v[192:193], v[192:193], v[8:9] op_sel:[0,1] op_sel_hi:[1,1]
  v_pk_mul_f32 v[194:195], v[194:195], v[8:9] op_sel:[0,1] op_sel_hi:[1,1]
  v_accvgpr_read_b32 v196, a20
  v_accvgpr_read_b32 v197, a21
  v_accvgpr_read_b32 v198, a22
  v_accvgpr_read_b32 v199, a23
  v_pk_mul_f32 v[196:197], v[196:197], v[8:9] op_sel:[0,1] op_sel_hi:[1,1]
  v_pk_mul_f32 v[198:199], v[198:199], v[8:9] op_sel:[0,1] op_sel_hi:[1,1]
  v_cvt_pk_bf16_f32 v192, v192, v193
  v_cvt_pk_bf16_f32 v193, v194, v195
  v_cvt_pk_bf16_f32 v194, v196, v197
  v_cvt_pk_bf16_f32 v195, v198, v199
  buffer_store_dwordx4 v[192:195], v1, s[20:23], s43 offen offset:2048 sc1
  v_accvgpr_read_b32 v200, a24
  v_accvgpr_read_b32 v201, a25
  v_accvgpr_read_b32 v202, a26
  v_accvgpr_read_b32 v203, a27
  v_pk_mul_f32 v[200:201], v[200:201], v[8:9] op_sel:[0,1] op_sel_hi:[1,1]
  v_pk_mul_f32 v[202:203], v[202:203], v[8:9] op_sel:[0,1] op_sel_hi:[1,1]
  v_accvgpr_read_b32 v204, a28
  v_accvgpr_read_b32 v205, a29
  v_accvgpr_read_b32 v206, a30
  v_accvgpr_read_b32 v207, a31
  v_pk_mul_f32 v[204:205], v[204:205], v[8:9] op_sel:[0,1] op_sel_hi:[1,1]
  v_pk_mul_f32 v[206:207], v[206:207], v[8:9] op_sel:[0,1] op_sel_hi:[1,1]
  v_cvt_pk_bf16_f32 v200, v200, v201
  v_cvt_pk_bf16_f32 v201, v202, v203
  v_cvt_pk_bf16_f32 v202, v204, v205
  v_cvt_pk_bf16_f32 v203, v206, v207
  buffer_store_dwordx4 v[200:203], v1, s[20:23], s43 offen offset:3072 sc1
  v_mov_b32 v249, v10
  s_nop 1
  v_permlane32_swap_b32 v10, v249
  v_add_f32 v10, v10, v249
  v_mov_b32 v249, v10
  s_nop 1
  v_permlane16_swap_b32 v10, v249
  v_add_f32 v10, v10, v249
  v_rcp_f32 v10, v10
  s_mov_b32 s43, 0x20000
  v_accvgpr_read_b32 v192, a32
  v_accvgpr_read_b32 v193, a33
  v_accvgpr_read_b32 v194, a34
  v_accvgpr_read_b32 v195, a35
  v_pk_mul_f32 v[192:193], v[192:193], v[10:11] op_sel:[0,0] op_sel_hi:[1,0]
  v_pk_mul_f32 v[194:195], v[194:195], v[10:11] op_sel:[0,0] op_sel_hi:[1,0]
  v_accvgpr_read_b32 v196, a36
  v_accvgpr_read_b32 v197, a37
  v_accvgpr_read_b32 v198, a38
  v_accvgpr_read_b32 v199, a39
  v_pk_mul_f32 v[196:197], v[196:197], v[10:11] op_sel:[0,0] op_sel_hi:[1,0]
  v_pk_mul_f32 v[198:199], v[198:199], v[10:11] op_sel:[0,0] op_sel_hi:[1,0]
  v_cvt_pk_bf16_f32 v192, v192, v193
  v_cvt_pk_bf16_f32 v193, v194, v195
  v_cvt_pk_bf16_f32 v194, v196, v197
  v_cvt_pk_bf16_f32 v195, v198, v199
  buffer_store_dwordx4 v[192:195], v1, s[20:23], s43 offen sc1
  v_accvgpr_read_b32 v200, a40
  v_accvgpr_read_b32 v201, a41
  v_accvgpr_read_b32 v202, a42
  v_accvgpr_read_b32 v203, a43
  v_pk_mul_f32 v[200:201], v[200:201], v[10:11] op_sel:[0,0] op_sel_hi:[1,0]
  v_pk_mul_f32 v[202:203], v[202:203], v[10:11] op_sel:[0,0] op_sel_hi:[1,0]
  v_accvgpr_read_b32 v204, a44
  v_accvgpr_read_b32 v205, a45
  v_accvgpr_read_b32 v206, a46
  v_accvgpr_read_b32 v207, a47
  v_pk_mul_f32 v[204:205], v[204:205], v[10:11] op_sel:[0,0] op_sel_hi:[1,0]
  v_pk_mul_f32 v[206:207], v[206:207], v[10:11] op_sel:[0,0] op_sel_hi:[1,0]
  v_cvt_pk_bf16_f32 v200, v200, v201
  v_cvt_pk_bf16_f32 v201, v202, v203
  v_cvt_pk_bf16_f32 v202, v204, v205
  v_cvt_pk_bf16_f32 v203, v206, v207
  buffer_store_dwordx4 v[200:203], v1, s[20:23], s43 offen offset:1024 sc1
  v_accvgpr_read_b32 v192, a48
  v_accvgpr_read_b32 v193, a49
  v_accvgpr_read_b32 v194, a50
  v_accvgpr_read_b32 v195, a51
  v_pk_mul_f32 v[192:193], v[192:193], v[10:11] op_sel:[0,0] op_sel_hi:[1,0]
  v_pk_mul_f32 v[194:195], v[194:195], v[10:11] op_sel:[0,0] op_sel_hi:[1,0]
  v_accvgpr_read_b32 v196, a52
  v_accvgpr_read_b32 v197, a53
  v_accvgpr_read_b32 v198, a54
  v_accvgpr_read_b32 v199, a55
  v_pk_mul_f32 v[196:197], v[196:197], v[10:11] op_sel:[0,0] op_sel_hi:[1,0]
  v_pk_mul_f32 v[198:199], v[198:199], v[10:11] op_sel:[0,0] op_sel_hi:[1,0]
  v_cvt_pk_bf16_f32 v192, v192, v193
  v_cvt_pk_bf16_f32 v193, v194, v195
  v_cvt_pk_bf16_f32 v194, v196, v197
  v_cvt_pk_bf16_f32 v195, v198, v199
  buffer_store_dwordx4 v[192:195], v1, s[20:23], s43 offen offset:2048 sc1
  v_accvgpr_read_b32 v200, a56
  v_accvgpr_read_b32 v201, a57
  v_accvgpr_read_b32 v202, a58
  v_accvgpr_read_b32 v203, a59
  v_pk_mul_f32 v[200:201], v[200:201], v[10:11] op_sel:[0,0] op_sel_hi:[1,0]
  v_pk_mul_f32 v[202:203], v[202:203], v[10:11] op_sel:[0,0] op_sel_hi:[1,0]
  v_accvgpr_read_b32 v204, a60
  v_accvgpr_read_b32 v205, a61
  v_accvgpr_read_b32 v206, a62
  v_accvgpr_read_b32 v207, a63
  v_pk_mul_f32 v[204:205], v[204:205], v[10:11] op_sel:[0,0] op_sel_hi:[1,0]
  v_pk_mul_f32 v[206:207], v[206:207], v[10:11] op_sel:[0,0] op_sel_hi:[1,0]
  v_cvt_pk_bf16_f32 v200, v200, v201
  v_cvt_pk_bf16_f32 v201, v202, v203
  v_cvt_pk_bf16_f32 v202, v204, v205
  v_cvt_pk_bf16_f32 v203, v206, v207
  buffer_store_dwordx4 v[200:203], v1, s[20:23], s43 offen offset:3072 sc1
  v_mov_b32 v249, v11
  s_nop 1
  v_permlane32_swap_b32 v11, v249
  v_add_f32 v11, v11, v249
  v_mov_b32 v249, v11
  s_nop 1
  v_permlane16_swap_b32 v11, v249
  v_add_f32 v11, v11, v249
  v_rcp_f32 v11, v11
  s_mov_b32 s43, 0x40000
  v_accvgpr_read_b32 v192, a64
  v_accvgpr_read_b32 v193, a65
  v_accvgpr_read_b32 v194, a66
  v_accvgpr_read_b32 v195, a67
  v_pk_mul_f32 v[192:193], v[192:193], v[10:11] op_sel:[0,1] op_sel_hi:[1,1]
  v_pk_mul_f32 v[194:195], v[194:195], v[10:11] op_sel:[0,1] op_sel_hi:[1,1]
  v_accvgpr_read_b32 v196, a68
  v_accvgpr_read_b32 v197, a69
  v_accvgpr_read_b32 v198, a70
  v_accvgpr_read_b32 v199, a71
  v_pk_mul_f32 v[196:197], v[196:197], v[10:11] op_sel:[0,1] op_sel_hi:[1,1]
  v_pk_mul_f32 v[198:199], v[198:199], v[10:11] op_sel:[0,1] op_sel_hi:[1,1]
  v_cvt_pk_bf16_f32 v192, v192, v193
  v_cvt_pk_bf16_f32 v193, v194, v195
  v_cvt_pk_bf16_f32 v194, v196, v197
  v_cvt_pk_bf16_f32 v195, v198, v199
  buffer_store_dwordx4 v[192:195], v1, s[20:23], s43 offen sc1
  v_accvgpr_read_b32 v200, a72
  v_accvgpr_read_b32 v201, a73
  v_accvgpr_read_b32 v202, a74
  v_accvgpr_read_b32 v203, a75
  v_pk_mul_f32 v[200:201], v[200:201], v[10:11] op_sel:[0,1] op_sel_hi:[1,1]
  v_pk_mul_f32 v[202:203], v[202:203], v[10:11] op_sel:[0,1] op_sel_hi:[1,1]
  v_accvgpr_read_b32 v204, a76
  v_accvgpr_read_b32 v205, a77
  v_accvgpr_read_b32 v206, a78
  v_accvgpr_read_b32 v207, a79
  v_pk_mul_f32 v[204:205], v[204:205], v[10:11] op_sel:[0,1] op_sel_hi:[1,1]
  v_pk_mul_f32 v[206:207], v[206:207], v[10:11] op_sel:[0,1] op_sel_hi:[1,1]
  v_cvt_pk_bf16_f32 v200, v200, v201
  v_cvt_pk_bf16_f32 v201, v202, v203
  v_cvt_pk_bf16_f32 v202, v204, v205
  v_cvt_pk_bf16_f32 v203, v206, v207
  buffer_store_dwordx4 v[200:203], v1, s[20:23], s43 offen offset:1024 sc1
  v_accvgpr_read_b32 v192, a80
  v_accvgpr_read_b32 v193, a81
  v_accvgpr_read_b32 v194, a82
  v_accvgpr_read_b32 v195, a83
  v_pk_mul_f32 v[192:193], v[192:193], v[10:11] op_sel:[0,1] op_sel_hi:[1,1]
  v_pk_mul_f32 v[194:195], v[194:195], v[10:11] op_sel:[0,1] op_sel_hi:[1,1]
  v_accvgpr_read_b32 v196, a84
  v_accvgpr_read_b32 v197, a85
  v_accvgpr_read_b32 v198, a86
  v_accvgpr_read_b32 v199, a87
  v_pk_mul_f32 v[196:197], v[196:197], v[10:11] op_sel:[0,1] op_sel_hi:[1,1]
  v_pk_mul_f32 v[198:199], v[198:199], v[10:11] op_sel:[0,1] op_sel_hi:[1,1]
  v_cvt_pk_bf16_f32 v192, v192, v193
  v_cvt_pk_bf16_f32 v193, v194, v195
  v_cvt_pk_bf16_f32 v194, v196, v197
  v_cvt_pk_bf16_f32 v195, v198, v199
  buffer_store_dwordx4 v[192:195], v1, s[20:23], s43 offen offset:2048 sc1
  v_accvgpr_read_b32 v200, a88
  v_accvgpr_read_b32 v201, a89
  v_accvgpr_read_b32 v202, a90
  v_accvgpr_read_b32 v203, a91
  v_pk_mul_f32 v[200:201], v[200:201], v[10:11] op_sel:[0,1] op_sel_hi:[1,1]
  v_pk_mul_f32 v[202:203], v[202:203], v[10:11] op_sel:[0,1] op_sel_hi:[1,1]
  v_accvgpr_read_b32 v204, a92
  v_accvgpr_read_b32 v205, a93
  v_accvgpr_read_b32 v206, a94
  v_accvgpr_read_b32 v207, a95
  v_pk_mul_f32 v[204:205], v[204:205], v[10:11] op_sel:[0,1] op_sel_hi:[1,1]
  v_pk_mul_f32 v[206:207], v[206:207], v[10:11] op_sel:[0,1] op_sel_hi:[1,1]
  v_cvt_pk_bf16_f32 v200, v200, v201
  v_cvt_pk_bf16_f32 v201, v202, v203
  v_cvt_pk_bf16_f32 v202, v204, v205
  v_cvt_pk_bf16_f32 v203, v206, v207
  buffer_store_dwordx4 v[200:203], v1, s[20:23], s43 offen offset:3072 sc1
  v_mov_b32 v249, v12
  s_nop 1
  v_permlane32_swap_b32 v12, v249
  v_add_f32 v12, v12, v249
  v_mov_b32 v249, v12
  s_nop 1
  v_permlane16_swap_b32 v12, v249
  v_add_f32 v12, v12, v249
  v_rcp_f32 v12, v12
  s_mov_b32 s43, 0x60000
  v_accvgpr_read_b32 v192, a96
  v_accvgpr_read_b32 v193, a97
  v_accvgpr_read_b32 v194, a98
  v_accvgpr_read_b32 v195, a99
  v_pk_mul_f32 v[192:193], v[192:193], v[12:13] op_sel:[0,0] op_sel_hi:[1,0]
  v_pk_mul_f32 v[194:195], v[194:195], v[12:13] op_sel:[0,0] op_sel_hi:[1,0]
  v_accvgpr_read_b32 v196, a100
  v_accvgpr_read_b32 v197, a101
  v_accvgpr_read_b32 v198, a102
  v_accvgpr_read_b32 v199, a103
  v_pk_mul_f32 v[196:197], v[196:197], v[12:13] op_sel:[0,0] op_sel_hi:[1,0]
  v_pk_mul_f32 v[198:199], v[198:199], v[12:13] op_sel:[0,0] op_sel_hi:[1,0]
  v_cvt_pk_bf16_f32 v192, v192, v193
  v_cvt_pk_bf16_f32 v193, v194, v195
  v_cvt_pk_bf16_f32 v194, v196, v197
  v_cvt_pk_bf16_f32 v195, v198, v199
  buffer_store_dwordx4 v[192:195], v1, s[20:23], s43 offen sc1
  v_accvgpr_read_b32 v200, a104
  v_accvgpr_read_b32 v201, a105
  v_accvgpr_read_b32 v202, a106
  v_accvgpr_read_b32 v203, a107
  v_pk_mul_f32 v[200:201], v[200:201], v[12:13] op_sel:[0,0] op_sel_hi:[1,0]
  v_pk_mul_f32 v[202:203], v[202:203], v[12:13] op_sel:[0,0] op_sel_hi:[1,0]
  v_accvgpr_read_b32 v204, a108
  v_accvgpr_read_b32 v205, a109
  v_accvgpr_read_b32 v206, a110
  v_accvgpr_read_b32 v207, a111
  v_pk_mul_f32 v[204:205], v[204:205], v[12:13] op_sel:[0,0] op_sel_hi:[1,0]
  v_pk_mul_f32 v[206:207], v[206:207], v[12:13] op_sel:[0,0] op_sel_hi:[1,0]
  v_cvt_pk_bf16_f32 v200, v200, v201
  v_cvt_pk_bf16_f32 v201, v202, v203
  v_cvt_pk_bf16_f32 v202, v204, v205
  v_cvt_pk_bf16_f32 v203, v206, v207
  buffer_store_dwordx4 v[200:203], v1, s[20:23], s43 offen offset:1024 sc1
  v_accvgpr_read_b32 v192, a112
  v_accvgpr_read_b32 v193, a113
  v_accvgpr_read_b32 v194, a114
  v_accvgpr_read_b32 v195, a115
  v_pk_mul_f32 v[192:193], v[192:193], v[12:13] op_sel:[0,0] op_sel_hi:[1,0]
  v_pk_mul_f32 v[194:195], v[194:195], v[12:13] op_sel:[0,0] op_sel_hi:[1,0]
  v_accvgpr_read_b32 v196, a116
  v_accvgpr_read_b32 v197, a117
  v_accvgpr_read_b32 v198, a118
  v_accvgpr_read_b32 v199, a119
  v_pk_mul_f32 v[196:197], v[196:197], v[12:13] op_sel:[0,0] op_sel_hi:[1,0]
  v_pk_mul_f32 v[198:199], v[198:199], v[12:13] op_sel:[0,0] op_sel_hi:[1,0]
  v_cvt_pk_bf16_f32 v192, v192, v193
  v_cvt_pk_bf16_f32 v193, v194, v195
  v_cvt_pk_bf16_f32 v194, v196, v197
  v_cvt_pk_bf16_f32 v195, v198, v199
  buffer_store_dwordx4 v[192:195], v1, s[20:23], s43 offen offset:2048 sc1
  v_accvgpr_read_b32 v200, a120
  v_accvgpr_read_b32 v201, a121
  v_accvgpr_read_b32 v202, a122
  v_accvgpr_read_b32 v203, a123
  v_pk_mul_f32 v[200:201], v[200:201], v[12:13] op_sel:[0,0] op_sel_hi:[1,0]
  v_pk_mul_f32 v[202:203], v[202:203], v[12:13] op_sel:[0,0] op_sel_hi:[1,0]
  v_accvgpr_read_b32 v204, a124
  v_accvgpr_read_b32 v205, a125
  v_accvgpr_read_b32 v206, a126
  v_accvgpr_read_b32 v207, a127
  v_pk_mul_f32 v[204:205], v[204:205], v[12:13] op_sel:[0,0] op_sel_hi:[1,0]
  v_pk_mul_f32 v[206:207], v[206:207], v[12:13] op_sel:[0,0] op_sel_hi:[1,0]
  v_cvt_pk_bf16_f32 v200, v200, v201
  v_cvt_pk_bf16_f32 v201, v202, v203
  v_cvt_pk_bf16_f32 v202, v204, v205
  v_cvt_pk_bf16_f32 v203, v206, v207
  buffer_store_dwordx4 v[200:203], v1, s[20:23], s43 offen offset:3072 sc1
  v_mov_b32 v249, v13
  s_nop 1
  v_permlane32_swap_b32 v13, v249
  v_add_f32 v13, v13, v249
  v_mov_b32 v249, v13
  s_nop 1
  v_permlane16_swap_b32 v13, v249
  v_add_f32 v13, v13, v249
  v_rcp_f32 v13, v13
  s_mov_b32 s43, 0
  v_accvgpr_read_b32 v192, a128
  v_accvgpr_read_b32 v193, a129
  v_accvgpr_read_b32 v194, a130
  v_accvgpr_read_b32 v195, a131
  v_pk_add_f32 v[192:193], v[192:193], v[176:177]
  v_pk_add_f32 v[194:195], v[194:195], v[178:179]
  v_pk_mul_f32 v[192:193], v[192:193], v[12:13] op_sel:[0,1] op_sel_hi:[1,1]
  v_pk_mul_f32 v[194:195], v[194:195], v[12:13] op_sel:[0,1] op_sel_hi:[1,1]
  v_accvgpr_read_b32 v196, a132
  v_accvgpr_read_b32 v197, a133
  v_accvgpr_read_b32 v198, a134
  v_accvgpr_read_b32 v199, a135
  v_pk_add_f32 v[196:197], v[196:197], v[180:181]
  v_pk_add_f32 v[198:199], v[198:199], v[182:183]
  v_pk_mul_f32 v[196:197], v[196:197], v[12:13] op_sel:[0,1] op_sel_hi:[1,1]
  v_pk_mul_f32 v[198:199], v[198:199], v[12:13] op_sel:[0,1] op_sel_hi:[1,1]
  v_cvt_pk_bf16_f32 v192, v192, v193
  v_cvt_pk_bf16_f32 v193, v194, v195
  v_cvt_pk_bf16_f32 v194, v196, v197
  v_cvt_pk_bf16_f32 v195, v198, v199
  buffer_store_dwordx4 v[192:195], v2, s[20:23], s43 offen sc1
  v_accvgpr_read_b32 v200, a136
  v_accvgpr_read_b32 v201, a137
  v_accvgpr_read_b32 v202, a138
  v_accvgpr_read_b32 v203, a139
  v_pk_add_f32 v[200:201], v[200:201], v[184:185]
  v_pk_add_f32 v[202:203], v[202:203], v[186:187]
  v_pk_mul_f32 v[200:201], v[200:201], v[12:13] op_sel:[0,1] op_sel_hi:[1,1]
  v_pk_mul_f32 v[202:203], v[202:203], v[12:13] op_sel:[0,1] op_sel_hi:[1,1]
  v_accvgpr_read_b32 v204, a140
  v_accvgpr_read_b32 v205, a141
  v_accvgpr_read_b32 v206, a142
  v_accvgpr_read_b32 v207, a143
  v_pk_add_f32 v[204:205], v[204:205], v[188:189]
  v_pk_add_f32 v[206:207], v[206:207], v[190:191]
  v_pk_mul_f32 v[204:205], v[204:205], v[12:13] op_sel:[0,1] op_sel_hi:[1,1]
  v_pk_mul_f32 v[206:207], v[206:207], v[12:13] op_sel:[0,1] op_sel_hi:[1,1]
  v_cvt_pk_bf16_f32 v200, v200, v201
  v_cvt_pk_bf16_f32 v201, v202, v203
  v_cvt_pk_bf16_f32 v202, v204, v205
  v_cvt_pk_bf16_f32 v203, v206, v207
  buffer_store_dwordx4 v[200:203], v2, s[20:23], s43 offen offset:1024 sc1
  s_waitcnt vmcnt(0)
  s_barrier
  v_lshrrev_b32 v249, 4, v14
  v_bfe_u32 v250, v14, 1, 2
  v_xor_b32 v250, v250, v249
  v_lshlrev_b32 v250, 5, v250
  v_lshrrev_b32 v249, 3, v14
  v_lshl_add_u32 v250, v249, 10, v250
  v_and_b32 v249, 1, v14
  v_lshl_add_u32 v250, v249, 4, v250
  s_lshl_b32 s42, s3, 19
  v_add_u32 v7, s42, v250
  v_add_u32 v8, 0x1c00, v7
  v_add_u32 v254, 0x3800, v7
  v_add_u32 v255, 0x5400, v7
  s_lshl_b32 s42, s68, 21
  s_lshl_b32 s43, s67, 7
  s_add_u32 s42, s42, s43
  s_sub_u32 s43, 0x400000, s42
  s_add_u32 s24, s56, s42
  s_addc_u32 s25, s57, 0
  s_mov_b32 s26, s43
  s_mov_b32 s27, 0x20000
  s_mov_b32 s100, 0
  s_add_u32 m0, s75, 0
  s_nop 0
  buffer_load_dwordx4 v7, s[24:27], s100 offen lds
  buffer_load_dwordx4 v8, s[24:27], s100 offen offset:1024 lds
  buffer_load_dwordx4 v254, s[24:27], s100 offen offset:2048 lds
  buffer_load_dwordx4 v255, s[24:27], s100 offen offset:3072 lds
  s_mov_b32 s100, 0x8000
  s_add_u32 m0, s75, 0x4000
  s_nop 0
  buffer_load_dwordx4 v7, s[24:27], s100 offen lds
  buffer_load_dwordx4 v8, s[24:27], s100 offen offset:1024 lds
  buffer_load_dwordx4 v254, s[24:27], s100 offen offset:2048 lds
  buffer_load_dwordx4 v255, s[24:27], s100 offen offset:3072 lds
  s_mov_b32 s100, 0x10000
  s_add_u32 m0, s75, 0x8000
  s_nop 0
  buffer_load_dwordx4 v7, s[24:27], s100 offen lds
  buffer_load_dwordx4 v8, s[24:27], s100 offen offset:1024 lds
  buffer_load_dwordx4 v254, s[24:27], s100 offen offset:2048 lds
  buffer_load_dwordx4 v255, s[24:27], s100 offen offset:3072 lds
  s_mov_b32 s100, 0x18000
  s_add_u32 m0, s75, 0xc000
  s_nop 0
  buffer_load_dwordx4 v7, s[24:27], s100 offen lds
  buffer_load_dwordx4 v8, s[24:27], s100 offen offset:1024 lds
  buffer_load_dwordx4 v254, s[24:27], s100 offen offset:2048 lds
  buffer_load_dwordx4 v255, s[24:27], s100 offen offset:3072 lds
  s_mov_b32 s100, 0x20000
  s_add_u32 m0, s75, 0x10000
  s_nop 0
  buffer_load_dwordx4 v7, s[24:27], s100 offen lds
  buffer_load_dwordx4 v8, s[24:27], s100 offen offset:1024 lds
  buffer_load_dwordx4 v254, s[24:27], s100 offen offset:2048 lds
  buffer_load_dwordx4 v255, s[24:27], s100 offen offset:3072 lds
  s_mov_b32 s100, 0x28000
  s_add_u32 m0, s75, 0x14000
  s_nop 0
  buffer_load_dwordx4 v7, s[24:27], s100 offen lds
  buffer_load_dwordx4 v8, s[24:27], s100 offen offset:1024 lds
  buffer_load_dwordx4 v254, s[24:27], s100 offen offset:2048 lds
  buffer_load_dwordx4 v255, s[24:27], s100 offen offset:3072 lds
  s_waitcnt vmcnt(0)
  s_branch L_join
L_cx2:
  ds_write_b128 v250, a[128:131]
  ds_write_b128 v250, a[132:135] offset:1024
  ds_write_b128 v250, a[136:139] offset:2048
  ds_write_b128 v250, a[140:143] offset:3072
  v_accvgpr_mov_b32 a128, a144
  v_accvgpr_mov_b32 a129, a145
  v_accvgpr_mov_b32 a130, a146
  v_accvgpr_mov_b32 a131, a147
  v_accvgpr_mov_b32 a132, a148
  v_accvgpr_mov_b32 a133, a149
  v_accvgpr_mov_b32 a134, a150
  v_accvgpr_mov_b32 a135, a151
  v_accvgpr_mov_b32 a136, a152
  v_accvgpr_mov_b32 a137, a153
  v_accvgpr_mov_b32 a138, a154
  v_accvgpr_mov_b32 a139, a155
  v_accvgpr_mov_b32 a140, a156
  v_accvgpr_mov_b32 a141, a157
  v_accvgpr_mov_b32 a142, a158
  v_accvgpr_mov_b32 a143, a159
  s_branch L_cx2r
.section .rodata,"a"
.p2align 6
.amdhsa_kernel standalone__mha_block_cached__near_ridge_kernel
  .amdhsa_next_free_vgpr 512
  .amdhsa_next_free_sgpr 102
  .amdhsa_accum_offset 256
  .amdhsa_group_segment_fixed_size 0
  .amdhsa_kernarg_size 64
  .amdhsa_user_sgpr_count 2
  .amdhsa_user_sgpr_kernarg_segment_ptr 1
  .amdhsa_system_sgpr_workgroup_id_x 1
.end_amdhsa_kernel
```
